```python
import torch

def _softmax(x, axis=-1):
    return torch.softmax(x, dim=axis)
def _gelu(x):
    return torch.nn.functional.gelu(x, approximate="tanh")
def _silu(x):
    return torch.nn.functional.silu(x)
def _sigmoid(x):
    return torch.sigmoid(x)
def _layernorm(x, axis=-1, eps=1e-5):
    m = x.mean(dim=axis, keepdim=True)
    v = x.var(dim=axis, keepdim=True, unbiased=False)
    return (x - m) / torch.sqrt(v + eps)
def _scatter_add(tgt, idx, src, axis=0):
    return tgt.clone().index_add_(axis, idx, src)
def _segment_sum(src, seg, n):
    out = torch.zeros((n,) + src.shape[1:], dtype=src.dtype)
    return out.index_add_(0, seg, src)
def _pad(x, pw):
    flat = tuple(v for pair in reversed(pw) for v in pair)
    return torch.nn.functional.pad(x, flat)

kernel_name = 'concat_heads__gqa_block_cached__gqa_block_cached__near_ridge'

def setup_inputs():

    _w = (lambda a: (lambda t: t.to(torch.bfloat16) if t.is_floating_point() else t)(torch.as_tensor(a)))
    def _A_setup():
        B, Sq, D = 16, 48, 448
        Hq, Hkv, Sk, Dh = 16, 8, 512, 256
        assert Hq % Hkv == 0, (Hq, Hkv)
        return {
            "x": _w((lambda *s: torch.randn(*s, dtype=torch.bfloat16) * 0.8)(B, Sq, D)),
            "k_cache": _w((lambda *s: torch.randn(*s, dtype=torch.bfloat16) * 0.8)(B, Hkv, Sk, Dh)),
            "v_cache": _w((lambda *s: torch.randn(*s, dtype=torch.bfloat16) * 0.05)(B, Hkv, Sk, Dh)),
            "wq": _w((lambda *s: torch.randn(*s, dtype=torch.bfloat16) * 0.8)(D, Hq * Dh) * (D ** -0.5)),
            "wo": _w((lambda *s: torch.randn(*s, dtype=torch.bfloat16) * 0.05)(Hq * Dh, D) * ((Hq * Dh) ** -0.5)),
        }
    _A_in = _A_setup()

    def _B_setup():
        B, Sq, D = 16, 48, 448
        Hq, Hkv, Sk, Dh = 16, 8, 512, 256
        assert Hq % Hkv == 0, (Hq, Hkv)
        return {
            "x": _w((lambda *s: torch.randn(*s, dtype=torch.bfloat16) * 0.8)(B, Sq, D)),
            "k_cache": _w((lambda *s: torch.randn(*s, dtype=torch.bfloat16) * 0.8)(B, Hkv, Sk, Dh)),
            "v_cache": _w((lambda *s: torch.randn(*s, dtype=torch.bfloat16) * 0.05)(B, Hkv, Sk, Dh)),
            "wq": _w((lambda *s: torch.randn(*s, dtype=torch.bfloat16) * 0.8)(D, Hq * Dh) * (D ** -0.5)),
            "wo": _w((lambda *s: torch.randn(*s, dtype=torch.bfloat16) * 0.05)(Hq * Dh, D) * ((Hq * Dh) ** -0.5)),
        }
    _B_in = _B_setup()

    return {
        "A_x": _A_in["x"],
        "A_k_cache": _A_in["k_cache"],
        "A_v_cache": _A_in["v_cache"],
        "A_wq": _A_in["wq"],
        "A_wo": _A_in["wo"],
        "B_x": _B_in["x"],
        "B_k_cache": _B_in["k_cache"],
        "B_v_cache": _B_in["v_cache"],
        "B_wq": _B_in["wq"],
        "B_wo": _B_in["wo"],
    }

def reference(A_x, A_k_cache, A_v_cache, A_wq, A_wo, B_x, B_k_cache, B_v_cache, B_wq, B_wo):
    def _A_ref(x, k_cache, v_cache, wq, wo):
        B, Sq, D = x.shape
        Hq, Dh = 16, 256
        Hkv = k_cache.shape[1]
        rep = Hq // Hkv
        q = (lambda x, *d: x.permute(*d))((x @ wq).reshape(B, Sq, Hq, Dh), 0, 2, 1, 3)
        k = (lambda x, n, axis: torch.repeat_interleave(x, n, dim=axis))(k_cache, rep, axis=1)
        v = (lambda x, n, axis: torch.repeat_interleave(x, n, dim=axis))(v_cache, rep, axis=1)
        scores = torch.einsum("bhqd,bhkd->bhqk", q, k) * (Dh ** -0.5)
        p = _softmax(scores, axis=-1)
        o = torch.einsum("bhqk,bhkd->bhqd", p, v)
        return (lambda x, *d: x.permute(*d))(o, 0, 2, 1, 3).reshape(B, Sq, Hq * Dh) @ wo

    def _B_ref(x, k_cache, v_cache, wq, wo):
        B, Sq, D = x.shape
        Hq, Dh = 16, 256
        Hkv = k_cache.shape[1]
        rep = Hq // Hkv
        q = (lambda x, *d: x.permute(*d))((x @ wq).reshape(B, Sq, Hq, Dh), 0, 2, 1, 3)
        k = (lambda x, n, axis: torch.repeat_interleave(x, n, dim=axis))(k_cache, rep, axis=1)
        v = (lambda x, n, axis: torch.repeat_interleave(x, n, dim=axis))(v_cache, rep, axis=1)
        scores = torch.einsum("bhqd,bhkd->bhqk", q, k) * (Dh ** -0.5)
        p = _softmax(scores, axis=-1)
        o = torch.einsum("bhqk,bhkd->bhqd", p, v)
        return (lambda x, *d: x.permute(*d))(o, 0, 2, 1, 3).reshape(B, Sq, Hq * Dh) @ wo

    a = _A_ref(A_x, A_k_cache, A_v_cache, A_wq, A_wo)
    b = _B_ref(B_x, B_k_cache, B_v_cache, B_wq, B_wo)
    return torch.concatenate([a, b], axis=-1)
```

```asm
; @launch grid=(256,1,1) block=(256,1,1) lds=161792
.amdgcn_target "amdgcn-amd-amdhsa--gfx950"
.text
.globl concat_heads__gqa_block_cached__gqa_block_cached__near_ridge_kernel
.p2align 8
.type concat_heads__gqa_block_cached__gqa_block_cached__near_ridge_kernel,@function
concat_heads__gqa_block_cached__gqa_block_cached__near_ridge_kernel:

    s_cmp_ge_u32 s2, 256
    s_cbranch_scc1 L_end
    s_load_dwordx8 s[8:15], s[0:1], 0
    s_load_dwordx8 s[20:27], s[0:1], 40
    s_load_dwordx2 s[16:17], s[0:1], 32
    s_load_dwordx2 s[18:19], s[0:1], 72
    s_load_dwordx4 s[28:31], s[0:1], 80
    s_load_dwordx2 s[32:33], s[0:1], 96

    v_lshrrev_b32 v56, 6, v0
    v_and_b32 v1, 63, v0

    s_getpc_b64 s[4:5]
    s_and_b32 s4, s4, 0xffffff00
    s_lshr_b32 s96, s2, 3
    s_mul_i32 s96, s96, 10
    v_min_u32 v58, 9, v1
    v_add_u32 v58, s96, v58
    v_min_u32 v58, (L_end-concat_heads__gqa_block_cached__gqa_block_cached__near_ridge_kernel)/128, v58
    v_lshlrev_b32 v58, 7, v58
    v_mov_b32 v59, s5
    v_add_co_u32 v58, vcc, s4, v58
    s_nop 1
    v_addc_co_u32 v59, vcc, 0, v59, vcc

    global_load_dword v65, v[58:59], off

    s_and_b32 s96, s2, 7
    v_readfirstlane_b32 s87, v56
    s_lshr_b32 s97, s2, 3
    s_lshr_b32 s91, s96, 2
    s_and_b32 s96, s96, 3
    s_lshl_b32 s96, s96, 1
    s_and_b32 s90, s97, 1
    s_add_u32 s90, s90, s96
    s_lshr_b32 s89, s97, 1
    v_lshrrev_b32 v44, 4, v1
    v_and_b32 v45, 15, v1
    v_lshrrev_b32 v48, 3, v1
    v_and_b32 v49, 7, v1
    s_lshl_b32 s86, s87, 12
    s_mov_b32 s92, s89
    s_cmp_ge_u32 s92, 7
    s_cselect_b32 s96, 7, 0
    s_sub_u32 s92, s92, s96
    s_cmp_ge_u32 s92, 7
    s_cselect_b32 s96, 7, 0
    s_sub_u32 s92, s92, s96

    s_add_u32 s96, s89, 0
    s_and_b32 s96, s96, 3
    s_lshl_b32 s74, s96, 7
    s_mul_i32 s78, s96, 57344
    s_mov_b32 s82, 0
    s_add_u32 s96, s89, 1
    s_and_b32 s96, s96, 3
    s_lshl_b32 s75, s96, 7
    s_mul_i32 s79, s96, 57344
    s_mov_b32 s83, 65536
    s_add_u32 s96, s89, 2
    s_and_b32 s96, s96, 3
    s_lshl_b32 s76, s96, 7
    s_mul_i32 s80, s96, 57344
    s_mov_b32 s84, 131072
    s_add_u32 s96, s89, 3
    s_and_b32 s96, s96, 3
    s_lshl_b32 s77, s96, 7
    s_mul_i32 s81, s96, 57344
    s_mov_b32 s85, 196608
    s_mul_i32 s96, s87, 1
    v_mul_u32_u24 v52, 16, v48
    v_add_u32 v52, s96, v52
    v_lshlrev_b32 v52, 9, v52
    v_lshrrev_b32 v53, 1, v48

    v_add_u32 v50, 0, v53
    v_xor_b32 v50, v50, v49
    v_lshlrev_b32 v50, 4, v50
    v_add_u32 v50, v50, v52
    v_add_u32 v6, 0, v50

    v_add_u32 v50, 4, v53
    v_xor_b32 v50, v50, v49
    v_lshlrev_b32 v50, 4, v50
    v_add_u32 v50, v50, v52
    v_add_u32 v7, 1024, v50

    v_add_u32 v50, 0, v53
    v_xor_b32 v50, v50, v49
    v_lshlrev_b32 v50, 4, v50
    v_add_u32 v50, v50, v52
    v_add_u32 v8, 2048, v50

    v_add_u32 v50, 4, v53
    v_xor_b32 v50, v50, v49
    v_lshlrev_b32 v50, 4, v50
    v_add_u32 v50, v50, v52
    v_add_u32 v9, 3072, v50

    s_min_u32 s96, s87, 2
    s_lshl_b32 s97, s96, 4
    v_add_u32 v50, s97, v48
    v_mul_u32_u24 v50, 896, v50
    v_lshrrev_b32 v51, 1, v48
    v_xor_b32 v52, v51, v49
    v_lshlrev_b32 v52, 4, v52
    v_add_u32 v54, v50, v52
    v_add_u32 v51, 4, v51
    v_xor_b32 v52, v51, v49
    v_lshlrev_b32 v52, 4, v52
    v_add_u32 v50, v50, v52
    v_add_u32 v55, 6144, v50
    s_lshl_b32 s98, s96, 11

    s_add_u32 s96, s92, 0
    s_cmp_ge_u32 s96, 7
    s_cselect_b32 s97, 7, 0
    s_sub_u32 s96, s96, s97
    s_lshl_b32 s60, s96, 19
    s_lshl_b32 s67, s96, 7

    s_add_u32 s96, s92, 1
    s_cmp_ge_u32 s96, 7
    s_cselect_b32 s97, 7, 0
    s_sub_u32 s96, s96, s97
    s_lshl_b32 s61, s96, 19
    s_lshl_b32 s68, s96, 7

    s_add_u32 s96, s92, 2
    s_cmp_ge_u32 s96, 7
    s_cselect_b32 s97, 7, 0
    s_sub_u32 s96, s96, s97
    s_lshl_b32 s62, s96, 19
    s_lshl_b32 s69, s96, 7

    s_add_u32 s96, s92, 3
    s_cmp_ge_u32 s96, 7
    s_cselect_b32 s97, 7, 0
    s_sub_u32 s96, s96, s97
    s_lshl_b32 s63, s96, 19
    s_lshl_b32 s70, s96, 7

    s_add_u32 s96, s92, 4
    s_cmp_ge_u32 s96, 7
    s_cselect_b32 s97, 7, 0
    s_sub_u32 s96, s96, s97
    s_lshl_b32 s64, s96, 19
    s_lshl_b32 s71, s96, 7

    s_add_u32 s96, s92, 5
    s_cmp_ge_u32 s96, 7
    s_cselect_b32 s97, 7, 0
    s_sub_u32 s96, s96, s97
    s_lshl_b32 s65, s96, 19
    s_lshl_b32 s72, s96, 7

    s_add_u32 s96, s92, 6
    s_cmp_ge_u32 s96, 7
    s_cselect_b32 s97, 7, 0
    s_sub_u32 s96, s96, s97
    s_lshl_b32 s66, s96, 19
    s_lshl_b32 s73, s96, 7

    s_lshl_b32 s96, s87, 4
    v_add_u32 v53, s96, v44
    v_lshlrev_b32 v53, 13, v53
    v_and_b32 v51, 1, v45
    v_lshlrev_b32 v51, 4, v51
    v_add_u32 v53, v53, v51

    v_lshrrev_b32 v50, 1, v45
    v_add_u32 v51, 0, v44
    v_xor_b32 v50, v50, v51
    v_lshrrev_b32 v51, 2, v50
    v_lshlrev_b32 v51, 9, v51
    v_and_b32 v50, 3, v50
    v_lshlrev_b32 v50, 5, v50
    v_add_u32 v50, v50, v51
    v_add_u32 v50, v50, v53
    v_add_u32 v2, 0, v50
    v_add_u32 v3, 31744, v50

    v_lshrrev_b32 v50, 1, v45
    v_add_u32 v51, 4, v44
    v_xor_b32 v50, v50, v51
    v_lshrrev_b32 v51, 2, v50
    v_lshlrev_b32 v51, 9, v51
    v_and_b32 v50, 3, v50
    v_lshlrev_b32 v50, 5, v50
    v_add_u32 v50, v50, v51
    v_add_u32 v50, v50, v53
    v_add_u32 v4, 63488, v50
    v_add_u32 v5, 95232, v50

    s_lshl_b32 s96, s89, 3
    s_add_u32 s96, s96, s90
    s_lshl_b32 s96, s96, 18
    s_waitcnt lgkmcnt(0)
    s_cmp_eq_u32 s91, 0
    s_cselect_b64 s[10:11], s[10:11], s[22:23]
    s_cselect_b64 s[12:13], s[12:13], s[24:25]
    s_cselect_b64 s[8:9], s[8:9], s[20:21]
    s_cselect_b64 s[14:15], s[14:15], s[26:27]
    s_cselect_b64 s[16:17], s[16:17], s[18:19]

    s_add_u32 s44, s10, s96
    s_addc_u32 s45, s11, 0
    s_and_b32 s45, s45, 0xffff
    s_mov_b32 s46, 0x40000
    s_mov_b32 s47, 0x20000

    s_add_u32 s48, s12, s96
    s_addc_u32 s49, s13, 0
    s_and_b32 s49, s49, 0xffff
    s_mov_b32 s50, 0x40000
    s_mov_b32 s51, 0x20000

    s_mul_i32 s96, s89, 43008

    s_add_u32 s36, s8, s96
    s_addc_u32 s37, s9, 0
    s_and_b32 s37, s37, 0xffff
    s_mov_b32 s38, 43008
    s_mov_b32 s39, 0x20000

    s_lshl_b32 s96, s90, 10
    s_sub_u32 s97, 3670016, s96

    s_add_u32 s40, s14, s96
    s_addc_u32 s41, s15, 0
    s_and_b32 s41, s41, 0xffff
    s_mov_b32 s42, s97
    s_mov_b32 s43, 0x20000

    s_cmp_eq_u32 s87, 3
    s_cbranch_scc1 L_skipx
    s_add_u32 m0, s98, 0
    s_mov_b32 s88, s67
    buffer_load_dwordx4 v54, s[36:39], s88 offen lds
    buffer_load_dwordx4 v55, s[36:39], s88 offen offset:1024 lds
    s_add_u32 m0, s98, 6144
    s_mov_b32 s88, s68
    buffer_load_dwordx4 v54, s[36:39], s88 offen lds
    buffer_load_dwordx4 v55, s[36:39], s88 offen offset:1024 lds
    s_add_u32 m0, s98, 12288
    s_mov_b32 s88, s69
    buffer_load_dwordx4 v54, s[36:39], s88 offen lds
    buffer_load_dwordx4 v55, s[36:39], s88 offen offset:1024 lds
    s_add_u32 m0, s98, 18432
    s_mov_b32 s88, s70
    buffer_load_dwordx4 v54, s[36:39], s88 offen lds
    buffer_load_dwordx4 v55, s[36:39], s88 offen offset:1024 lds
    s_add_u32 m0, s98, 24576
    s_mov_b32 s88, s71
    buffer_load_dwordx4 v54, s[36:39], s88 offen lds
    buffer_load_dwordx4 v55, s[36:39], s88 offen offset:1024 lds
    s_add_u32 m0, s98, 30720
    s_mov_b32 s88, s72
    buffer_load_dwordx4 v54, s[36:39], s88 offen lds
    buffer_load_dwordx4 v55, s[36:39], s88 offen offset:1024 lds
    s_add_u32 m0, s98, 36864
    s_mov_b32 s88, s73
    buffer_load_dwordx4 v54, s[36:39], s88 offen lds
    buffer_load_dwordx4 v55, s[36:39], s88 offen offset:1024 lds
L_skipx:
    s_add_u32 m0, s86, 49152
    s_add_u32 s88, s60, s74
    buffer_load_dwordx4 v2, s[40:43], s88 offen lds
    buffer_load_dwordx4 v3, s[40:43], s88 offen offset:1024 lds
    buffer_load_dwordx4 v4, s[40:43], s88 offen offset:2048 lds
    buffer_load_dwordx4 v5, s[40:43], s88 offen offset:3072 lds
    s_add_u32 m0, s86, 65536
    s_add_u32 s88, s61, s74
    buffer_load_dwordx4 v2, s[40:43], s88 offen lds
    buffer_load_dwordx4 v3, s[40:43], s88 offen offset:1024 lds
    buffer_load_dwordx4 v4, s[40:43], s88 offen offset:2048 lds
    buffer_load_dwordx4 v5, s[40:43], s88 offen offset:3072 lds
    s_mul_i32 s96, s90, 458752

    s_add_u32 s52, s16, s96
    s_addc_u32 s53, s17, 0
    s_and_b32 s53, s53, 0xffff
    s_mov_b32 s54, 458752
    s_mov_b32 s55, 0x20000

    s_lshl_b32 s93, s91, 4
    s_add_u32 s93, s93, s89
    s_lshl_b32 s96, s93, 3
    s_add_u32 s96, s96, s90
    s_mul_i32 s96, s96, 43008
    s_add_u32 s96, s96, 0

    s_add_u32 s56, s32, s96
    s_addc_u32 s57, s33, 0
    s_and_b32 s57, s57, 0xffff
    s_mov_b32 s58, 43008
    s_mov_b32 s59, 0x20000

    s_lshl_b32 s96, s93, 10
    s_add_u32 s96, s96, 12582912

    s_add_u32 s4, s32, s96
    s_addc_u32 s5, s33, 0
    s_and_b32 s5, s5, 0xffff
    s_mov_b32 s6, 1024
    s_mov_b32 s7, 0x20000

    s_mov_b32 s94, 0x3db8aa3b
    s_mov_b32 s95, 0x3db8aa3b
    v_bfe_u32 v46, v1, 2, 2
    v_and_b32 v47, 3, v1
    v_lshrrev_b32 v53, 1, v48
    s_mul_i32 s96, s87, 1
    v_mul_u32_u24 v52, 16, v48
    v_add_u32 v52, s96, v52
    v_lshlrev_b32 v52, 9, v52
    v_and_b32 v51, 3, v53
    v_lshlrev_b32 v51, 1, v51
    v_xor_b32 v51, v51, v49
    v_lshlrev_b32 v51, 4, v51
    v_add_u32 v50, v51, v52

    v_add_u32 v10, 0, v50
    v_add_u32 v11, 1024, v50
    v_add_u32 v12, 2048, v50
    v_add_u32 v13, 3072, v50

    s_lshr_b32 s96, s87, 1
    s_lshl_b32 s96, s96, 8
    s_and_b32 s97, s87, 1
    s_lshl_b32 s97, s97, 5
    s_add_u32 s96, s96, s97
    v_add_u32 v50, s96, v48
    v_mul_u32_u24 v50, 896, v50
    v_add_u32 v50, v50, v51

    v_add_u32 v14, 0, v50
    v_add_u32 v15, 6144, v50
    v_add_u32 v16, 12288, v50
    v_add_u32 v17, 18432, v50

    v_lshlrev_b32 v50, 3, v44
    v_add_u32 v50, v50, v46
    v_lshlrev_b32 v50, 8, v50
    v_lshlrev_b32 v51, 3, v47
    v_add_u32 v50, v50, v51
    v_and_b32 v51, 1, v44
    v_lshlrev_b32 v51, 2, v51
    v_add_u32 v51, v51, v46
    s_lshl_b32 s96, s87, 1

    s_add_u32 s97, s96, 0
    v_xor_b32 v52, s97, v51
    v_lshlrev_b32 v52, 5, v52
    v_add_u32 v18, v52, v50
    v_add_u32 v19, 0x10000, v18

    s_add_u32 s97, s96, 1
    v_xor_b32 v52, s97, v51
    v_lshlrev_b32 v52, 5, v52
    v_add_u32 v20, v52, v50
    v_add_u32 v21, 0x10000, v20

    s_and_b32 s96, s87, 1
    s_lshl_b32 s96, s96, 6
    v_add_u32 v50, s96, v45
    v_lshlrev_b32 v50, 7, v50
    v_and_b32 v51, 1, v44
    v_lshlrev_b32 v51, 3, v51
    v_add_u32 v50, v50, v51
    v_lshrrev_b32 v51, 1, v44
    v_lshrrev_b32 v52, 1, v45
    v_xor_b32 v51, v51, v52

    v_xor_b32 v52, 0, v51
    v_lshlrev_b32 v52, 4, v52
    v_add_u32 v22, v52, v50
    v_add_u32 v23, 0x10000, v22

    v_xor_b32 v52, 2, v51
    v_lshlrev_b32 v52, 4, v52
    v_add_u32 v24, v52, v50
    v_add_u32 v25, 0x10000, v24

    v_xor_b32 v52, 4, v51
    v_lshlrev_b32 v52, 4, v52
    v_add_u32 v26, v52, v50
    v_add_u32 v27, 0x10000, v26

    v_xor_b32 v52, 6, v51
    v_lshlrev_b32 v52, 4, v52
    v_add_u32 v28, v52, v50
    v_add_u32 v29, 0x10000, v28

    v_lshlrev_b32 v50, 2, v44
    v_add_u32 v50, v50, v46
    v_lshlrev_b32 v50, 7, v50
    v_lshrrev_b32 v51, 1, v47
    v_lshlrev_b32 v51, 4, v51
    v_add_u32 v50, v50, v51
    v_and_b32 v51, 1, v47
    v_lshlrev_b32 v51, 3, v51
    v_add_u32 v50, v50, v51
    v_lshlrev_b32 v51, 1, v44
    v_lshrrev_b32 v52, 1, v46
    v_add_u32 v51, v51, v52
    v_and_b32 v51, 3, v51
    s_and_b32 s96, s87, 1
    s_lshl_b32 s97, s96, 13
    s_lshl_b32 s96, s96, 1

    s_xor_b32 s98, s96, 0
    v_xor_b32 v52, s98, v51
    v_lshlrev_b32 v52, 5, v52
    v_add_u32 v52, v52, v50
    v_add_u32 v30, s97, v52
    v_add_u32 v31, 0x10000, v30

    s_xor_b32 s98, s96, 1
    v_xor_b32 v52, s98, v51
    v_lshlrev_b32 v52, 5, v52
    v_add_u32 v52, v52, v50
    v_add_u32 v32, s97, v52
    v_add_u32 v33, 0x10000, v32

    s_xor_b32 s98, s96, 2
    v_xor_b32 v52, s98, v51
    v_lshlrev_b32 v52, 5, v52
    v_add_u32 v52, v52, v50
    v_add_u32 v34, s97, v52
    v_add_u32 v35, 0x10000, v34

    s_xor_b32 s98, s96, 3
    v_xor_b32 v52, s98, v51
    v_lshlrev_b32 v52, 5, v52
    v_add_u32 v52, v52, v50
    v_add_u32 v36, s97, v52
    v_add_u32 v37, 0x10000, v36

    v_xor_b32 v52, s87, v51
    v_lshlrev_b32 v52, 5, v52
    v_add_u32 v38, v52, v50
    v_add_u32 v39, 0x10000, v38
    v_lshlrev_b32 v50, 4, v1
    v_add_u32 v42, 131072, v50
    s_mul_i32 s96, s87, 6144
    v_add_u32 v40, s96, v42
    s_xor_b32 s97, s87, 1
    s_mul_i32 s97, s97, 6144
    v_add_u32 v41, s97, v42
    s_and_b32 s97, s87, 2
    s_mul_i32 s97, s97, 6144
    v_add_u32 v43, s97, v42

    s_waitcnt vmcnt(8)
    s_barrier

    v_and_b32 v58, 15, v1
    v_lshrrev_b32 v59, 1, v58
    v_lshrrev_b32 v60, 4, v1
    v_xor_b32 v59, v59, v60
    v_lshlrev_b32 v58, 7, v58
    v_lshlrev_b32 v60, 4, v59
    v_add_u32 v56, v58, v60
    v_xor_b32 v59, 4, v59
    v_lshlrev_b32 v60, 4, v59
    v_add_u32 v57, v58, v60

    ds_read_b128 a[0:3], v56 offset:0
    ds_read_b128 a[4:7], v56 offset:2048
    ds_read_b128 a[8:11], v56 offset:4096
    ds_read_b128 a[12:15], v57 offset:0
    ds_read_b128 a[16:19], v57 offset:2048
    ds_read_b128 a[20:23], v57 offset:4096
    ds_read_b128 a[24:27], v56 offset:6144
    ds_read_b128 a[28:31], v56 offset:8192
    ds_read_b128 a[32:35], v56 offset:10240
    ds_read_b128 a[36:39], v57 offset:6144
    ds_read_b128 a[40:43], v57 offset:8192
    ds_read_b128 a[44:47], v57 offset:10240
    ds_read_b128 a[48:51], v56 offset:12288
    ds_read_b128 a[52:55], v56 offset:14336
    ds_read_b128 a[56:59], v56 offset:16384
    ds_read_b128 a[60:63], v57 offset:12288
    ds_read_b128 a[64:67], v57 offset:14336
    ds_read_b128 a[68:71], v57 offset:16384
    ds_read_b128 a[72:75], v56 offset:18432
    ds_read_b128 a[76:79], v56 offset:20480
    ds_read_b128 a[80:83], v56 offset:22528
    ds_read_b128 a[84:87], v57 offset:18432
    ds_read_b128 a[88:91], v57 offset:20480
    ds_read_b128 a[92:95], v57 offset:22528
    ds_read_b128 a[96:99], v56 offset:24576
    ds_read_b128 a[100:103], v56 offset:26624
    ds_read_b128 a[104:107], v56 offset:28672
    ds_read_b128 a[108:111], v57 offset:24576
    ds_read_b128 a[112:115], v57 offset:26624
    ds_read_b128 a[116:119], v57 offset:28672
    ds_read_b128 a[120:123], v56 offset:30720
    ds_read_b128 a[124:127], v56 offset:32768
    ds_read_b128 a[128:131], v56 offset:34816
    ds_read_b128 a[132:135], v57 offset:30720
    ds_read_b128 a[136:139], v57 offset:32768
    ds_read_b128 a[140:143], v57 offset:34816
    ds_read_b128 a[144:147], v56 offset:36864
    ds_read_b128 a[148:151], v56 offset:38912
    ds_read_b128 a[152:155], v56 offset:40960
    ds_read_b128 a[156:159], v57 offset:36864
    ds_read_b128 a[160:163], v57 offset:38912
    ds_read_b128 a[164:167], v57 offset:40960
    s_waitcnt lgkmcnt(0)
    s_add_u32 m0, s86, 81920
    s_add_u32 s88, s62, s74
    buffer_load_dwordx4 v2, s[40:43], s88 offen lds
    buffer_load_dwordx4 v3, s[40:43], s88 offen offset:1024 lds
    buffer_load_dwordx4 v4, s[40:43], s88 offen offset:2048 lds
    buffer_load_dwordx4 v5, s[40:43], s88 offen offset:3072 lds
    s_add_u32 m0, s86, 98304
    s_add_u32 s88, s63, s74
    buffer_load_dwordx4 v2, s[40:43], s88 offen lds
    buffer_load_dwordx4 v3, s[40:43], s88 offen offset:1024 lds
    buffer_load_dwordx4 v4, s[40:43], s88 offen offset:2048 lds
    buffer_load_dwordx4 v5, s[40:43], s88 offen offset:3072 lds
    s_add_u32 m0, s86, 114688
    s_add_u32 s88, s82, s74
    buffer_load_dwordx4 v6, s[44:47], s88 offen nt lds
    buffer_load_dwordx4 v7, s[44:47], s88 offen offset:1024 nt lds
    buffer_load_dwordx4 v8, s[44:47], s88 offen offset:2048 nt lds
    buffer_load_dwordx4 v9, s[44:47], s88 offen offset:3072 nt lds
    s_waitcnt vmcnt(16)
    s_barrier
    ds_read_b64_tr_b16 a[216:217], v18 offset:49152
    ds_read_b64_tr_b16 a[218:219], v18 offset:50176
    ds_read_b64_tr_b16 a[220:221], v20 offset:49152
    ds_read_b64_tr_b16 a[222:223], v20 offset:50176
    ds_read_b64_tr_b16 a[224:225], v18 offset:57344
    ds_read_b64_tr_b16 a[226:227], v18 offset:58368
    ds_read_b64_tr_b16 a[228:229], v20 offset:57344
    ds_read_b64_tr_b16 a[230:231], v20 offset:58368
    s_waitcnt lgkmcnt(6)
    s_waitcnt vmcnt(12)
    s_barrier
    v_mfma_f32_16x16x32_bf16 a[168:171], a[216:219], a[0:3], 0
    ds_read_b64_tr_b16 a[232:233], v19 offset:0
    s_add_u32 m0, s86, 0
    v_mfma_f32_16x16x32_bf16 a[172:175], a[216:219], a[4:7], 0
    ds_read_b64_tr_b16 a[234:235], v19 offset:1024
    s_add_u32 s88, s83, s74
    v_mfma_f32_16x16x32_bf16 a[176:179], a[216:219], a[8:11], 0
    buffer_load_dwordx4 v6, s[44:47], s88 offen nt lds
    s_waitcnt lgkmcnt(6)
    v_mfma_f32_16x16x32_bf16 a[180:183], a[220:223], a[0:3], 0
    ds_read_b64_tr_b16 a[236:237], v21 offset:0
    v_mfma_f32_16x16x32_bf16 a[184:187], a[220:223], a[4:7], 0
    ds_read_b64_tr_b16 a[238:239], v21 offset:1024
    v_mfma_f32_16x16x32_bf16 a[188:191], a[220:223], a[8:11], 0
    buffer_load_dwordx4 v7, s[44:47], s88 offen offset:1024 nt lds
    s_waitcnt lgkmcnt(6)
    v_mfma_f32_16x16x32_bf16 a[168:171], a[224:227], a[12:15], a[168:171]
    ds_read_b64_tr_b16 a[240:241], v19 offset:8192
    v_mfma_f32_16x16x32_bf16 a[172:175], a[224:227], a[16:19], a[172:175]
    ds_read_b64_tr_b16 a[242:243], v19 offset:9216
    v_mfma_f32_16x16x32_bf16 a[176:179], a[224:227], a[20:23], a[176:179]
    buffer_load_dwordx4 v8, s[44:47], s88 offen offset:2048 nt lds
    s_waitcnt lgkmcnt(6)
    v_mfma_f32_16x16x32_bf16 a[180:183], a[228:231], a[12:15], a[180:183]
    ds_read_b64_tr_b16 a[244:245], v21 offset:8192
    v_mfma_f32_16x16x32_bf16 a[184:187], a[228:231], a[16:19], a[184:187]
    ds_read_b64_tr_b16 a[246:247], v21 offset:9216
    v_mfma_f32_16x16x32_bf16 a[188:191], a[228:231], a[20:23], a[188:191]
    buffer_load_dwordx4 v9, s[44:47], s88 offen offset:3072 nt lds
    s_waitcnt lgkmcnt(6)
    s_waitcnt vmcnt(12)
    s_barrier
    v_mfma_f32_16x16x32_bf16 a[168:171], a[232:235], a[24:27], a[168:171]
    ds_read_b64_tr_b16 a[216:217], v19 offset:16384
    s_add_u32 m0, s86, 16384
    v_mfma_f32_16x16x32_bf16 a[172:175], a[232:235], a[28:31], a[172:175]
    ds_read_b64_tr_b16 a[218:219], v19 offset:17408
    s_add_u32 s88, s64, s74
    v_mfma_f32_16x16x32_bf16 a[176:179], a[232:235], a[32:35], a[176:179]
    buffer_load_dwordx4 v2, s[40:43], s88 offen lds
    s_waitcnt lgkmcnt(6)
    v_mfma_f32_16x16x32_bf16 a[180:183], a[236:239], a[24:27], a[180:183]
    ds_read_b64_tr_b16 a[220:221], v21 offset:16384
    v_mfma_f32_16x16x32_bf16 a[184:187], a[236:239], a[28:31], a[184:187]
    ds_read_b64_tr_b16 a[222:223], v21 offset:17408
    v_mfma_f32_16x16x32_bf16 a[188:191], a[236:239], a[32:35], a[188:191]
    buffer_load_dwordx4 v3, s[40:43], s88 offen offset:1024 lds
    s_waitcnt lgkmcnt(6)
    v_mfma_f32_16x16x32_bf16 a[168:171], a[240:243], a[36:39], a[168:171]
    ds_read_b64_tr_b16 a[224:225], v19 offset:24576
    v_mfma_f32_16x16x32_bf16 a[172:175], a[240:243], a[40:43], a[172:175]
    ds_read_b64_tr_b16 a[226:227], v19 offset:25600
    v_mfma_f32_16x16x32_bf16 a[176:179], a[240:243], a[44:47], a[176:179]
    buffer_load_dwordx4 v4, s[40:43], s88 offen offset:2048 lds
    s_waitcnt lgkmcnt(6)
    v_mfma_f32_16x16x32_bf16 a[180:183], a[244:247], a[36:39], a[180:183]
    ds_read_b64_tr_b16 a[228:229], v21 offset:24576
    v_mfma_f32_16x16x32_bf16 a[184:187], a[244:247], a[40:43], a[184:187]
    ds_read_b64_tr_b16 a[230:231], v21 offset:25600
    v_mfma_f32_16x16x32_bf16 a[188:191], a[244:247], a[44:47], a[188:191]
    buffer_load_dwordx4 v5, s[40:43], s88 offen offset:3072 lds
    s_waitcnt lgkmcnt(6)
    s_waitcnt vmcnt(12)
    s_barrier
    v_mfma_f32_16x16x32_bf16 a[168:171], a[216:219], a[48:51], a[168:171]
    ds_read_b64_tr_b16 a[232:233], v19 offset:32768
    s_add_u32 m0, s86, 32768
    v_mfma_f32_16x16x32_bf16 a[172:175], a[216:219], a[52:55], a[172:175]
    ds_read_b64_tr_b16 a[234:235], v19 offset:33792
    s_add_u32 s88, s65, s74
    v_mfma_f32_16x16x32_bf16 a[176:179], a[216:219], a[56:59], a[176:179]
    buffer_load_dwordx4 v2, s[40:43], s88 offen lds
    s_waitcnt lgkmcnt(6)
    v_mfma_f32_16x16x32_bf16 a[180:183], a[220:223], a[48:51], a[180:183]
    ds_read_b64_tr_b16 a[236:237], v21 offset:32768
    v_mfma_f32_16x16x32_bf16 a[184:187], a[220:223], a[52:55], a[184:187]
    ds_read_b64_tr_b16 a[238:239], v21 offset:33792
    v_mfma_f32_16x16x32_bf16 a[188:191], a[220:223], a[56:59], a[188:191]
    buffer_load_dwordx4 v3, s[40:43], s88 offen offset:1024 lds
    s_waitcnt lgkmcnt(6)
    v_mfma_f32_16x16x32_bf16 a[168:171], a[224:227], a[60:63], a[168:171]
    ds_read_b64_tr_b16 a[240:241], v19 offset:40960
    v_mfma_f32_16x16x32_bf16 a[172:175], a[224:227], a[64:67], a[172:175]
    ds_read_b64_tr_b16 a[242:243], v19 offset:41984
    v_mfma_f32_16x16x32_bf16 a[176:179], a[224:227], a[68:71], a[176:179]
    buffer_load_dwordx4 v4, s[40:43], s88 offen offset:2048 lds
    s_waitcnt lgkmcnt(6)
    v_mfma_f32_16x16x32_bf16 a[180:183], a[228:231], a[60:63], a[180:183]
    ds_read_b64_tr_b16 a[244:245], v21 offset:40960
    v_mfma_f32_16x16x32_bf16 a[184:187], a[228:231], a[64:67], a[184:187]
    ds_read_b64_tr_b16 a[246:247], v21 offset:41984
    v_mfma_f32_16x16x32_bf16 a[188:191], a[228:231], a[68:71], a[188:191]
    buffer_load_dwordx4 v5, s[40:43], s88 offen offset:3072 lds
    s_waitcnt lgkmcnt(6)
    s_waitcnt vmcnt(4)
    s_barrier
    v_mfma_f32_16x16x32_bf16 a[168:171], a[232:235], a[72:75], a[168:171]
    ds_read_b64_tr_b16 a[216:217], v18 offset:16384
    s_add_u32 m0, s86, 49152
    v_mfma_f32_16x16x32_bf16 a[172:175], a[232:235], a[76:79], a[172:175]
    ds_read_b64_tr_b16 a[218:219], v18 offset:17408
    s_add_u32 s88, s66, s74
    v_mfma_f32_16x16x32_bf16 a[176:179], a[232:235], a[80:83], a[176:179]
    buffer_load_dwordx4 v2, s[40:43], s88 offen lds
    s_waitcnt lgkmcnt(6)
    v_mfma_f32_16x16x32_bf16 a[180:183], a[236:239], a[72:75], a[180:183]
    ds_read_b64_tr_b16 a[220:221], v20 offset:16384
    v_mfma_f32_16x16x32_bf16 a[184:187], a[236:239], a[76:79], a[184:187]
    ds_read_b64_tr_b16 a[222:223], v20 offset:17408
    v_mfma_f32_16x16x32_bf16 a[188:191], a[236:239], a[80:83], a[188:191]
    buffer_load_dwordx4 v3, s[40:43], s88 offen offset:1024 lds
    s_waitcnt lgkmcnt(6)
    v_mfma_f32_16x16x32_bf16 a[168:171], a[240:243], a[84:87], a[168:171]
    ds_read_b64_tr_b16 a[224:225], v18 offset:24576
    v_mfma_f32_16x16x32_bf16 a[172:175], a[240:243], a[88:91], a[172:175]
    ds_read_b64_tr_b16 a[226:227], v18 offset:25600
    v_mfma_f32_16x16x32_bf16 a[176:179], a[240:243], a[92:95], a[176:179]
    buffer_load_dwordx4 v4, s[40:43], s88 offen offset:2048 lds
    s_waitcnt lgkmcnt(6)
    v_mfma_f32_16x16x32_bf16 a[180:183], a[244:247], a[84:87], a[180:183]
    ds_read_b64_tr_b16 a[228:229], v20 offset:24576
    v_mfma_f32_16x16x32_bf16 a[184:187], a[244:247], a[88:91], a[184:187]
    ds_read_b64_tr_b16 a[230:231], v20 offset:25600
    v_mfma_f32_16x16x32_bf16 a[188:191], a[244:247], a[92:95], a[188:191]
    buffer_load_dwordx4 v5, s[40:43], s88 offen offset:3072 lds
    s_waitcnt lgkmcnt(6)
    s_waitcnt vmcnt(4)
    s_barrier
    v_mfma_f32_16x16x32_bf16 a[168:171], a[216:219], a[96:99], a[168:171]
    ds_read_b64_tr_b16 a[232:233], v18 offset:32768
    s_add_u32 m0, s86, 65536
    v_mfma_f32_16x16x32_bf16 a[172:175], a[216:219], a[100:103], a[172:175]
    ds_read_b64_tr_b16 a[234:235], v18 offset:33792
    s_add_u32 s88, s85, s74
    v_mfma_f32_16x16x32_bf16 a[176:179], a[216:219], a[104:107], a[176:179]
    buffer_load_dwordx4 v6, s[44:47], s88 offen nt lds
    s_waitcnt lgkmcnt(6)
    v_mfma_f32_16x16x32_bf16 a[180:183], a[220:223], a[96:99], a[180:183]
    ds_read_b64_tr_b16 a[236:237], v20 offset:32768
    v_mfma_f32_16x16x32_bf16 a[184:187], a[220:223], a[100:103], a[184:187]
    ds_read_b64_tr_b16 a[238:239], v20 offset:33792
    v_mfma_f32_16x16x32_bf16 a[188:191], a[220:223], a[104:107], a[188:191]
    buffer_load_dwordx4 v7, s[44:47], s88 offen offset:1024 nt lds
    s_waitcnt lgkmcnt(6)
    v_mfma_f32_16x16x32_bf16 a[168:171], a[224:227], a[108:111], a[168:171]
    ds_read_b64_tr_b16 a[240:241], v18 offset:40960
    v_mfma_f32_16x16x32_bf16 a[172:175], a[224:227], a[112:115], a[172:175]
    ds_read_b64_tr_b16 a[242:243], v18 offset:41984
    v_mfma_f32_16x16x32_bf16 a[176:179], a[224:227], a[116:119], a[176:179]
    buffer_load_dwordx4 v8, s[44:47], s88 offen offset:2048 nt lds
    s_waitcnt lgkmcnt(6)
    v_mfma_f32_16x16x32_bf16 a[180:183], a[228:231], a[108:111], a[180:183]
    ds_read_b64_tr_b16 a[244:245], v20 offset:40960
    v_mfma_f32_16x16x32_bf16 a[184:187], a[228:231], a[112:115], a[184:187]
    ds_read_b64_tr_b16 a[246:247], v20 offset:41984
    v_mfma_f32_16x16x32_bf16 a[188:191], a[228:231], a[116:119], a[188:191]
    buffer_load_dwordx4 v9, s[44:47], s88 offen offset:3072 nt lds
    s_waitcnt lgkmcnt(6)
    s_waitcnt vmcnt(4)
    s_barrier
    v_mfma_f32_16x16x32_bf16 a[168:171], a[232:235], a[120:123], a[168:171]
    ds_read_b64_tr_b16 a[216:217], v18 offset:49152
    s_add_u32 m0, s86, 81920
    v_mfma_f32_16x16x32_bf16 a[172:175], a[232:235], a[124:127], a[172:175]
    ds_read_b64_tr_b16 a[218:219], v18 offset:50176
    s_add_u32 s88, s84, s74
    v_mfma_f32_16x16x32_bf16 a[176:179], a[232:235], a[128:131], a[176:179]
    buffer_load_dwordx4 v6, s[44:47], s88 offen nt lds
    s_waitcnt lgkmcnt(6)
    v_mfma_f32_16x16x32_bf16 a[180:183], a[236:239], a[120:123], a[180:183]
    ds_read_b64_tr_b16 a[220:221], v20 offset:49152
    v_mfma_f32_16x16x32_bf16 a[184:187], a[236:239], a[124:127], a[184:187]
    ds_read_b64_tr_b16 a[222:223], v20 offset:50176
    v_mfma_f32_16x16x32_bf16 a[188:191], a[236:239], a[128:131], a[188:191]
    buffer_load_dwordx4 v7, s[44:47], s88 offen offset:1024 nt lds
    s_waitcnt lgkmcnt(6)
    v_mfma_f32_16x16x32_bf16 a[168:171], a[240:243], a[132:135], a[168:171]
    ds_read_b64_tr_b16 a[224:225], v18 offset:57344
    v_mfma_f32_16x16x32_bf16 a[172:175], a[240:243], a[136:139], a[172:175]
    ds_read_b64_tr_b16 a[226:227], v18 offset:58368
    v_mfma_f32_16x16x32_bf16 a[176:179], a[240:243], a[140:143], a[176:179]
    buffer_load_dwordx4 v8, s[44:47], s88 offen offset:2048 nt lds
    s_waitcnt lgkmcnt(6)
    v_mfma_f32_16x16x32_bf16 a[180:183], a[244:247], a[132:135], a[180:183]
    ds_read_b64_tr_b16 a[228:229], v20 offset:57344
    v_mfma_f32_16x16x32_bf16 a[184:187], a[244:247], a[136:139], a[184:187]
    ds_read_b64_tr_b16 a[230:231], v20 offset:58368
    v_mfma_f32_16x16x32_bf16 a[188:191], a[244:247], a[140:143], a[188:191]
    buffer_load_dwordx4 v9, s[44:47], s88 offen offset:3072 nt lds
    s_waitcnt lgkmcnt(6)
    s_barrier
    v_mfma_f32_16x16x32_bf16 a[168:171], a[216:219], a[144:147], a[168:171]
    ds_read_b64 a[232:233], v23 offset:49152
    v_mfma_f32_16x16x32_bf16 a[172:175], a[216:219], a[148:151], a[172:175]
    ds_read_b64 a[234:235], v25 offset:49152
    v_mfma_f32_16x16x32_bf16 a[176:179], a[216:219], a[152:155], a[176:179]
    s_waitcnt lgkmcnt(6)
    v_mfma_f32_16x16x32_bf16 a[180:183], a[220:223], a[144:147], a[180:183]
    ds_read_b64 a[236:237], v27 offset:49152
    v_mfma_f32_16x16x32_bf16 a[184:187], a[220:223], a[148:151], a[184:187]
    ds_read_b64 a[238:239], v29 offset:49152
    v_mfma_f32_16x16x32_bf16 a[188:191], a[220:223], a[152:155], a[188:191]
    s_waitcnt lgkmcnt(6)
    v_mfma_f32_16x16x32_bf16 a[168:171], a[224:227], a[156:159], a[168:171]
    ds_read_b64 a[240:241], v23 offset:51200
    v_mfma_f32_16x16x32_bf16 a[172:175], a[224:227], a[160:163], a[172:175]
    ds_read_b64 a[242:243], v25 offset:51200
    v_mfma_f32_16x16x32_bf16 a[176:179], a[224:227], a[164:167], a[176:179]
    s_waitcnt lgkmcnt(6)
    v_mfma_f32_16x16x32_bf16 a[180:183], a[228:231], a[156:159], a[180:183]
    ds_read_b64 a[244:245], v27 offset:51200
    v_mfma_f32_16x16x32_bf16 a[184:187], a[228:231], a[160:163], a[184:187]
    ds_read_b64 a[246:247], v29 offset:51200
    v_mfma_f32_16x16x32_bf16 a[188:191], a[228:231], a[164:167], a[188:191]
    v_accvgpr_read_b32 v44, a168
    s_add_u32 m0, s86, 98304
    s_add_u32 s88, s60, s75
    buffer_load_dwordx4 v2, s[40:43], s88 offen lds
    v_accvgpr_read_b32 v45, a169
    v_accvgpr_read_b32 v46, a170
    v_accvgpr_read_b32 v47, a171
    v_cvt_pk_bf16_f32 v56, v44, v45
    v_cvt_pk_bf16_f32 v57, v46, v47
    v_accvgpr_read_b32 v48, a180
    v_accvgpr_read_b32 v49, a181
    v_accvgpr_read_b32 v50, a182
    v_accvgpr_read_b32 v51, a183
    v_cvt_pk_bf16_f32 v58, v48, v49
    v_cvt_pk_bf16_f32 v59, v50, v51
    buffer_load_dwordx4 v3, s[40:43], s88 offen offset:1024 lds
    ds_write_b128 v40, v[56:59] offset:0
    v_accvgpr_read_b32 v44, a172
    v_accvgpr_read_b32 v45, a173
    v_accvgpr_read_b32 v46, a174
    v_accvgpr_read_b32 v47, a175
    v_cvt_pk_bf16_f32 v60, v44, v45
    v_cvt_pk_bf16_f32 v61, v46, v47
    v_accvgpr_read_b32 v48, a184
    v_accvgpr_read_b32 v49, a185
    v_accvgpr_read_b32 v50, a186
    v_accvgpr_read_b32 v51, a187
    buffer_load_dwordx4 v4, s[40:43], s88 offen offset:2048 lds
    v_cvt_pk_bf16_f32 v62, v48, v49
    v_cvt_pk_bf16_f32 v63, v50, v51
    ds_write_b128 v40, v[60:63] offset:1024
    v_accvgpr_read_b32 v44, a176
    v_accvgpr_read_b32 v45, a177
    v_accvgpr_read_b32 v46, a178
    v_accvgpr_read_b32 v47, a179
    v_cvt_pk_bf16_f32 v56, v44, v45
    v_cvt_pk_bf16_f32 v57, v46, v47
    v_accvgpr_read_b32 v48, a188
    v_accvgpr_read_b32 v49, a189
    buffer_load_dwordx4 v5, s[40:43], s88 offen offset:3072 lds
    s_add_u32 m0, s86, 16384
    s_add_u32 s88, s61, s75
    v_accvgpr_read_b32 v50, a190
    v_accvgpr_read_b32 v51, a191
    v_cvt_pk_bf16_f32 v58, v48, v49
    v_cvt_pk_bf16_f32 v59, v50, v51
    ds_write_b128 v40, v[56:59] offset:2048
    s_waitcnt lgkmcnt(0)
    s_barrier
    ds_read_b128 a[168:171], v43 offset:0
    ds_read_b128 a[172:175], v43 offset:1024
    ds_read_b128 a[176:179], v43 offset:2048
    ds_read_b128 a[180:183], v43 offset:6144
    ds_read_b128 a[184:187], v43 offset:7168
    ds_read_b128 a[188:191], v43 offset:8192
    buffer_load_dwordx4 v2, s[40:43], s88 offen lds
    s_waitcnt lgkmcnt(0)
    v_mfma_f32_16x16x32_bf16 v[64:67], a[232:235], a[168:171], 0
    ds_read_b64 a[216:217], v23 offset:53248
    v_mfma_f32_16x16x32_bf16 v[68:71], a[232:235], a[172:175], 0
    ds_read_b64 a[218:219], v25 offset:53248
    v_mfma_f32_16x16x32_bf16 v[72:75], a[232:235], a[176:179], 0
    buffer_load_dwordx4 v3, s[40:43], s88 offen offset:1024 lds
    v_mfma_f32_16x16x32_bf16 v[64:67], a[236:239], a[180:183], v[64:67]
    ds_read_b64 a[220:221], v27 offset:53248
    v_mfma_f32_16x16x32_bf16 v[68:71], a[236:239], a[184:187], v[68:71]
    ds_read_b64 a[222:223], v29 offset:53248
    v_mfma_f32_16x16x32_bf16 v[72:75], a[236:239], a[188:191], v[72:75]
    buffer_load_dwordx4 v4, s[40:43], s88 offen offset:2048 lds
    v_mfma_f32_16x16x32_bf16 v[76:79], a[240:243], a[168:171], 0
    ds_read_b64 a[224:225], v23 offset:55296
    v_mfma_f32_16x16x32_bf16 v[80:83], a[240:243], a[172:175], 0
    ds_read_b64 a[226:227], v25 offset:55296
    v_mfma_f32_16x16x32_bf16 v[84:87], a[240:243], a[176:179], 0
    buffer_load_dwordx4 v5, s[40:43], s88 offen offset:3072 lds
    v_mfma_f32_16x16x32_bf16 v[76:79], a[244:247], a[180:183], v[76:79]
    ds_read_b64 a[228:229], v27 offset:55296
    s_add_u32 m0, s86, 32768
    v_mfma_f32_16x16x32_bf16 v[80:83], a[244:247], a[184:187], v[80:83]
    ds_read_b64 a[230:231], v29 offset:55296
    s_add_u32 s88, s62, s75
    v_mfma_f32_16x16x32_bf16 v[84:87], a[244:247], a[188:191], v[84:87]
    buffer_load_dwordx4 v2, s[40:43], s88 offen lds
    s_waitcnt lgkmcnt(6)
    s_barrier
    v_mfma_f32_16x16x32_bf16 v[88:91], a[216:219], a[168:171], 0
    ds_read_b64 a[232:233], v22 offset:0
    v_mfma_f32_16x16x32_bf16 v[92:95], a[216:219], a[172:175], 0
    ds_read_b64 a[234:235], v24 offset:0
    v_mfma_f32_16x16x32_bf16 v[96:99], a[216:219], a[176:179], 0
    buffer_load_dwordx4 v3, s[40:43], s88 offen offset:1024 lds
    s_waitcnt lgkmcnt(6)
    v_mfma_f32_16x16x32_bf16 v[88:91], a[220:223], a[180:183], v[88:91]
    ds_read_b64 a[236:237], v26 offset:0
    v_mfma_f32_16x16x32_bf16 v[92:95], a[220:223], a[184:187], v[92:95]
    ds_read_b64 a[238:239], v28 offset:0
    v_mfma_f32_16x16x32_bf16 v[96:99], a[220:223], a[188:191], v[96:99]
    buffer_load_dwordx4 v4, s[40:43], s88 offen offset:2048 lds
    s_waitcnt lgkmcnt(6)
    v_mfma_f32_16x16x32_bf16 v[100:103], a[224:227], a[168:171], 0
    ds_read_b64 a[240:241], v22 offset:2048
    v_mfma_f32_16x16x32_bf16 v[104:107], a[224:227], a[172:175], 0
    ds_read_b64 a[242:243], v24 offset:2048
    v_mfma_f32_16x16x32_bf16 v[108:111], a[224:227], a[176:179], 0
    buffer_load_dwordx4 v5, s[40:43], s88 offen offset:3072 lds
    s_waitcnt lgkmcnt(6)
    v_mfma_f32_16x16x32_bf16 v[100:103], a[228:231], a[180:183], v[100:103]
    ds_read_b64 a[244:245], v26 offset:2048
    s_add_u32 m0, s86, 49152
    v_mfma_f32_16x16x32_bf16 v[104:107], a[228:231], a[184:187], v[104:107]
    ds_read_b64 a[246:247], v28 offset:2048
    s_add_u32 s88, s63, s75
    v_mfma_f32_16x16x32_bf16 v[108:111], a[228:231], a[188:191], v[108:111]
    buffer_load_dwordx4 v2, s[40:43], s88 offen lds
    s_waitcnt lgkmcnt(6)
    v_mfma_f32_16x16x32_bf16 v[112:115], a[232:235], a[168:171], 0
    ds_read_b64 a[216:217], v22 offset:4096

    s_lshl_b32 s96, s90, 7
    v_mov_b32 v60, 0
    v_mov_b32 v61, 0
    v_mov_b32 v62, 0
    v_mov_b32 v63, 0
    s_mov_b64 s[98:99], exec
    s_mov_b64 exec, 1
    s_cmp_eq_u32 s87, 0
    s_cbranch_scc1 L_clrA1
    buffer_load_dword v53, v61, s[40:43], 0 offen
    s_branch L_clrB1
L_clrA1:
    buffer_store_dwordx4 v[60:63], v61, s[4:7], s96 offen sc1
L_clrB1:
    s_mov_b64 exec, s[98:99]

    v_mfma_f32_16x16x32_bf16 v[116:119], a[232:235], a[172:175], 0
    ds_read_b64 a[218:219], v24 offset:4096
    v_mfma_f32_16x16x32_bf16 v[120:123], a[232:235], a[176:179], 0
    buffer_load_dwordx4 v3, s[40:43], s88 offen offset:1024 lds
    s_waitcnt lgkmcnt(6)
    v_mfma_f32_16x16x32_bf16 v[112:115], a[236:239], a[180:183], v[112:115]
    ds_read_b64 a[220:221], v26 offset:4096
    v_mfma_f32_16x16x32_bf16 v[116:119], a[236:239], a[184:187], v[116:119]
    ds_read_b64 a[222:223], v28 offset:4096
    v_mfma_f32_16x16x32_bf16 v[120:123], a[236:239], a[188:191], v[120:123]
    buffer_load_dwordx4 v4, s[40:43], s88 offen offset:2048 lds
    s_waitcnt lgkmcnt(6)
    v_mfma_f32_16x16x32_bf16 v[124:127], a[240:243], a[168:171], 0
    ds_read_b64 a[224:225], v22 offset:6144
    v_mfma_f32_16x16x32_bf16 v[128:131], a[240:243], a[172:175], 0
    ds_read_b64 a[226:227], v24 offset:6144
    v_mfma_f32_16x16x32_bf16 v[132:135], a[240:243], a[176:179], 0
    buffer_load_dwordx4 v5, s[40:43], s88 offen offset:3072 lds
    s_waitcnt lgkmcnt(6)
    v_mfma_f32_16x16x32_bf16 v[124:127], a[244:247], a[180:183], v[124:127]
    ds_read_b64 a[228:229], v26 offset:6144
    v_mfma_f32_16x16x32_bf16 v[128:131], a[244:247], a[184:187], v[128:131]
    ds_read_b64 a[230:231], v28 offset:6144
    v_mfma_f32_16x16x32_bf16 v[132:135], a[244:247], a[188:191], v[132:135]
    s_waitcnt lgkmcnt(6)
    s_waitcnt vmcnt(17)
    s_barrier
    v_mfma_f32_16x16x32_bf16 v[136:139], a[216:219], a[168:171], 0
    ds_read_b64 a[232:233], v23 offset:16384
    s_add_u32 m0, s86, 114688
    v_mfma_f32_16x16x32_bf16 v[140:143], a[216:219], a[172:175], 0
    ds_read_b64 a[234:235], v25 offset:16384
    s_add_u32 s88, s82, s75
    v_mfma_f32_16x16x32_bf16 v[144:147], a[216:219], a[176:179], 0
    buffer_load_dwordx4 v6, s[44:47], s88 offen nt lds
    s_waitcnt lgkmcnt(6)
    v_mfma_f32_16x16x32_bf16 v[136:139], a[220:223], a[180:183], v[136:139]
    ds_read_b64 a[236:237], v27 offset:16384
    v_mfma_f32_16x16x32_bf16 v[140:143], a[220:223], a[184:187], v[140:143]
    ds_read_b64 a[238:239], v29 offset:16384
    v_mfma_f32_16x16x32_bf16 v[144:147], a[220:223], a[188:191], v[144:147]
    buffer_load_dwordx4 v7, s[44:47], s88 offen offset:1024 nt lds
    s_waitcnt lgkmcnt(6)
    v_mfma_f32_16x16x32_bf16 v[148:151], a[224:227], a[168:171], 0
    ds_read_b64 a[240:241], v23 offset:18432
    v_mfma_f32_16x16x32_bf16 v[152:155], a[224:227], a[172:175], 0
    ds_read_b64 a[242:243], v25 offset:18432
    v_mfma_f32_16x16x32_bf16 v[156:159], a[224:227], a[176:179], 0
    buffer_load_dwordx4 v8, s[44:47], s88 offen offset:2048 nt lds
    s_waitcnt lgkmcnt(6)
    v_mfma_f32_16x16x32_bf16 v[148:151], a[228:231], a[180:183], v[148:151]
    ds_read_b64 a[244:245], v27 offset:18432
    v_mfma_f32_16x16x32_bf16 v[152:155], a[228:231], a[184:187], v[152:155]
    ds_read_b64 a[246:247], v29 offset:18432
    v_mfma_f32_16x16x32_bf16 v[156:159], a[228:231], a[188:191], v[156:159]
    buffer_load_dwordx4 v9, s[44:47], s88 offen offset:3072 nt lds
    s_waitcnt lgkmcnt(6)
    v_mfma_f32_16x16x32_bf16 v[160:163], a[232:235], a[168:171], 0
    ds_read_b64 a[216:217], v23 offset:20480
    v_mfma_f32_16x16x32_bf16 v[164:167], a[232:235], a[172:175], 0
    ds_read_b64 a[218:219], v25 offset:20480
    v_mfma_f32_16x16x32_bf16 v[168:171], a[232:235], a[176:179], 0
    s_waitcnt lgkmcnt(6)
    v_mfma_f32_16x16x32_bf16 v[160:163], a[236:239], a[180:183], v[160:163]
    ds_read_b64 a[220:221], v27 offset:20480
    v_mfma_f32_16x16x32_bf16 v[164:167], a[236:239], a[184:187], v[164:167]
    ds_read_b64 a[222:223], v29 offset:20480
    v_mfma_f32_16x16x32_bf16 v[168:171], a[236:239], a[188:191], v[168:171]
    s_waitcnt lgkmcnt(6)
    v_mfma_f32_16x16x32_bf16 v[172:175], a[240:243], a[168:171], 0
    ds_read_b64 a[224:225], v23 offset:22528
    v_mfma_f32_16x16x32_bf16 v[176:179], a[240:243], a[172:175], 0
    ds_read_b64 a[226:227], v25 offset:22528
    v_mfma_f32_16x16x32_bf16 v[180:183], a[240:243], a[176:179], 0
    s_waitcnt lgkmcnt(6)
    v_mfma_f32_16x16x32_bf16 v[172:175], a[244:247], a[180:183], v[172:175]
    ds_read_b64 a[228:229], v27 offset:22528
    v_mfma_f32_16x16x32_bf16 v[176:179], a[244:247], a[184:187], v[176:179]
    ds_read_b64 a[230:231], v29 offset:22528
    v_mfma_f32_16x16x32_bf16 v[180:183], a[244:247], a[188:191], v[180:183]
    s_waitcnt lgkmcnt(6)
    s_barrier
    v_mfma_f32_16x16x32_bf16 v[184:187], a[216:219], a[168:171], 0
    ds_read_b64 a[232:233], v23 offset:0
    s_add_u32 m0, s86, 0
    v_mfma_f32_16x16x32_bf16 v[188:191], a[216:219], a[172:175], 0
    ds_read_b64 a[234:235], v25 offset:0
    s_add_u32 s88, s83, s75
    v_mfma_f32_16x16x32_bf16 v[192:195], a[216:219], a[176:179], 0
    buffer_load_dwordx4 v6, s[44:47], s88 offen nt lds
    s_waitcnt lgkmcnt(6)
    v_mfma_f32_16x16x32_bf16 v[184:187], a[220:223], a[180:183], v[184:187]
    ds_read_b64 a[236:237], v27 offset:0
    v_mfma_f32_16x16x32_bf16 v[188:191], a[220:223], a[184:187], v[188:191]
    ds_read_b64 a[238:239], v29 offset:0
    v_mfma_f32_16x16x32_bf16 v[192:195], a[220:223], a[188:191], v[192:195]
    buffer_load_dwordx4 v7, s[44:47], s88 offen offset:1024 nt lds
    s_waitcnt lgkmcnt(6)
    v_mfma_f32_16x16x32_bf16 v[196:199], a[224:227], a[168:171], 0
    ds_read_b64 a[240:241], v23 offset:2048
    v_mfma_f32_16x16x32_bf16 v[200:203], a[224:227], a[172:175], 0
    ds_read_b64 a[242:243], v25 offset:2048
    v_mfma_f32_16x16x32_bf16 v[204:207], a[224:227], a[176:179], 0
    buffer_load_dwordx4 v8, s[44:47], s88 offen offset:2048 nt lds
    s_waitcnt lgkmcnt(6)
    v_mfma_f32_16x16x32_bf16 v[196:199], a[228:231], a[180:183], v[196:199]
    ds_read_b64 a[244:245], v27 offset:2048
    v_mfma_f32_16x16x32_bf16 v[200:203], a[228:231], a[184:187], v[200:203]
    ds_read_b64 a[246:247], v29 offset:2048
    v_mfma_f32_16x16x32_bf16 v[204:207], a[228:231], a[188:191], v[204:207]
    buffer_load_dwordx4 v9, s[44:47], s88 offen offset:3072 nt lds
    s_waitcnt lgkmcnt(6)
    v_mfma_f32_16x16x32_bf16 v[208:211], a[232:235], a[168:171], 0
    ds_read_b64 a[216:217], v23 offset:4096
    v_mfma_f32_16x16x32_bf16 v[212:215], a[232:235], a[172:175], 0
    ds_read_b64 a[218:219], v25 offset:4096
    v_mfma_f32_16x16x32_bf16 v[216:219], a[232:235], a[176:179], 0
    s_waitcnt lgkmcnt(6)
    v_mfma_f32_16x16x32_bf16 v[208:211], a[236:239], a[180:183], v[208:211]
    ds_read_b64 a[220:221], v27 offset:4096
    v_mfma_f32_16x16x32_bf16 v[212:215], a[236:239], a[184:187], v[212:215]
    ds_read_b64 a[222:223], v29 offset:4096
    v_mfma_f32_16x16x32_bf16 v[216:219], a[236:239], a[188:191], v[216:219]
    s_waitcnt lgkmcnt(6)
    v_mfma_f32_16x16x32_bf16 v[220:223], a[240:243], a[168:171], 0
    ds_read_b64 a[224:225], v23 offset:6144
    v_mfma_f32_16x16x32_bf16 v[224:227], a[240:243], a[172:175], 0
    ds_read_b64 a[226:227], v25 offset:6144
    v_mfma_f32_16x16x32_bf16 v[228:231], a[240:243], a[176:179], 0
    s_waitcnt lgkmcnt(6)
    v_mfma_f32_16x16x32_bf16 v[220:223], a[244:247], a[180:183], v[220:223]
    ds_read_b64 a[228:229], v27 offset:6144
    v_mfma_f32_16x16x32_bf16 v[224:227], a[244:247], a[184:187], v[224:227]
    ds_read_b64 a[230:231], v29 offset:6144
    v_mfma_f32_16x16x32_bf16 v[228:231], a[244:247], a[188:191], v[228:231]
    s_waitcnt lgkmcnt(6)
    s_waitcnt vmcnt(21)
    s_barrier
    v_mfma_f32_16x16x32_bf16 v[232:235], a[216:219], a[168:171], 0
    ds_read_b64_tr_b16 a[232:233], v19 offset:32768
    s_add_u32 m0, s86, 81920
    v_mfma_f32_16x16x32_bf16 v[236:239], a[216:219], a[172:175], 0
    ds_read_b64_tr_b16 a[234:235], v19 offset:33792
    s_add_u32 s88, s64, s75
    v_mfma_f32_16x16x32_bf16 v[240:243], a[216:219], a[176:179], 0
    buffer_load_dwordx4 v2, s[40:43], s88 offen lds
    s_waitcnt lgkmcnt(6)
    v_mfma_f32_16x16x32_bf16 v[232:235], a[220:223], a[180:183], v[232:235]
    ds_read_b64_tr_b16 a[236:237], v21 offset:32768
    v_mfma_f32_16x16x32_bf16 v[236:239], a[220:223], a[184:187], v[236:239]
    ds_read_b64_tr_b16 a[238:239], v21 offset:33792
    v_mfma_f32_16x16x32_bf16 v[240:243], a[220:223], a[188:191], v[240:243]
    buffer_load_dwordx4 v3, s[40:43], s88 offen offset:1024 lds
    s_waitcnt lgkmcnt(6)
    v_mfma_f32_16x16x32_bf16 v[244:247], a[224:227], a[168:171], 0
    ds_read_b64_tr_b16 a[240:241], v19 offset:40960
    v_mfma_f32_16x16x32_bf16 v[248:251], a[224:227], a[172:175], 0
    ds_read_b64_tr_b16 a[242:243], v19 offset:41984
    v_mfma_f32_16x16x32_bf16 v[252:255], a[224:227], a[176:179], 0
    buffer_load_dwordx4 v4, s[40:43], s88 offen offset:2048 lds
    s_waitcnt lgkmcnt(6)
    v_mfma_f32_16x16x32_bf16 v[244:247], a[228:231], a[180:183], v[244:247]
    ds_read_b64_tr_b16 a[244:245], v21 offset:40960
    v_mfma_f32_16x16x32_bf16 v[248:251], a[228:231], a[184:187], v[248:251]
    ds_read_b64_tr_b16 a[246:247], v21 offset:41984
    v_mfma_f32_16x16x32_bf16 v[252:255], a[228:231], a[188:191], v[252:255]
    buffer_load_dwordx4 v5, s[40:43], s88 offen offset:3072 lds
    s_waitcnt lgkmcnt(6)
    s_waitcnt vmcnt(21)
    s_barrier
    v_mfma_f32_16x16x32_bf16 a[192:195], a[232:235], a[0:3], 0
    ds_read_b64_tr_b16 a[216:217], v18 offset:16384
    v_mfma_f32_16x16x32_bf16 a[196:199], a[232:235], a[4:7], 0
    ds_read_b64_tr_b16 a[218:219], v18 offset:17408
    v_mfma_f32_16x16x32_bf16 a[200:203], a[232:235], a[8:11], 0
    s_waitcnt lgkmcnt(6)
    v_mfma_f32_16x16x32_bf16 a[204:207], a[236:239], a[0:3], 0
    ds_read_b64_tr_b16 a[220:221], v20 offset:16384
    v_mfma_f32_16x16x32_bf16 a[208:211], a[236:239], a[4:7], 0
    ds_read_b64_tr_b16 a[222:223], v20 offset:17408
    v_mfma_f32_16x16x32_bf16 a[212:215], a[236:239], a[8:11], 0
    s_waitcnt lgkmcnt(6)
    v_mfma_f32_16x16x32_bf16 a[192:195], a[240:243], a[12:15], a[192:195]
    ds_read_b64_tr_b16 a[224:225], v18 offset:24576
    v_mfma_f32_16x16x32_bf16 a[196:199], a[240:243], a[16:19], a[196:199]
    ds_read_b64_tr_b16 a[226:227], v18 offset:25600
    v_mfma_f32_16x16x32_bf16 a[200:203], a[240:243], a[20:23], a[200:203]
    s_waitcnt lgkmcnt(6)
    v_mfma_f32_16x16x32_bf16 a[204:207], a[244:247], a[12:15], a[204:207]
    ds_read_b64_tr_b16 a[228:229], v20 offset:24576
    v_mfma_f32_16x16x32_bf16 a[208:211], a[244:247], a[16:19], a[208:211]
    ds_read_b64_tr_b16 a[230:231], v20 offset:25600
    v_mfma_f32_16x16x32_bf16 a[212:215], a[244:247], a[20:23], a[212:215]
    s_waitcnt lgkmcnt(6)
    s_waitcnt vmcnt(17)
    s_barrier
    v_mfma_f32_16x16x32_bf16 a[192:195], a[216:219], a[24:27], a[192:195]
    ds_read_b64_tr_b16 a[232:233], v18 offset:32768
    s_add_u32 m0, s86, 65536
    v_mfma_f32_16x16x32_bf16 a[196:199], a[216:219], a[28:31], a[196:199]
    ds_read_b64_tr_b16 a[234:235], v18 offset:33792
    s_add_u32 s88, s65, s75
    v_mfma_f32_16x16x32_bf16 a[200:203], a[216:219], a[32:35], a[200:203]
    buffer_load_dwordx4 v2, s[40:43], s88 offen lds
    s_waitcnt lgkmcnt(6)
    v_mfma_f32_16x16x32_bf16 a[204:207], a[220:223], a[24:27], a[204:207]
    ds_read_b64_tr_b16 a[236:237], v20 offset:32768
    v_mfma_f32_16x16x32_bf16 a[208:211], a[220:223], a[28:31], a[208:211]
    ds_read_b64_tr_b16 a[238:239], v20 offset:33792
    v_mfma_f32_16x16x32_bf16 a[212:215], a[220:223], a[32:35], a[212:215]
    buffer_load_dwordx4 v3, s[40:43], s88 offen offset:1024 lds
    s_waitcnt lgkmcnt(6)
    v_mfma_f32_16x16x32_bf16 a[192:195], a[224:227], a[36:39], a[192:195]
    ds_read_b64_tr_b16 a[240:241], v18 offset:40960
    v_mfma_f32_16x16x32_bf16 a[196:199], a[224:227], a[40:43], a[196:199]
    ds_read_b64_tr_b16 a[242:243], v18 offset:41984
    v_mfma_f32_16x16x32_bf16 a[200:203], a[224:227], a[44:47], a[200:203]
    buffer_load_dwordx4 v4, s[40:43], s88 offen offset:2048 lds
    s_waitcnt lgkmcnt(6)
    v_mfma_f32_16x16x32_bf16 a[204:207], a[228:231], a[36:39], a[204:207]
    ds_read_b64_tr_b16 a[244:245], v20 offset:40960
    v_mfma_f32_16x16x32_bf16 a[208:211], a[228:231], a[40:43], a[208:211]
    ds_read_b64_tr_b16 a[246:247], v20 offset:41984
    v_mfma_f32_16x16x32_bf16 a[212:215], a[228:231], a[44:47], a[212:215]
    buffer_load_dwordx4 v5, s[40:43], s88 offen offset:3072 lds
    s_waitcnt lgkmcnt(6)
    s_waitcnt vmcnt(16)
    s_barrier
    v_mfma_f32_16x16x32_bf16 a[192:195], a[232:235], a[48:51], a[192:195]
    ds_read_b64_tr_b16 a[216:217], v18 offset:49152
    s_add_u32 m0, s86, 98304
    v_mfma_f32_16x16x32_bf16 a[196:199], a[232:235], a[52:55], a[196:199]
    ds_read_b64_tr_b16 a[218:219], v18 offset:50176
    s_add_u32 s88, s66, s75
    v_mfma_f32_16x16x32_bf16 a[200:203], a[232:235], a[56:59], a[200:203]
    buffer_load_dwordx4 v2, s[40:43], s88 offen lds
    s_waitcnt lgkmcnt(6)
    v_mfma_f32_16x16x32_bf16 a[204:207], a[236:239], a[48:51], a[204:207]
    ds_read_b64_tr_b16 a[220:221], v20 offset:49152
    v_mfma_f32_16x16x32_bf16 a[208:211], a[236:239], a[52:55], a[208:211]
    ds_read_b64_tr_b16 a[222:223], v20 offset:50176
    v_mfma_f32_16x16x32_bf16 a[212:215], a[236:239], a[56:59], a[212:215]
    buffer_load_dwordx4 v3, s[40:43], s88 offen offset:1024 lds
    s_waitcnt lgkmcnt(6)
    v_mfma_f32_16x16x32_bf16 a[192:195], a[240:243], a[60:63], a[192:195]
    ds_read_b64_tr_b16 a[224:225], v18 offset:57344
    v_mfma_f32_16x16x32_bf16 a[196:199], a[240:243], a[64:67], a[196:199]
    ds_read_b64_tr_b16 a[226:227], v18 offset:58368
    v_mfma_f32_16x16x32_bf16 a[200:203], a[240:243], a[68:71], a[200:203]
    buffer_load_dwordx4 v4, s[40:43], s88 offen offset:2048 lds
    s_waitcnt lgkmcnt(6)
    v_mfma_f32_16x16x32_bf16 a[204:207], a[244:247], a[60:63], a[204:207]
    ds_read_b64_tr_b16 a[228:229], v20 offset:57344
    v_mfma_f32_16x16x32_bf16 a[208:211], a[244:247], a[64:67], a[208:211]
    ds_read_b64_tr_b16 a[230:231], v20 offset:58368
    v_mfma_f32_16x16x32_bf16 a[212:215], a[244:247], a[68:71], a[212:215]
    buffer_load_dwordx4 v5, s[40:43], s88 offen offset:3072 lds
    s_waitcnt lgkmcnt(6)
    s_waitcnt vmcnt(8)
    s_barrier
    v_mfma_f32_16x16x32_bf16 a[192:195], a[216:219], a[72:75], a[192:195]
    ds_read_b64_tr_b16 a[232:233], v19 offset:16384
    s_add_u32 m0, s86, 16384
    v_mfma_f32_16x16x32_bf16 a[196:199], a[216:219], a[76:79], a[196:199]
    ds_read_b64_tr_b16 a[234:235], v19 offset:17408
    s_add_u32 s88, s84, s75
    v_mfma_f32_16x16x32_bf16 a[200:203], a[216:219], a[80:83], a[200:203]
    buffer_load_dwordx4 v6, s[44:47], s88 offen nt lds
    s_waitcnt lgkmcnt(6)
    v_mfma_f32_16x16x32_bf16 a[204:207], a[220:223], a[72:75], a[204:207]
    ds_read_b64_tr_b16 a[236:237], v21 offset:16384
    v_mfma_f32_16x16x32_bf16 a[208:211], a[220:223], a[76:79], a[208:211]
    ds_read_b64_tr_b16 a[238:239], v21 offset:17408
    v_mfma_f32_16x16x32_bf16 a[212:215], a[220:223], a[80:83], a[212:215]
    buffer_load_dwordx4 v7, s[44:47], s88 offen offset:1024 nt lds
    s_waitcnt lgkmcnt(6)
    v_mfma_f32_16x16x32_bf16 a[192:195], a[224:227], a[84:87], a[192:195]
    ds_read_b64_tr_b16 a[240:241], v19 offset:24576
    v_mfma_f32_16x16x32_bf16 a[196:199], a[224:227], a[88:91], a[196:199]
    ds_read_b64_tr_b16 a[242:243], v19 offset:25600
    v_mfma_f32_16x16x32_bf16 a[200:203], a[224:227], a[92:95], a[200:203]
    buffer_load_dwordx4 v8, s[44:47], s88 offen offset:2048 nt lds
    s_waitcnt lgkmcnt(6)
    v_mfma_f32_16x16x32_bf16 a[204:207], a[228:231], a[84:87], a[204:207]
    ds_read_b64_tr_b16 a[244:245], v21 offset:24576
    v_mfma_f32_16x16x32_bf16 a[208:211], a[228:231], a[88:91], a[208:211]
    ds_read_b64_tr_b16 a[246:247], v21 offset:25600
    v_mfma_f32_16x16x32_bf16 a[212:215], a[228:231], a[92:95], a[212:215]
    buffer_load_dwordx4 v9, s[44:47], s88 offen offset:3072 nt lds
    s_waitcnt lgkmcnt(6)
    s_waitcnt vmcnt(8)
    s_barrier
    v_mfma_f32_16x16x32_bf16 a[192:195], a[232:235], a[96:99], a[192:195]
    ds_read_b64_tr_b16 a[216:217], v19 offset:0
    s_add_u32 m0, s86, 32768
    v_mfma_f32_16x16x32_bf16 a[196:199], a[232:235], a[100:103], a[196:199]
    ds_read_b64_tr_b16 a[218:219], v19 offset:1024
    s_add_u32 s88, s85, s75
    v_mfma_f32_16x16x32_bf16 a[200:203], a[232:235], a[104:107], a[200:203]
    buffer_load_dwordx4 v6, s[44:47], s88 offen nt lds
    s_waitcnt lgkmcnt(6)
    v_mfma_f32_16x16x32_bf16 a[204:207], a[236:239], a[96:99], a[204:207]
    ds_read_b64_tr_b16 a[220:221], v21 offset:0
    v_mfma_f32_16x16x32_bf16 a[208:211], a[236:239], a[100:103], a[208:211]
    ds_read_b64_tr_b16 a[222:223], v21 offset:1024
    v_mfma_f32_16x16x32_bf16 a[212:215], a[236:239], a[104:107], a[212:215]
    buffer_load_dwordx4 v7, s[44:47], s88 offen offset:1024 nt lds
    s_waitcnt lgkmcnt(6)
    v_mfma_f32_16x16x32_bf16 a[192:195], a[240:243], a[108:111], a[192:195]
    ds_read_b64_tr_b16 a[224:225], v19 offset:8192
    v_mfma_f32_16x16x32_bf16 a[196:199], a[240:243], a[112:115], a[196:199]
    ds_read_b64_tr_b16 a[226:227], v19 offset:9216
    v_mfma_f32_16x16x32_bf16 a[200:203], a[240:243], a[116:119], a[200:203]
    buffer_load_dwordx4 v8, s[44:47], s88 offen offset:2048 nt lds
    s_waitcnt lgkmcnt(6)
    v_mfma_f32_16x16x32_bf16 a[204:207], a[244:247], a[108:111], a[204:207]
    ds_read_b64_tr_b16 a[228:229], v21 offset:8192
    v_mfma_f32_16x16x32_bf16 a[208:211], a[244:247], a[112:115], a[208:211]
    ds_read_b64_tr_b16 a[230:231], v21 offset:9216
    v_mfma_f32_16x16x32_bf16 a[212:215], a[244:247], a[116:119], a[212:215]
    buffer_load_dwordx4 v9, s[44:47], s88 offen offset:3072 nt lds
    s_waitcnt lgkmcnt(6)
    s_waitcnt vmcnt(8)
    s_barrier
    v_mfma_f32_16x16x32_bf16 a[192:195], a[216:219], a[120:123], a[192:195]
    ds_read_b64_tr_b16 a[232:233], v19 offset:32768
    v_mfma_f32_16x16x32_bf16 a[196:199], a[216:219], a[124:127], a[196:199]
    ds_read_b64_tr_b16 a[234:235], v19 offset:33792
    v_mfma_f32_16x16x32_bf16 a[200:203], a[216:219], a[128:131], a[200:203]
    s_waitcnt lgkmcnt(6)
    v_mfma_f32_16x16x32_bf16 a[204:207], a[220:223], a[120:123], a[204:207]
    ds_read_b64_tr_b16 a[236:237], v21 offset:32768
    v_mfma_f32_16x16x32_bf16 a[208:211], a[220:223], a[124:127], a[208:211]
    ds_read_b64_tr_b16 a[238:239], v21 offset:33792
    v_mfma_f32_16x16x32_bf16 a[212:215], a[220:223], a[128:131], a[212:215]
    s_waitcnt lgkmcnt(6)
    v_mfma_f32_16x16x32_bf16 a[192:195], a[224:227], a[132:135], a[192:195]
    ds_read_b64_tr_b16 a[240:241], v19 offset:40960
    v_mfma_f32_16x16x32_bf16 a[196:199], a[224:227], a[136:139], a[196:199]
    ds_read_b64_tr_b16 a[242:243], v19 offset:41984
    v_mfma_f32_16x16x32_bf16 a[200:203], a[224:227], a[140:143], a[200:203]
    s_waitcnt lgkmcnt(6)
    v_mfma_f32_16x16x32_bf16 a[204:207], a[228:231], a[132:135], a[204:207]
    ds_read_b64_tr_b16 a[244:245], v21 offset:40960
    v_mfma_f32_16x16x32_bf16 a[208:211], a[228:231], a[136:139], a[208:211]
    ds_read_b64_tr_b16 a[246:247], v21 offset:41984
    v_mfma_f32_16x16x32_bf16 a[212:215], a[228:231], a[140:143], a[212:215]
    s_waitcnt lgkmcnt(6)
    s_barrier
    v_mfma_f32_16x16x32_bf16 a[192:195], a[232:235], a[144:147], a[192:195]
    ds_read_b64 a[216:217], v23 offset:49152
    v_mfma_f32_16x16x32_bf16 a[196:199], a[232:235], a[148:151], a[196:199]
    ds_read_b64 a[218:219], v25 offset:49152
    v_mfma_f32_16x16x32_bf16 a[200:203], a[232:235], a[152:155], a[200:203]
    s_waitcnt lgkmcnt(6)
    v_mfma_f32_16x16x32_bf16 a[204:207], a[236:239], a[144:147], a[204:207]
    ds_read_b64 a[220:221], v27 offset:49152
    v_mfma_f32_16x16x32_bf16 a[208:211], a[236:239], a[148:151], a[208:211]
    ds_read_b64 a[222:223], v29 offset:49152
    v_mfma_f32_16x16x32_bf16 a[212:215], a[236:239], a[152:155], a[212:215]
    s_waitcnt lgkmcnt(6)
    v_mfma_f32_16x16x32_bf16 a[192:195], a[240:243], a[156:159], a[192:195]
    ds_read_b64 a[224:225], v23 offset:51200
    v_mfma_f32_16x16x32_bf16 a[196:199], a[240:243], a[160:163], a[196:199]
    ds_read_b64 a[226:227], v25 offset:51200
    v_mfma_f32_16x16x32_bf16 a[200:203], a[240:243], a[164:167], a[200:203]
    s_waitcnt lgkmcnt(6)
    v_mfma_f32_16x16x32_bf16 a[204:207], a[244:247], a[156:159], a[204:207]
    ds_read_b64 a[228:229], v27 offset:51200
    v_mfma_f32_16x16x32_bf16 a[208:211], a[244:247], a[160:163], a[208:211]
    ds_read_b64 a[230:231], v29 offset:51200
    v_mfma_f32_16x16x32_bf16 a[212:215], a[244:247], a[164:167], a[212:215]
    v_accvgpr_read_b32 v44, a192
    s_add_u32 m0, s86, 49152
    s_add_u32 s88, s60, s76
    buffer_load_dwordx4 v2, s[40:43], s88 offen lds
    v_accvgpr_read_b32 v45, a193
    v_accvgpr_read_b32 v46, a194
    v_accvgpr_read_b32 v47, a195
    v_cvt_pk_bf16_f32 v56, v44, v45
    v_cvt_pk_bf16_f32 v57, v46, v47
    v_accvgpr_read_b32 v48, a204
    v_accvgpr_read_b32 v49, a205
    v_accvgpr_read_b32 v50, a206
    v_accvgpr_read_b32 v51, a207
    v_cvt_pk_bf16_f32 v58, v48, v49
    v_cvt_pk_bf16_f32 v59, v50, v51
    buffer_load_dwordx4 v3, s[40:43], s88 offen offset:1024 lds
    ds_write_b128 v40, v[56:59] offset:0
    v_accvgpr_read_b32 v44, a196
    v_accvgpr_read_b32 v45, a197
    v_accvgpr_read_b32 v46, a198
    v_accvgpr_read_b32 v47, a199
    v_cvt_pk_bf16_f32 v60, v44, v45
    v_cvt_pk_bf16_f32 v61, v46, v47
    v_accvgpr_read_b32 v48, a208
    v_accvgpr_read_b32 v49, a209
    v_accvgpr_read_b32 v50, a210
    v_accvgpr_read_b32 v51, a211
    buffer_load_dwordx4 v4, s[40:43], s88 offen offset:2048 lds
    v_cvt_pk_bf16_f32 v62, v48, v49
    v_cvt_pk_bf16_f32 v63, v50, v51
    ds_write_b128 v40, v[60:63] offset:1024
    v_accvgpr_read_b32 v44, a200
    v_accvgpr_read_b32 v45, a201
    v_accvgpr_read_b32 v46, a202
    v_accvgpr_read_b32 v47, a203
    v_cvt_pk_bf16_f32 v56, v44, v45
    v_cvt_pk_bf16_f32 v57, v46, v47
    v_accvgpr_read_b32 v48, a212
    v_accvgpr_read_b32 v49, a213
    buffer_load_dwordx4 v5, s[40:43], s88 offen offset:3072 lds
    s_add_u32 m0, s86, 81920
    s_add_u32 s88, s61, s76
    v_accvgpr_read_b32 v50, a214
    v_accvgpr_read_b32 v51, a215
    v_cvt_pk_bf16_f32 v58, v48, v49
    v_cvt_pk_bf16_f32 v59, v50, v51
    ds_write_b128 v40, v[56:59] offset:2048
    s_waitcnt lgkmcnt(0)
    s_barrier
    ds_read_b128 a[192:195], v43 offset:0
    ds_read_b128 a[196:199], v43 offset:1024
    ds_read_b128 a[200:203], v43 offset:2048
    ds_read_b128 a[204:207], v43 offset:6144
    ds_read_b128 a[208:211], v43 offset:7168
    ds_read_b128 a[212:215], v43 offset:8192
    buffer_load_dwordx4 v2, s[40:43], s88 offen lds
    s_waitcnt lgkmcnt(0)
    v_mfma_f32_16x16x32_bf16 v[64:67], a[216:219], a[192:195], v[64:67]
    ds_read_b64 a[232:233], v23 offset:53248
    v_mfma_f32_16x16x32_bf16 v[68:71], a[216:219], a[196:199], v[68:71]
    ds_read_b64 a[234:235], v25 offset:53248
    v_mfma_f32_16x16x32_bf16 v[72:75], a[216:219], a[200:203], v[72:75]
    buffer_load_dwordx4 v3, s[40:43], s88 offen offset:1024 lds
    v_mfma_f32_16x16x32_bf16 v[64:67], a[220:223], a[204:207], v[64:67]
    ds_read_b64 a[236:237], v27 offset:53248
    v_mfma_f32_16x16x32_bf16 v[68:71], a[220:223], a[208:211], v[68:71]
    ds_read_b64 a[238:239], v29 offset:53248
    v_mfma_f32_16x16x32_bf16 v[72:75], a[220:223], a[212:215], v[72:75]
    buffer_load_dwordx4 v4, s[40:43], s88 offen offset:2048 lds
    v_mfma_f32_16x16x32_bf16 v[76:79], a[224:227], a[192:195], v[76:79]
    ds_read_b64 a[240:241], v23 offset:55296
    v_mfma_f32_16x16x32_bf16 v[80:83], a[224:227], a[196:199], v[80:83]
    ds_read_b64 a[242:243], v25 offset:55296
    v_mfma_f32_16x16x32_bf16 v[84:87], a[224:227], a[200:203], v[84:87]
    buffer_load_dwordx4 v5, s[40:43], s88 offen offset:3072 lds
    v_mfma_f32_16x16x32_bf16 v[76:79], a[228:231], a[204:207], v[76:79]
    ds_read_b64 a[244:245], v27 offset:55296
    s_add_u32 m0, s86, 65536
    v_mfma_f32_16x16x32_bf16 v[80:83], a[228:231], a[208:211], v[80:83]
    ds_read_b64 a[246:247], v29 offset:55296
    s_add_u32 s88, s62, s76
    v_mfma_f32_16x16x32_bf16 v[84:87], a[228:231], a[212:215], v[84:87]
    buffer_load_dwordx4 v2, s[40:43], s88 offen lds
    s_waitcnt lgkmcnt(6)
    s_barrier
    v_mfma_f32_16x16x32_bf16 v[88:91], a[232:235], a[192:195], v[88:91]
    ds_read_b64 a[216:217], v22 offset:0
    v_mfma_f32_16x16x32_bf16 v[92:95], a[232:235], a[196:199], v[92:95]
    ds_read_b64 a[218:219], v24 offset:0
    v_mfma_f32_16x16x32_bf16 v[96:99], a[232:235], a[200:203], v[96:99]
    buffer_load_dwordx4 v3, s[40:43], s88 offen offset:1024 lds
    s_waitcnt lgkmcnt(6)
    v_mfma_f32_16x16x32_bf16 v[88:91], a[236:239], a[204:207], v[88:91]
    ds_read_b64 a[220:221], v26 offset:0
    v_mfma_f32_16x16x32_bf16 v[92:95], a[236:239], a[208:211], v[92:95]
    ds_read_b64 a[222:223], v28 offset:0
    v_mfma_f32_16x16x32_bf16 v[96:99], a[236:239], a[212:215], v[96:99]
    buffer_load_dwordx4 v4, s[40:43], s88 offen offset:2048 lds
    s_waitcnt lgkmcnt(6)
    v_mfma_f32_16x16x32_bf16 v[100:103], a[240:243], a[192:195], v[100:103]
    ds_read_b64 a[224:225], v22 offset:2048
    v_mfma_f32_16x16x32_bf16 v[104:107], a[240:243], a[196:199], v[104:107]
    ds_read_b64 a[226:227], v24 offset:2048
    v_mfma_f32_16x16x32_bf16 v[108:111], a[240:243], a[200:203], v[108:111]
    buffer_load_dwordx4 v5, s[40:43], s88 offen offset:3072 lds
    s_waitcnt lgkmcnt(6)
    v_mfma_f32_16x16x32_bf16 v[100:103], a[244:247], a[204:207], v[100:103]
    ds_read_b64 a[228:229], v26 offset:2048
    s_add_u32 m0, s86, 98304
    v_mfma_f32_16x16x32_bf16 v[104:107], a[244:247], a[208:211], v[104:107]
    ds_read_b64 a[230:231], v28 offset:2048
    s_add_u32 s88, s63, s76
    v_mfma_f32_16x16x32_bf16 v[108:111], a[244:247], a[212:215], v[108:111]
    buffer_load_dwordx4 v2, s[40:43], s88 offen lds
    s_waitcnt lgkmcnt(6)
    v_mfma_f32_16x16x32_bf16 v[112:115], a[216:219], a[192:195], v[112:115]
    ds_read_b64 a[232:233], v22 offset:4096
    v_mfma_f32_16x16x32_bf16 v[116:119], a[216:219], a[196:199], v[116:119]
    ds_read_b64 a[234:235], v24 offset:4096
    v_mfma_f32_16x16x32_bf16 v[120:123], a[216:219], a[200:203], v[120:123]
    buffer_load_dwordx4 v3, s[40:43], s88 offen offset:1024 lds
    s_waitcnt lgkmcnt(6)
    v_mfma_f32_16x16x32_bf16 v[112:115], a[220:223], a[204:207], v[112:115]
    ds_read_b64 a[236:237], v26 offset:4096
    v_mfma_f32_16x16x32_bf16 v[116:119], a[220:223], a[208:211], v[116:119]
    ds_read_b64 a[238:239], v28 offset:4096
    v_mfma_f32_16x16x32_bf16 v[120:123], a[220:223], a[212:215], v[120:123]
    buffer_load_dwordx4 v4, s[40:43], s88 offen offset:2048 lds
    s_waitcnt lgkmcnt(6)
    v_mfma_f32_16x16x32_bf16 v[124:127], a[224:227], a[192:195], v[124:127]
    ds_read_b64 a[240:241], v22 offset:6144
    v_mfma_f32_16x16x32_bf16 v[128:131], a[224:227], a[196:199], v[128:131]
    ds_read_b64 a[242:243], v24 offset:6144
    v_mfma_f32_16x16x32_bf16 v[132:135], a[224:227], a[200:203], v[132:135]
    buffer_load_dwordx4 v5, s[40:43], s88 offen offset:3072 lds
    s_waitcnt lgkmcnt(6)
    v_mfma_f32_16x16x32_bf16 v[124:127], a[228:231], a[204:207], v[124:127]
    ds_read_b64 a[244:245], v26 offset:6144
    v_mfma_f32_16x16x32_bf16 v[128:131], a[228:231], a[208:211], v[128:131]
    ds_read_b64 a[246:247], v28 offset:6144
    v_mfma_f32_16x16x32_bf16 v[132:135], a[228:231], a[212:215], v[132:135]
    s_waitcnt lgkmcnt(6)
    s_waitcnt vmcnt(20)
    s_barrier
    v_mfma_f32_16x16x32_bf16 v[136:139], a[232:235], a[192:195], v[136:139]
    ds_read_b64 a[216:217], v22 offset:16384
    s_add_u32 m0, s86, 114688
    v_mfma_f32_16x16x32_bf16 v[140:143], a[232:235], a[196:199], v[140:143]
    ds_read_b64 a[218:219], v24 offset:16384
    s_add_u32 s88, s82, s76
    v_mfma_f32_16x16x32_bf16 v[144:147], a[232:235], a[200:203], v[144:147]
    buffer_load_dwordx4 v6, s[44:47], s88 offen nt lds
    s_waitcnt lgkmcnt(6)
    v_mfma_f32_16x16x32_bf16 v[136:139], a[236:239], a[204:207], v[136:139]
    ds_read_b64 a[220:221], v26 offset:16384
    v_mfma_f32_16x16x32_bf16 v[140:143], a[236:239], a[208:211], v[140:143]
    ds_read_b64 a[222:223], v28 offset:16384
    v_mfma_f32_16x16x32_bf16 v[144:147], a[236:239], a[212:215], v[144:147]
    buffer_load_dwordx4 v7, s[44:47], s88 offen offset:1024 nt lds
    s_waitcnt lgkmcnt(6)
    v_mfma_f32_16x16x32_bf16 v[148:151], a[240:243], a[192:195], v[148:151]
    ds_read_b64 a[224:225], v22 offset:18432
    v_mfma_f32_16x16x32_bf16 v[152:155], a[240:243], a[196:199], v[152:155]
    ds_read_b64 a[226:227], v24 offset:18432
    v_mfma_f32_16x16x32_bf16 v[156:159], a[240:243], a[200:203], v[156:159]
    buffer_load_dwordx4 v8, s[44:47], s88 offen offset:2048 nt lds
    s_waitcnt lgkmcnt(6)
    v_mfma_f32_16x16x32_bf16 v[148:151], a[244:247], a[204:207], v[148:151]
    ds_read_b64 a[228:229], v26 offset:18432
    v_mfma_f32_16x16x32_bf16 v[152:155], a[244:247], a[208:211], v[152:155]
    ds_read_b64 a[230:231], v28 offset:18432
    v_mfma_f32_16x16x32_bf16 v[156:159], a[244:247], a[212:215], v[156:159]
    buffer_load_dwordx4 v9, s[44:47], s88 offen offset:3072 nt lds
    s_waitcnt lgkmcnt(6)
    v_mfma_f32_16x16x32_bf16 v[160:163], a[216:219], a[192:195], v[160:163]
    ds_read_b64 a[232:233], v22 offset:20480
    v_mfma_f32_16x16x32_bf16 v[164:167], a[216:219], a[196:199], v[164:167]
    ds_read_b64 a[234:235], v24 offset:20480
    v_mfma_f32_16x16x32_bf16 v[168:171], a[216:219], a[200:203], v[168:171]
    s_waitcnt lgkmcnt(6)
    v_mfma_f32_16x16x32_bf16 v[160:163], a[220:223], a[204:207], v[160:163]
    ds_read_b64 a[236:237], v26 offset:20480
    v_mfma_f32_16x16x32_bf16 v[164:167], a[220:223], a[208:211], v[164:167]
    ds_read_b64 a[238:239], v28 offset:20480
    v_mfma_f32_16x16x32_bf16 v[168:171], a[220:223], a[212:215], v[168:171]
    s_waitcnt lgkmcnt(6)
    v_mfma_f32_16x16x32_bf16 v[172:175], a[224:227], a[192:195], v[172:175]
    ds_read_b64 a[240:241], v22 offset:22528
    v_mfma_f32_16x16x32_bf16 v[176:179], a[224:227], a[196:199], v[176:179]
    ds_read_b64 a[242:243], v24 offset:22528
    v_mfma_f32_16x16x32_bf16 v[180:183], a[224:227], a[200:203], v[180:183]
    s_waitcnt lgkmcnt(6)
    v_mfma_f32_16x16x32_bf16 v[172:175], a[228:231], a[204:207], v[172:175]
    ds_read_b64 a[244:245], v26 offset:22528
    v_mfma_f32_16x16x32_bf16 v[176:179], a[228:231], a[208:211], v[176:179]
    ds_read_b64 a[246:247], v28 offset:22528
    v_mfma_f32_16x16x32_bf16 v[180:183], a[228:231], a[212:215], v[180:183]
    s_waitcnt lgkmcnt(6)
    s_waitcnt vmcnt(20)
    s_barrier
    v_mfma_f32_16x16x32_bf16 v[184:187], a[232:235], a[192:195], v[184:187]
    ds_read_b64 a[216:217], v22 offset:32768
    s_add_u32 m0, s86, 0
    v_mfma_f32_16x16x32_bf16 v[188:191], a[232:235], a[196:199], v[188:191]
    ds_read_b64 a[218:219], v24 offset:32768
    s_add_u32 s88, s83, s76
    v_mfma_f32_16x16x32_bf16 v[192:195], a[232:235], a[200:203], v[192:195]
    buffer_load_dwordx4 v6, s[44:47], s88 offen nt lds
    s_waitcnt lgkmcnt(6)
    v_mfma_f32_16x16x32_bf16 v[184:187], a[236:239], a[204:207], v[184:187]
    ds_read_b64 a[220:221], v26 offset:32768
    v_mfma_f32_16x16x32_bf16 v[188:191], a[236:239], a[208:211], v[188:191]
    ds_read_b64 a[222:223], v28 offset:32768
    v_mfma_f32_16x16x32_bf16 v[192:195], a[236:239], a[212:215], v[192:195]
    buffer_load_dwordx4 v7, s[44:47], s88 offen offset:1024 nt lds
    s_waitcnt lgkmcnt(6)
    v_mfma_f32_16x16x32_bf16 v[196:199], a[240:243], a[192:195], v[196:199]
    ds_read_b64 a[224:225], v22 offset:34816
    v_mfma_f32_16x16x32_bf16 v[200:203], a[240:243], a[196:199], v[200:203]
    ds_read_b64 a[226:227], v24 offset:34816
    v_mfma_f32_16x16x32_bf16 v[204:207], a[240:243], a[200:203], v[204:207]
    buffer_load_dwordx4 v8, s[44:47], s88 offen offset:2048 nt lds
    s_waitcnt lgkmcnt(6)
    v_mfma_f32_16x16x32_bf16 v[196:199], a[244:247], a[204:207], v[196:199]
    ds_read_b64 a[228:229], v26 offset:34816
    v_mfma_f32_16x16x32_bf16 v[200:203], a[244:247], a[208:211], v[200:203]
    ds_read_b64 a[230:231], v28 offset:34816
    v_mfma_f32_16x16x32_bf16 v[204:207], a[244:247], a[212:215], v[204:207]
    buffer_load_dwordx4 v9, s[44:47], s88 offen offset:3072 nt lds
    s_waitcnt lgkmcnt(6)
    v_mfma_f32_16x16x32_bf16 v[208:211], a[216:219], a[192:195], v[208:211]
    ds_read_b64 a[232:233], v22 offset:36864
    v_mfma_f32_16x16x32_bf16 v[212:215], a[216:219], a[196:199], v[212:215]
    ds_read_b64 a[234:235], v24 offset:36864
    v_mfma_f32_16x16x32_bf16 v[216:219], a[216:219], a[200:203], v[216:219]
    s_waitcnt lgkmcnt(6)
    v_mfma_f32_16x16x32_bf16 v[208:211], a[220:223], a[204:207], v[208:211]
    ds_read_b64 a[236:237], v26 offset:36864
    v_mfma_f32_16x16x32_bf16 v[212:215], a[220:223], a[208:211], v[212:215]
    ds_read_b64 a[238:239], v28 offset:36864
    v_mfma_f32_16x16x32_bf16 v[216:219], a[220:223], a[212:215], v[216:219]
    s_waitcnt lgkmcnt(6)
    v_mfma_f32_16x16x32_bf16 v[220:223], a[224:227], a[192:195], v[220:223]
    ds_read_b64 a[240:241], v22 offset:38912
    v_mfma_f32_16x16x32_bf16 v[224:227], a[224:227], a[196:199], v[224:227]
    ds_read_b64 a[242:243], v24 offset:38912
    v_mfma_f32_16x16x32_bf16 v[228:231], a[224:227], a[200:203], v[228:231]
    s_waitcnt lgkmcnt(6)
    v_mfma_f32_16x16x32_bf16 v[220:223], a[228:231], a[204:207], v[220:223]
    ds_read_b64 a[244:245], v26 offset:38912
    v_mfma_f32_16x16x32_bf16 v[224:227], a[228:231], a[208:211], v[224:227]
    ds_read_b64 a[246:247], v28 offset:38912
    v_mfma_f32_16x16x32_bf16 v[228:231], a[228:231], a[212:215], v[228:231]
    s_waitcnt lgkmcnt(6)
    s_waitcnt vmcnt(20)
    s_barrier
    v_mfma_f32_16x16x32_bf16 v[232:235], a[232:235], a[192:195], v[232:235]
    ds_read_b64_tr_b16 a[216:217], v18 offset:49152
    s_add_u32 m0, s86, 16384
    v_mfma_f32_16x16x32_bf16 v[236:239], a[232:235], a[196:199], v[236:239]
    ds_read_b64_tr_b16 a[218:219], v18 offset:50176
    s_add_u32 s88, s64, s76
    v_mfma_f32_16x16x32_bf16 v[240:243], a[232:235], a[200:203], v[240:243]
    buffer_load_dwordx4 v2, s[40:43], s88 offen lds
    s_waitcnt lgkmcnt(6)
    v_mfma_f32_16x16x32_bf16 v[232:235], a[236:239], a[204:207], v[232:235]
    ds_read_b64_tr_b16 a[220:221], v20 offset:49152
    v_mfma_f32_16x16x32_bf16 v[236:239], a[236:239], a[208:211], v[236:239]
    ds_read_b64_tr_b16 a[222:223], v20 offset:50176
    v_mfma_f32_16x16x32_bf16 v[240:243], a[236:239], a[212:215], v[240:243]
    buffer_load_dwordx4 v3, s[40:43], s88 offen offset:1024 lds
    s_waitcnt lgkmcnt(6)
    v_mfma_f32_16x16x32_bf16 v[244:247], a[240:243], a[192:195], v[244:247]
    ds_read_b64_tr_b16 a[224:225], v18 offset:57344
    v_mfma_f32_16x16x32_bf16 v[248:251], a[240:243], a[196:199], v[248:251]
    ds_read_b64_tr_b16 a[226:227], v18 offset:58368
    v_mfma_f32_16x16x32_bf16 v[252:255], a[240:243], a[200:203], v[252:255]
    buffer_load_dwordx4 v4, s[40:43], s88 offen offset:2048 lds
    s_waitcnt lgkmcnt(6)
    v_mfma_f32_16x16x32_bf16 v[244:247], a[244:247], a[204:207], v[244:247]
    ds_read_b64_tr_b16 a[228:229], v20 offset:57344
    v_mfma_f32_16x16x32_bf16 v[248:251], a[244:247], a[208:211], v[248:251]
    ds_read_b64_tr_b16 a[230:231], v20 offset:58368
    v_mfma_f32_16x16x32_bf16 v[252:255], a[244:247], a[212:215], v[252:255]
    buffer_load_dwordx4 v5, s[40:43], s88 offen offset:3072 lds
    s_waitcnt lgkmcnt(6)
    s_waitcnt vmcnt(20)
    s_barrier
    v_mfma_f32_16x16x32_bf16 a[168:171], a[216:219], a[0:3], 0
    ds_read_b64_tr_b16 a[232:233], v19 offset:16384
    v_mfma_f32_16x16x32_bf16 a[172:175], a[216:219], a[4:7], 0
    ds_read_b64_tr_b16 a[234:235], v19 offset:17408
    v_mfma_f32_16x16x32_bf16 a[176:179], a[216:219], a[8:11], 0
    s_waitcnt lgkmcnt(6)
    v_mfma_f32_16x16x32_bf16 a[180:183], a[220:223], a[0:3], 0
    ds_read_b64_tr_b16 a[236:237], v21 offset:16384
    v_mfma_f32_16x16x32_bf16 a[184:187], a[220:223], a[4:7], 0
    ds_read_b64_tr_b16 a[238:239], v21 offset:17408
    v_mfma_f32_16x16x32_bf16 a[188:191], a[220:223], a[8:11], 0
    s_waitcnt lgkmcnt(6)
    v_mfma_f32_16x16x32_bf16 a[168:171], a[224:227], a[12:15], a[168:171]
    ds_read_b64_tr_b16 a[240:241], v19 offset:24576
    v_mfma_f32_16x16x32_bf16 a[172:175], a[224:227], a[16:19], a[172:175]
    ds_read_b64_tr_b16 a[242:243], v19 offset:25600
    v_mfma_f32_16x16x32_bf16 a[176:179], a[224:227], a[20:23], a[176:179]
    s_waitcnt lgkmcnt(6)
    v_mfma_f32_16x16x32_bf16 a[180:183], a[228:231], a[12:15], a[180:183]
    ds_read_b64_tr_b16 a[244:245], v21 offset:24576
    v_mfma_f32_16x16x32_bf16 a[184:187], a[228:231], a[16:19], a[184:187]
    ds_read_b64_tr_b16 a[246:247], v21 offset:25600
    v_mfma_f32_16x16x32_bf16 a[188:191], a[228:231], a[20:23], a[188:191]
    s_waitcnt lgkmcnt(6)
    s_waitcnt vmcnt(16)
    s_barrier
    v_mfma_f32_16x16x32_bf16 a[168:171], a[232:235], a[24:27], a[168:171]
    ds_read_b64_tr_b16 a[216:217], v19 offset:0
    s_add_u32 m0, s86, 32768
    v_mfma_f32_16x16x32_bf16 a[172:175], a[232:235], a[28:31], a[172:175]
    ds_read_b64_tr_b16 a[218:219], v19 offset:1024
    s_add_u32 s88, s65, s76
    v_mfma_f32_16x16x32_bf16 a[176:179], a[232:235], a[32:35], a[176:179]
    buffer_load_dwordx4 v2, s[40:43], s88 offen lds
    s_waitcnt lgkmcnt(6)
    v_mfma_f32_16x16x32_bf16 a[180:183], a[236:239], a[24:27], a[180:183]
    ds_read_b64_tr_b16 a[220:221], v21 offset:0
    v_mfma_f32_16x16x32_bf16 a[184:187], a[236:239], a[28:31], a[184:187]
    ds_read_b64_tr_b16 a[222:223], v21 offset:1024
    v_mfma_f32_16x16x32_bf16 a[188:191], a[236:239], a[32:35], a[188:191]
    buffer_load_dwordx4 v3, s[40:43], s88 offen offset:1024 lds
    s_waitcnt lgkmcnt(6)
    v_mfma_f32_16x16x32_bf16 a[168:171], a[240:243], a[36:39], a[168:171]
    ds_read_b64_tr_b16 a[224:225], v19 offset:8192
    v_mfma_f32_16x16x32_bf16 a[172:175], a[240:243], a[40:43], a[172:175]
    ds_read_b64_tr_b16 a[226:227], v19 offset:9216
    v_mfma_f32_16x16x32_bf16 a[176:179], a[240:243], a[44:47], a[176:179]
    buffer_load_dwordx4 v4, s[40:43], s88 offen offset:2048 lds
    s_waitcnt lgkmcnt(6)
    v_mfma_f32_16x16x32_bf16 a[180:183], a[244:247], a[36:39], a[180:183]
    ds_read_b64_tr_b16 a[228:229], v21 offset:8192
    v_mfma_f32_16x16x32_bf16 a[184:187], a[244:247], a[40:43], a[184:187]
    ds_read_b64_tr_b16 a[230:231], v21 offset:9216
    v_mfma_f32_16x16x32_bf16 a[188:191], a[244:247], a[44:47], a[188:191]
    buffer_load_dwordx4 v5, s[40:43], s88 offen offset:3072 lds
    s_waitcnt lgkmcnt(6)
    s_waitcnt vmcnt(16)
    s_barrier
    v_mfma_f32_16x16x32_bf16 a[168:171], a[216:219], a[48:51], a[168:171]
    ds_read_b64_tr_b16 a[232:233], v19 offset:32768
    s_add_u32 m0, s86, 49152
    v_mfma_f32_16x16x32_bf16 a[172:175], a[216:219], a[52:55], a[172:175]
    ds_read_b64_tr_b16 a[234:235], v19 offset:33792
    s_add_u32 s88, s66, s76
    v_mfma_f32_16x16x32_bf16 a[176:179], a[216:219], a[56:59], a[176:179]
    buffer_load_dwordx4 v2, s[40:43], s88 offen lds
    s_waitcnt lgkmcnt(6)
    v_mfma_f32_16x16x32_bf16 a[180:183], a[220:223], a[48:51], a[180:183]
    ds_read_b64_tr_b16 a[236:237], v21 offset:32768
    v_mfma_f32_16x16x32_bf16 a[184:187], a[220:223], a[52:55], a[184:187]
    ds_read_b64_tr_b16 a[238:239], v21 offset:33792
    v_mfma_f32_16x16x32_bf16 a[188:191], a[220:223], a[56:59], a[188:191]
    buffer_load_dwordx4 v3, s[40:43], s88 offen offset:1024 lds
    s_waitcnt lgkmcnt(6)
    v_mfma_f32_16x16x32_bf16 a[168:171], a[224:227], a[60:63], a[168:171]
    ds_read_b64_tr_b16 a[240:241], v19 offset:40960
    v_mfma_f32_16x16x32_bf16 a[172:175], a[224:227], a[64:67], a[172:175]
    ds_read_b64_tr_b16 a[242:243], v19 offset:41984
    v_mfma_f32_16x16x32_bf16 a[176:179], a[224:227], a[68:71], a[176:179]
    buffer_load_dwordx4 v4, s[40:43], s88 offen offset:2048 lds
    s_waitcnt lgkmcnt(6)
    v_mfma_f32_16x16x32_bf16 a[180:183], a[228:231], a[60:63], a[180:183]
    ds_read_b64_tr_b16 a[244:245], v21 offset:40960
    v_mfma_f32_16x16x32_bf16 a[184:187], a[228:231], a[64:67], a[184:187]
    ds_read_b64_tr_b16 a[246:247], v21 offset:41984
    v_mfma_f32_16x16x32_bf16 a[188:191], a[228:231], a[68:71], a[188:191]
    buffer_load_dwordx4 v5, s[40:43], s88 offen offset:3072 lds
    s_waitcnt lgkmcnt(6)
    s_waitcnt vmcnt(8)
    s_barrier
    v_mfma_f32_16x16x32_bf16 a[168:171], a[232:235], a[72:75], a[168:171]
    ds_read_b64_tr_b16 a[216:217], v18 offset:16384
    s_add_u32 m0, s86, 81920
    v_mfma_f32_16x16x32_bf16 a[172:175], a[232:235], a[76:79], a[172:175]
    ds_read_b64_tr_b16 a[218:219], v18 offset:17408
    s_add_u32 s88, s84, s76
    v_mfma_f32_16x16x32_bf16 a[176:179], a[232:235], a[80:83], a[176:179]
    buffer_load_dwordx4 v6, s[44:47], s88 offen nt lds
    s_waitcnt lgkmcnt(6)
    v_mfma_f32_16x16x32_bf16 a[180:183], a[236:239], a[72:75], a[180:183]
    ds_read_b64_tr_b16 a[220:221], v20 offset:16384
    v_mfma_f32_16x16x32_bf16 a[184:187], a[236:239], a[76:79], a[184:187]
    ds_read_b64_tr_b16 a[222:223], v20 offset:17408
    v_mfma_f32_16x16x32_bf16 a[188:191], a[236:239], a[80:83], a[188:191]
    buffer_load_dwordx4 v7, s[44:47], s88 offen offset:1024 nt lds
    s_waitcnt lgkmcnt(6)
    v_mfma_f32_16x16x32_bf16 a[168:171], a[240:243], a[84:87], a[168:171]
    ds_read_b64_tr_b16 a[224:225], v18 offset:24576
    v_mfma_f32_16x16x32_bf16 a[172:175], a[240:243], a[88:91], a[172:175]
    ds_read_b64_tr_b16 a[226:227], v18 offset:25600
    v_mfma_f32_16x16x32_bf16 a[176:179], a[240:243], a[92:95], a[176:179]
    buffer_load_dwordx4 v8, s[44:47], s88 offen offset:2048 nt lds
    s_waitcnt lgkmcnt(6)
    v_mfma_f32_16x16x32_bf16 a[180:183], a[244:247], a[84:87], a[180:183]
    ds_read_b64_tr_b16 a[228:229], v20 offset:24576
    v_mfma_f32_16x16x32_bf16 a[184:187], a[244:247], a[88:91], a[184:187]
    ds_read_b64_tr_b16 a[230:231], v20 offset:25600
    v_mfma_f32_16x16x32_bf16 a[188:191], a[244:247], a[92:95], a[188:191]
    buffer_load_dwordx4 v9, s[44:47], s88 offen offset:3072 nt lds
    s_waitcnt lgkmcnt(6)
    s_waitcnt vmcnt(8)
    s_barrier
    v_mfma_f32_16x16x32_bf16 a[168:171], a[216:219], a[96:99], a[168:171]
    ds_read_b64_tr_b16 a[232:233], v18 offset:32768
    s_add_u32 m0, s86, 65536
    v_mfma_f32_16x16x32_bf16 a[172:175], a[216:219], a[100:103], a[172:175]
    ds_read_b64_tr_b16 a[234:235], v18 offset:33792
    s_add_u32 s88, s85, s76
    v_mfma_f32_16x16x32_bf16 a[176:179], a[216:219], a[104:107], a[176:179]
    buffer_load_dwordx4 v6, s[44:47], s88 offen nt lds
    s_waitcnt lgkmcnt(6)
    v_mfma_f32_16x16x32_bf16 a[180:183], a[220:223], a[96:99], a[180:183]
    ds_read_b64_tr_b16 a[236:237], v20 offset:32768
    v_mfma_f32_16x16x32_bf16 a[184:187], a[220:223], a[100:103], a[184:187]
    ds_read_b64_tr_b16 a[238:239], v20 offset:33792
    v_mfma_f32_16x16x32_bf16 a[188:191], a[220:223], a[104:107], a[188:191]
    buffer_load_dwordx4 v7, s[44:47], s88 offen offset:1024 nt lds
    s_waitcnt lgkmcnt(6)
    v_mfma_f32_16x16x32_bf16 a[168:171], a[224:227], a[108:111], a[168:171]
    ds_read_b64_tr_b16 a[240:241], v18 offset:40960
    v_mfma_f32_16x16x32_bf16 a[172:175], a[224:227], a[112:115], a[172:175]
    ds_read_b64_tr_b16 a[242:243], v18 offset:41984
    v_mfma_f32_16x16x32_bf16 a[176:179], a[224:227], a[116:119], a[176:179]
    buffer_load_dwordx4 v8, s[44:47], s88 offen offset:2048 nt lds
    s_waitcnt lgkmcnt(6)
    v_mfma_f32_16x16x32_bf16 a[180:183], a[228:231], a[108:111], a[180:183]
    ds_read_b64_tr_b16 a[244:245], v20 offset:40960
    v_mfma_f32_16x16x32_bf16 a[184:187], a[228:231], a[112:115], a[184:187]
    ds_read_b64_tr_b16 a[246:247], v20 offset:41984
    v_mfma_f32_16x16x32_bf16 a[188:191], a[228:231], a[116:119], a[188:191]
    buffer_load_dwordx4 v9, s[44:47], s88 offen offset:3072 nt lds
    s_waitcnt lgkmcnt(6)
    s_waitcnt vmcnt(8)
    s_barrier
    v_mfma_f32_16x16x32_bf16 a[168:171], a[232:235], a[120:123], a[168:171]
    ds_read_b64_tr_b16 a[216:217], v18 offset:49152
    v_mfma_f32_16x16x32_bf16 a[172:175], a[232:235], a[124:127], a[172:175]
    ds_read_b64_tr_b16 a[218:219], v18 offset:50176
    v_mfma_f32_16x16x32_bf16 a[176:179], a[232:235], a[128:131], a[176:179]
    s_waitcnt lgkmcnt(6)
    v_mfma_f32_16x16x32_bf16 a[180:183], a[236:239], a[120:123], a[180:183]
    ds_read_b64_tr_b16 a[220:221], v20 offset:49152
    v_mfma_f32_16x16x32_bf16 a[184:187], a[236:239], a[124:127], a[184:187]
    ds_read_b64_tr_b16 a[222:223], v20 offset:50176
    v_mfma_f32_16x16x32_bf16 a[188:191], a[236:239], a[128:131], a[188:191]
    s_waitcnt lgkmcnt(6)
    v_mfma_f32_16x16x32_bf16 a[168:171], a[240:243], a[132:135], a[168:171]
    ds_read_b64_tr_b16 a[224:225], v18 offset:57344
    v_mfma_f32_16x16x32_bf16 a[172:175], a[240:243], a[136:139], a[172:175]
    ds_read_b64_tr_b16 a[226:227], v18 offset:58368
    v_mfma_f32_16x16x32_bf16 a[176:179], a[240:243], a[140:143], a[176:179]
    s_waitcnt lgkmcnt(6)
    v_mfma_f32_16x16x32_bf16 a[180:183], a[244:247], a[132:135], a[180:183]
    ds_read_b64_tr_b16 a[228:229], v20 offset:57344
    v_mfma_f32_16x16x32_bf16 a[184:187], a[244:247], a[136:139], a[184:187]
    ds_read_b64_tr_b16 a[230:231], v20 offset:58368
    v_mfma_f32_16x16x32_bf16 a[188:191], a[244:247], a[140:143], a[188:191]
    s_waitcnt lgkmcnt(6)
    s_barrier
    v_mfma_f32_16x16x32_bf16 a[168:171], a[216:219], a[144:147], a[168:171]
    ds_read_b64 a[232:233], v23 offset:49152
    v_mfma_f32_16x16x32_bf16 a[172:175], a[216:219], a[148:151], a[172:175]
    ds_read_b64 a[234:235], v25 offset:49152
    v_mfma_f32_16x16x32_bf16 a[176:179], a[216:219], a[152:155], a[176:179]
    s_waitcnt lgkmcnt(6)
    v_mfma_f32_16x16x32_bf16 a[180:183], a[220:223], a[144:147], a[180:183]
    ds_read_b64 a[236:237], v27 offset:49152
    v_mfma_f32_16x16x32_bf16 a[184:187], a[220:223], a[148:151], a[184:187]
    ds_read_b64 a[238:239], v29 offset:49152
    v_mfma_f32_16x16x32_bf16 a[188:191], a[220:223], a[152:155], a[188:191]
    s_waitcnt lgkmcnt(6)
    v_mfma_f32_16x16x32_bf16 a[168:171], a[224:227], a[156:159], a[168:171]
    ds_read_b64 a[240:241], v23 offset:51200
    v_mfma_f32_16x16x32_bf16 a[172:175], a[224:227], a[160:163], a[172:175]
    ds_read_b64 a[242:243], v25 offset:51200
    v_mfma_f32_16x16x32_bf16 a[176:179], a[224:227], a[164:167], a[176:179]
    s_waitcnt lgkmcnt(6)
    v_mfma_f32_16x16x32_bf16 a[180:183], a[228:231], a[156:159], a[180:183]
    ds_read_b64 a[244:245], v27 offset:51200
    v_mfma_f32_16x16x32_bf16 a[184:187], a[228:231], a[160:163], a[184:187]
    ds_read_b64 a[246:247], v29 offset:51200
    v_mfma_f32_16x16x32_bf16 a[188:191], a[228:231], a[164:167], a[188:191]
    v_accvgpr_read_b32 v44, a168
    s_add_u32 m0, s86, 98304
    s_add_u32 s88, s60, s77
    buffer_load_dwordx4 v2, s[40:43], s88 offen lds
    v_accvgpr_read_b32 v45, a169
    v_accvgpr_read_b32 v46, a170
    v_accvgpr_read_b32 v47, a171
    v_cvt_pk_bf16_f32 v56, v44, v45
    v_cvt_pk_bf16_f32 v57, v46, v47
    v_accvgpr_read_b32 v48, a180
    v_accvgpr_read_b32 v49, a181
    v_accvgpr_read_b32 v50, a182
    v_accvgpr_read_b32 v51, a183
    v_cvt_pk_bf16_f32 v58, v48, v49
    v_cvt_pk_bf16_f32 v59, v50, v51
    buffer_load_dwordx4 v3, s[40:43], s88 offen offset:1024 lds
    ds_write_b128 v40, v[56:59] offset:0
    v_accvgpr_read_b32 v44, a172
    v_accvgpr_read_b32 v45, a173
    v_accvgpr_read_b32 v46, a174
    v_accvgpr_read_b32 v47, a175
    v_cvt_pk_bf16_f32 v60, v44, v45
    v_cvt_pk_bf16_f32 v61, v46, v47
    v_accvgpr_read_b32 v48, a184
    v_accvgpr_read_b32 v49, a185
    v_accvgpr_read_b32 v50, a186
    v_accvgpr_read_b32 v51, a187
    buffer_load_dwordx4 v4, s[40:43], s88 offen offset:2048 lds
    v_cvt_pk_bf16_f32 v62, v48, v49
    v_cvt_pk_bf16_f32 v63, v50, v51
    ds_write_b128 v40, v[60:63] offset:1024
    v_accvgpr_read_b32 v44, a176
    v_accvgpr_read_b32 v45, a177
    v_accvgpr_read_b32 v46, a178
    v_accvgpr_read_b32 v47, a179
    v_cvt_pk_bf16_f32 v56, v44, v45
    v_cvt_pk_bf16_f32 v57, v46, v47
    v_accvgpr_read_b32 v48, a188
    v_accvgpr_read_b32 v49, a189
    buffer_load_dwordx4 v5, s[40:43], s88 offen offset:3072 lds
    v_accvgpr_read_b32 v50, a190
    v_accvgpr_read_b32 v51, a191
    v_cvt_pk_bf16_f32 v58, v48, v49
    v_cvt_pk_bf16_f32 v59, v50, v51
    ds_write_b128 v40, v[56:59] offset:2048
    s_waitcnt lgkmcnt(0)
    s_barrier
    ds_read_b128 a[168:171], v43 offset:0
    ds_read_b128 a[172:175], v43 offset:1024
    ds_read_b128 a[176:179], v43 offset:2048
    ds_read_b128 a[180:183], v43 offset:6144
    ds_read_b128 a[184:187], v43 offset:7168
    ds_read_b128 a[188:191], v43 offset:8192
    s_waitcnt lgkmcnt(0)
    v_mfma_f32_16x16x32_bf16 v[64:67], a[232:235], a[168:171], v[64:67]
    ds_read_b64 a[216:217], v23 offset:53248
    s_add_u32 m0, s86, 16384
    v_mfma_f32_16x16x32_bf16 v[68:71], a[232:235], a[172:175], v[68:71]
    ds_read_b64 a[218:219], v25 offset:53248
    s_add_u32 s88, s63, s77
    v_mfma_f32_16x16x32_bf16 v[72:75], a[232:235], a[176:179], v[72:75]
    buffer_load_dwordx4 v2, s[40:43], s88 offen lds
    v_mfma_f32_16x16x32_bf16 v[64:67], a[236:239], a[180:183], v[64:67]
    ds_read_b64 a[220:221], v27 offset:53248
    v_mfma_f32_16x16x32_bf16 v[68:71], a[236:239], a[184:187], v[68:71]
    ds_read_b64 a[222:223], v29 offset:53248
    v_mfma_f32_16x16x32_bf16 v[72:75], a[236:239], a[188:191], v[72:75]
    buffer_load_dwordx4 v3, s[40:43], s88 offen offset:1024 lds
    v_mfma_f32_16x16x32_bf16 v[76:79], a[240:243], a[168:171], v[76:79]
    ds_read_b64 a[224:225], v23 offset:55296
    v_mfma_f32_16x16x32_bf16 v[80:83], a[240:243], a[172:175], v[80:83]
    ds_read_b64 a[226:227], v25 offset:55296
    v_mfma_f32_16x16x32_bf16 v[84:87], a[240:243], a[176:179], v[84:87]
    buffer_load_dwordx4 v4, s[40:43], s88 offen offset:2048 lds
    v_mfma_f32_16x16x32_bf16 v[76:79], a[244:247], a[180:183], v[76:79]
    ds_read_b64 a[228:229], v27 offset:55296
    v_mfma_f32_16x16x32_bf16 v[80:83], a[244:247], a[184:187], v[80:83]
    ds_read_b64 a[230:231], v29 offset:55296
    v_mfma_f32_16x16x32_bf16 v[84:87], a[244:247], a[188:191], v[84:87]
    buffer_load_dwordx4 v5, s[40:43], s88 offen offset:3072 lds
    s_waitcnt lgkmcnt(6)
    s_barrier
    v_mfma_f32_16x16x32_bf16 v[88:91], a[216:219], a[168:171], v[88:91]
    ds_read_b64 a[232:233], v22 offset:0
    v_mfma_f32_16x16x32_bf16 v[92:95], a[216:219], a[172:175], v[92:95]
    ds_read_b64 a[234:235], v24 offset:0
    v_mfma_f32_16x16x32_bf16 v[96:99], a[216:219], a[176:179], v[96:99]
    s_waitcnt lgkmcnt(6)
    v_mfma_f32_16x16x32_bf16 v[88:91], a[220:223], a[180:183], v[88:91]
    ds_read_b64 a[236:237], v26 offset:0
    v_mfma_f32_16x16x32_bf16 v[92:95], a[220:223], a[184:187], v[92:95]
    ds_read_b64 a[238:239], v28 offset:0
    v_mfma_f32_16x16x32_bf16 v[96:99], a[220:223], a[188:191], v[96:99]
    s_waitcnt lgkmcnt(6)
    v_mfma_f32_16x16x32_bf16 v[100:103], a[224:227], a[168:171], v[100:103]
    ds_read_b64 a[240:241], v22 offset:2048
    v_mfma_f32_16x16x32_bf16 v[104:107], a[224:227], a[172:175], v[104:107]
    ds_read_b64 a[242:243], v24 offset:2048
    v_mfma_f32_16x16x32_bf16 v[108:111], a[224:227], a[176:179], v[108:111]
    s_waitcnt lgkmcnt(6)
    v_mfma_f32_16x16x32_bf16 v[100:103], a[228:231], a[180:183], v[100:103]
    ds_read_b64 a[244:245], v26 offset:2048
    v_mfma_f32_16x16x32_bf16 v[104:107], a[228:231], a[184:187], v[104:107]
    ds_read_b64 a[246:247], v28 offset:2048
    v_mfma_f32_16x16x32_bf16 v[108:111], a[228:231], a[188:191], v[108:111]
    s_waitcnt lgkmcnt(6)
    v_mfma_f32_16x16x32_bf16 v[112:115], a[232:235], a[168:171], v[112:115]
    ds_read_b64 a[216:217], v22 offset:4096
    s_add_u32 m0, s86, 32768
    v_mfma_f32_16x16x32_bf16 v[116:119], a[232:235], a[172:175], v[116:119]
    ds_read_b64 a[218:219], v24 offset:4096
    s_add_u32 s88, s61, s77
    v_mfma_f32_16x16x32_bf16 v[120:123], a[232:235], a[176:179], v[120:123]
    buffer_load_dwordx4 v2, s[40:43], s88 offen lds
    s_waitcnt lgkmcnt(6)
    v_mfma_f32_16x16x32_bf16 v[112:115], a[236:239], a[180:183], v[112:115]
    ds_read_b64 a[220:221], v26 offset:4096
    v_mfma_f32_16x16x32_bf16 v[116:119], a[236:239], a[184:187], v[116:119]
    ds_read_b64 a[222:223], v28 offset:4096
    v_mfma_f32_16x16x32_bf16 v[120:123], a[236:239], a[188:191], v[120:123]
    buffer_load_dwordx4 v3, s[40:43], s88 offen offset:1024 lds
    s_waitcnt lgkmcnt(6)
    v_mfma_f32_16x16x32_bf16 v[124:127], a[240:243], a[168:171], v[124:127]
    ds_read_b64 a[224:225], v22 offset:6144
    v_mfma_f32_16x16x32_bf16 v[128:131], a[240:243], a[172:175], v[128:131]
    ds_read_b64 a[226:227], v24 offset:6144
    v_mfma_f32_16x16x32_bf16 v[132:135], a[240:243], a[176:179], v[132:135]
    buffer_load_dwordx4 v4, s[40:43], s88 offen offset:2048 lds
    s_waitcnt lgkmcnt(6)
    v_mfma_f32_16x16x32_bf16 v[124:127], a[244:247], a[180:183], v[124:127]
    ds_read_b64 a[228:229], v26 offset:6144
    v_mfma_f32_16x16x32_bf16 v[128:131], a[244:247], a[184:187], v[128:131]
    ds_read_b64 a[230:231], v28 offset:6144
    v_mfma_f32_16x16x32_bf16 v[132:135], a[244:247], a[188:191], v[132:135]
    buffer_load_dwordx4 v5, s[40:43], s88 offen offset:3072 lds
    s_waitcnt lgkmcnt(6)
    s_waitcnt vmcnt(16)
    s_barrier
    v_mfma_f32_16x16x32_bf16 v[136:139], a[216:219], a[168:171], v[136:139]
    ds_read_b64 a[232:233], v23 offset:16384
    s_add_u32 m0, s86, 49152
    v_mfma_f32_16x16x32_bf16 v[140:143], a[216:219], a[172:175], v[140:143]
    ds_read_b64 a[234:235], v25 offset:16384
    s_add_u32 s88, s62, s77
    v_mfma_f32_16x16x32_bf16 v[144:147], a[216:219], a[176:179], v[144:147]
    buffer_load_dwordx4 v2, s[40:43], s88 offen lds
    s_waitcnt lgkmcnt(6)
    v_mfma_f32_16x16x32_bf16 v[136:139], a[220:223], a[180:183], v[136:139]
    ds_read_b64 a[236:237], v27 offset:16384
    v_mfma_f32_16x16x32_bf16 v[140:143], a[220:223], a[184:187], v[140:143]
    ds_read_b64 a[238:239], v29 offset:16384
    v_mfma_f32_16x16x32_bf16 v[144:147], a[220:223], a[188:191], v[144:147]
    buffer_load_dwordx4 v3, s[40:43], s88 offen offset:1024 lds
    s_waitcnt lgkmcnt(6)
    v_mfma_f32_16x16x32_bf16 v[148:151], a[224:227], a[168:171], v[148:151]
    ds_read_b64 a[240:241], v23 offset:18432
    v_mfma_f32_16x16x32_bf16 v[152:155], a[224:227], a[172:175], v[152:155]
    ds_read_b64 a[242:243], v25 offset:18432
    v_mfma_f32_16x16x32_bf16 v[156:159], a[224:227], a[176:179], v[156:159]
    buffer_load_dwordx4 v4, s[40:43], s88 offen offset:2048 lds
    s_waitcnt lgkmcnt(6)
    v_mfma_f32_16x16x32_bf16 v[148:151], a[228:231], a[180:183], v[148:151]
    ds_read_b64 a[244:245], v27 offset:18432
    v_mfma_f32_16x16x32_bf16 v[152:155], a[228:231], a[184:187], v[152:155]
    ds_read_b64 a[246:247], v29 offset:18432
    v_mfma_f32_16x16x32_bf16 v[156:159], a[228:231], a[188:191], v[156:159]
    buffer_load_dwordx4 v5, s[40:43], s88 offen offset:3072 lds
    s_waitcnt lgkmcnt(6)
    v_mfma_f32_16x16x32_bf16 v[160:163], a[232:235], a[168:171], v[160:163]
    ds_read_b64 a[216:217], v23 offset:20480
    s_add_u32 m0, s86, 114688
    v_mfma_f32_16x16x32_bf16 v[164:167], a[232:235], a[172:175], v[164:167]
    ds_read_b64 a[218:219], v25 offset:20480
    s_add_u32 s88, s82, s77
    v_mfma_f32_16x16x32_bf16 v[168:171], a[232:235], a[176:179], v[168:171]
    buffer_load_dwordx4 v6, s[44:47], s88 offen nt lds
    s_waitcnt lgkmcnt(6)
    v_mfma_f32_16x16x32_bf16 v[160:163], a[236:239], a[180:183], v[160:163]
    ds_read_b64 a[220:221], v27 offset:20480
    v_mfma_f32_16x16x32_bf16 v[164:167], a[236:239], a[184:187], v[164:167]
    ds_read_b64 a[222:223], v29 offset:20480
    v_mfma_f32_16x16x32_bf16 v[168:171], a[236:239], a[188:191], v[168:171]
    buffer_load_dwordx4 v7, s[44:47], s88 offen offset:1024 nt lds
    s_waitcnt lgkmcnt(6)
    v_mfma_f32_16x16x32_bf16 v[172:175], a[240:243], a[168:171], v[172:175]
    ds_read_b64 a[224:225], v23 offset:22528
    v_mfma_f32_16x16x32_bf16 v[176:179], a[240:243], a[172:175], v[176:179]
    ds_read_b64 a[226:227], v25 offset:22528
    v_mfma_f32_16x16x32_bf16 v[180:183], a[240:243], a[176:179], v[180:183]
    buffer_load_dwordx4 v8, s[44:47], s88 offen offset:2048 nt lds
    s_waitcnt lgkmcnt(6)
    v_mfma_f32_16x16x32_bf16 v[172:175], a[244:247], a[180:183], v[172:175]
    ds_read_b64 a[228:229], v27 offset:22528
    v_mfma_f32_16x16x32_bf16 v[176:179], a[244:247], a[184:187], v[176:179]
    ds_read_b64 a[230:231], v29 offset:22528
    v_mfma_f32_16x16x32_bf16 v[180:183], a[244:247], a[188:191], v[180:183]
    buffer_load_dwordx4 v9, s[44:47], s88 offen offset:3072 nt lds
    s_waitcnt lgkmcnt(6)
    s_waitcnt vmcnt(20)
    s_barrier
    v_mfma_f32_16x16x32_bf16 v[184:187], a[216:219], a[168:171], v[184:187]
    ds_read_b64 a[232:233], v23 offset:0
    s_add_u32 m0, s86, 0
    v_mfma_f32_16x16x32_bf16 v[188:191], a[216:219], a[172:175], v[188:191]
    ds_read_b64 a[234:235], v25 offset:0
    s_add_u32 s88, s83, s77
    v_mfma_f32_16x16x32_bf16 v[192:195], a[216:219], a[176:179], v[192:195]
    buffer_load_dwordx4 v6, s[44:47], s88 offen nt lds
    s_waitcnt lgkmcnt(6)
    v_mfma_f32_16x16x32_bf16 v[184:187], a[220:223], a[180:183], v[184:187]
    ds_read_b64 a[236:237], v27 offset:0
    v_mfma_f32_16x16x32_bf16 v[188:191], a[220:223], a[184:187], v[188:191]
    ds_read_b64 a[238:239], v29 offset:0
    v_mfma_f32_16x16x32_bf16 v[192:195], a[220:223], a[188:191], v[192:195]
    buffer_load_dwordx4 v7, s[44:47], s88 offen offset:1024 nt lds
    s_waitcnt lgkmcnt(6)
    v_mfma_f32_16x16x32_bf16 v[196:199], a[224:227], a[168:171], v[196:199]
    ds_read_b64 a[240:241], v23 offset:2048
    v_mfma_f32_16x16x32_bf16 v[200:203], a[224:227], a[172:175], v[200:203]
    ds_read_b64 a[242:243], v25 offset:2048
    v_mfma_f32_16x16x32_bf16 v[204:207], a[224:227], a[176:179], v[204:207]
    buffer_load_dwordx4 v8, s[44:47], s88 offen offset:2048 nt lds
    s_waitcnt lgkmcnt(6)
    v_mfma_f32_16x16x32_bf16 v[196:199], a[228:231], a[180:183], v[196:199]
    ds_read_b64 a[244:245], v27 offset:2048
    v_mfma_f32_16x16x32_bf16 v[200:203], a[228:231], a[184:187], v[200:203]
    ds_read_b64 a[246:247], v29 offset:2048
    v_mfma_f32_16x16x32_bf16 v[204:207], a[228:231], a[188:191], v[204:207]
    buffer_load_dwordx4 v9, s[44:47], s88 offen offset:3072 nt lds
    s_waitcnt lgkmcnt(6)
    v_mfma_f32_16x16x32_bf16 v[208:211], a[232:235], a[168:171], v[208:211]
    ds_read_b64 a[216:217], v23 offset:4096
    v_mfma_f32_16x16x32_bf16 v[212:215], a[232:235], a[172:175], v[212:215]
    ds_read_b64 a[218:219], v25 offset:4096
    v_mfma_f32_16x16x32_bf16 v[216:219], a[232:235], a[176:179], v[216:219]
    s_waitcnt lgkmcnt(6)
    v_mfma_f32_16x16x32_bf16 v[208:211], a[236:239], a[180:183], v[208:211]
    ds_read_b64 a[220:221], v27 offset:4096
    v_mfma_f32_16x16x32_bf16 v[212:215], a[236:239], a[184:187], v[212:215]
    ds_read_b64 a[222:223], v29 offset:4096
    v_mfma_f32_16x16x32_bf16 v[216:219], a[236:239], a[188:191], v[216:219]
    s_waitcnt lgkmcnt(6)
    v_mfma_f32_16x16x32_bf16 v[220:223], a[240:243], a[168:171], v[220:223]
    ds_read_b64 a[224:225], v23 offset:6144
    v_mfma_f32_16x16x32_bf16 v[224:227], a[240:243], a[172:175], v[224:227]
    ds_read_b64 a[226:227], v25 offset:6144
    v_mfma_f32_16x16x32_bf16 v[228:231], a[240:243], a[176:179], v[228:231]
    s_waitcnt lgkmcnt(6)
    v_mfma_f32_16x16x32_bf16 v[220:223], a[244:247], a[180:183], v[220:223]
    ds_read_b64 a[228:229], v27 offset:6144
    v_mfma_f32_16x16x32_bf16 v[224:227], a[244:247], a[184:187], v[224:227]
    ds_read_b64 a[230:231], v29 offset:6144
    v_mfma_f32_16x16x32_bf16 v[228:231], a[244:247], a[188:191], v[228:231]
    s_waitcnt lgkmcnt(6)
    s_waitcnt vmcnt(20)
    s_barrier
    v_mfma_f32_16x16x32_bf16 v[232:235], a[216:219], a[168:171], v[232:235]
    ds_read_b64_tr_b16 a[232:233], v19 offset:32768
    s_add_u32 m0, s86, 81920
    v_mfma_f32_16x16x32_bf16 v[236:239], a[216:219], a[172:175], v[236:239]
    ds_read_b64_tr_b16 a[234:235], v19 offset:33792
    s_add_u32 s88, s64, s77
    v_mfma_f32_16x16x32_bf16 v[240:243], a[216:219], a[176:179], v[240:243]
    buffer_load_dwordx4 v2, s[40:43], s88 offen lds
    s_waitcnt lgkmcnt(6)
    v_mfma_f32_16x16x32_bf16 v[232:235], a[220:223], a[180:183], v[232:235]
    ds_read_b64_tr_b16 a[236:237], v21 offset:32768
    v_mfma_f32_16x16x32_bf16 v[236:239], a[220:223], a[184:187], v[236:239]
    ds_read_b64_tr_b16 a[238:239], v21 offset:33792
    v_mfma_f32_16x16x32_bf16 v[240:243], a[220:223], a[188:191], v[240:243]
    buffer_load_dwordx4 v3, s[40:43], s88 offen offset:1024 lds
    s_waitcnt lgkmcnt(6)
    v_mfma_f32_16x16x32_bf16 v[244:247], a[224:227], a[168:171], v[244:247]
    ds_read_b64_tr_b16 a[240:241], v19 offset:40960
    v_mfma_f32_16x16x32_bf16 v[248:251], a[224:227], a[172:175], v[248:251]
    ds_read_b64_tr_b16 a[242:243], v19 offset:41984
    v_mfma_f32_16x16x32_bf16 v[252:255], a[224:227], a[176:179], v[252:255]
    buffer_load_dwordx4 v4, s[40:43], s88 offen offset:2048 lds
    s_waitcnt lgkmcnt(6)
    v_mfma_f32_16x16x32_bf16 v[244:247], a[228:231], a[180:183], v[244:247]
    ds_read_b64_tr_b16 a[244:245], v21 offset:40960
    v_mfma_f32_16x16x32_bf16 v[248:251], a[228:231], a[184:187], v[248:251]
    ds_read_b64_tr_b16 a[246:247], v21 offset:41984
    v_mfma_f32_16x16x32_bf16 v[252:255], a[228:231], a[188:191], v[252:255]
    buffer_load_dwordx4 v5, s[40:43], s88 offen offset:3072 lds
    s_waitcnt lgkmcnt(6)
    s_waitcnt vmcnt(16)
    s_barrier
    v_mfma_f32_16x16x32_bf16 a[192:195], a[232:235], a[0:3], 0
    ds_read_b64_tr_b16 a[216:217], v18 offset:32768
    v_mfma_f32_16x16x32_bf16 a[196:199], a[232:235], a[4:7], 0
    ds_read_b64_tr_b16 a[218:219], v18 offset:33792
    v_mfma_f32_16x16x32_bf16 a[200:203], a[232:235], a[8:11], 0
    s_waitcnt lgkmcnt(6)
    v_mfma_f32_16x16x32_bf16 a[204:207], a[236:239], a[0:3], 0
    ds_read_b64_tr_b16 a[220:221], v20 offset:32768
    v_mfma_f32_16x16x32_bf16 a[208:211], a[236:239], a[4:7], 0
    ds_read_b64_tr_b16 a[222:223], v20 offset:33792
    v_mfma_f32_16x16x32_bf16 a[212:215], a[236:239], a[8:11], 0
    s_waitcnt lgkmcnt(6)
    v_mfma_f32_16x16x32_bf16 a[192:195], a[240:243], a[12:15], a[192:195]
    ds_read_b64_tr_b16 a[224:225], v18 offset:40960
    v_mfma_f32_16x16x32_bf16 a[196:199], a[240:243], a[16:19], a[196:199]
    ds_read_b64_tr_b16 a[226:227], v18 offset:41984
    v_mfma_f32_16x16x32_bf16 a[200:203], a[240:243], a[20:23], a[200:203]
    s_waitcnt lgkmcnt(6)
    v_mfma_f32_16x16x32_bf16 a[204:207], a[244:247], a[12:15], a[204:207]
    ds_read_b64_tr_b16 a[228:229], v20 offset:40960
    v_mfma_f32_16x16x32_bf16 a[208:211], a[244:247], a[16:19], a[208:211]
    ds_read_b64_tr_b16 a[230:231], v20 offset:41984
    v_mfma_f32_16x16x32_bf16 a[212:215], a[244:247], a[20:23], a[212:215]
    s_waitcnt lgkmcnt(6)
    s_waitcnt vmcnt(12)
    s_barrier
    v_mfma_f32_16x16x32_bf16 a[192:195], a[216:219], a[24:27], a[192:195]
    ds_read_b64_tr_b16 a[232:233], v18 offset:49152
    s_add_u32 m0, s86, 65536
    v_mfma_f32_16x16x32_bf16 a[196:199], a[216:219], a[28:31], a[196:199]
    ds_read_b64_tr_b16 a[234:235], v18 offset:50176
    s_add_u32 s88, s65, s77
    v_mfma_f32_16x16x32_bf16 a[200:203], a[216:219], a[32:35], a[200:203]
    buffer_load_dwordx4 v2, s[40:43], s88 offen lds
    s_waitcnt lgkmcnt(6)
    v_mfma_f32_16x16x32_bf16 a[204:207], a[220:223], a[24:27], a[204:207]
    ds_read_b64_tr_b16 a[236:237], v20 offset:49152
    v_mfma_f32_16x16x32_bf16 a[208:211], a[220:223], a[28:31], a[208:211]
    ds_read_b64_tr_b16 a[238:239], v20 offset:50176
    v_mfma_f32_16x16x32_bf16 a[212:215], a[220:223], a[32:35], a[212:215]
    buffer_load_dwordx4 v3, s[40:43], s88 offen offset:1024 lds
    s_waitcnt lgkmcnt(6)
    v_mfma_f32_16x16x32_bf16 a[192:195], a[224:227], a[36:39], a[192:195]
    ds_read_b64_tr_b16 a[240:241], v18 offset:57344
    v_mfma_f32_16x16x32_bf16 a[196:199], a[224:227], a[40:43], a[196:199]
    ds_read_b64_tr_b16 a[242:243], v18 offset:58368
    v_mfma_f32_16x16x32_bf16 a[200:203], a[224:227], a[44:47], a[200:203]
    buffer_load_dwordx4 v4, s[40:43], s88 offen offset:2048 lds
    s_waitcnt lgkmcnt(6)
    v_mfma_f32_16x16x32_bf16 a[204:207], a[228:231], a[36:39], a[204:207]
    ds_read_b64_tr_b16 a[244:245], v20 offset:57344
    v_mfma_f32_16x16x32_bf16 a[208:211], a[228:231], a[40:43], a[208:211]
    ds_read_b64_tr_b16 a[246:247], v20 offset:58368
    v_mfma_f32_16x16x32_bf16 a[212:215], a[228:231], a[44:47], a[212:215]
    buffer_load_dwordx4 v5, s[40:43], s88 offen offset:3072 lds
    s_waitcnt lgkmcnt(6)
    s_barrier
    v_mfma_f32_16x16x32_bf16 a[192:195], a[232:235], a[48:51], a[192:195]
    ds_read_b64_tr_b16 a[216:217], v18 offset:16384
    s_add_u32 m0, s86, 98304
    v_mfma_f32_16x16x32_bf16 a[196:199], a[232:235], a[52:55], a[196:199]
    ds_read_b64_tr_b16 a[218:219], v18 offset:17408
    s_add_u32 s88, s66, s77
    v_mfma_f32_16x16x32_bf16 a[200:203], a[232:235], a[56:59], a[200:203]
    buffer_load_dwordx4 v2, s[40:43], s88 offen lds
    s_waitcnt lgkmcnt(6)
    v_mfma_f32_16x16x32_bf16 a[204:207], a[236:239], a[48:51], a[204:207]
    ds_read_b64_tr_b16 a[220:221], v20 offset:16384
    v_mfma_f32_16x16x32_bf16 a[208:211], a[236:239], a[52:55], a[208:211]
    ds_read_b64_tr_b16 a[222:223], v20 offset:17408
    v_mfma_f32_16x16x32_bf16 a[212:215], a[236:239], a[56:59], a[212:215]
    buffer_load_dwordx4 v3, s[40:43], s88 offen offset:1024 lds
    s_waitcnt lgkmcnt(6)
    v_mfma_f32_16x16x32_bf16 a[192:195], a[240:243], a[60:63], a[192:195]
    ds_read_b64_tr_b16 a[224:225], v18 offset:24576
    v_mfma_f32_16x16x32_bf16 a[196:199], a[240:243], a[64:67], a[196:199]
    ds_read_b64_tr_b16 a[226:227], v18 offset:25600
    v_mfma_f32_16x16x32_bf16 a[200:203], a[240:243], a[68:71], a[200:203]
    buffer_load_dwordx4 v4, s[40:43], s88 offen offset:2048 lds
    s_waitcnt lgkmcnt(6)
    v_mfma_f32_16x16x32_bf16 a[204:207], a[244:247], a[60:63], a[204:207]
    ds_read_b64_tr_b16 a[228:229], v20 offset:24576
    v_mfma_f32_16x16x32_bf16 a[208:211], a[244:247], a[64:67], a[208:211]
    ds_read_b64_tr_b16 a[230:231], v20 offset:25600
    v_mfma_f32_16x16x32_bf16 a[212:215], a[244:247], a[68:71], a[212:215]
    buffer_load_dwordx4 v5, s[40:43], s88 offen offset:3072 lds
    s_waitcnt lgkmcnt(6)
    s_waitcnt vmcnt(8)
    s_barrier
    v_mfma_f32_16x16x32_bf16 a[192:195], a[216:219], a[72:75], a[192:195]
    ds_read_b64_tr_b16 a[232:233], v19 offset:16384
    s_add_u32 m0, s86, 32768
    v_mfma_f32_16x16x32_bf16 a[196:199], a[216:219], a[76:79], a[196:199]
    ds_read_b64_tr_b16 a[234:235], v19 offset:17408
    s_add_u32 s88, s84, s77
    v_mfma_f32_16x16x32_bf16 a[200:203], a[216:219], a[80:83], a[200:203]
    buffer_load_dwordx4 v6, s[44:47], s88 offen nt lds
    s_waitcnt lgkmcnt(6)
    v_mfma_f32_16x16x32_bf16 a[204:207], a[220:223], a[72:75], a[204:207]
    ds_read_b64_tr_b16 a[236:237], v21 offset:16384
    v_mfma_f32_16x16x32_bf16 a[208:211], a[220:223], a[76:79], a[208:211]
    ds_read_b64_tr_b16 a[238:239], v21 offset:17408
    v_mfma_f32_16x16x32_bf16 a[212:215], a[220:223], a[80:83], a[212:215]
    buffer_load_dwordx4 v7, s[44:47], s88 offen offset:1024 nt lds
    s_waitcnt lgkmcnt(6)
    v_mfma_f32_16x16x32_bf16 a[192:195], a[224:227], a[84:87], a[192:195]
    ds_read_b64_tr_b16 a[240:241], v19 offset:24576
    v_mfma_f32_16x16x32_bf16 a[196:199], a[224:227], a[88:91], a[196:199]
    ds_read_b64_tr_b16 a[242:243], v19 offset:25600
    v_mfma_f32_16x16x32_bf16 a[200:203], a[224:227], a[92:95], a[200:203]
    buffer_load_dwordx4 v8, s[44:47], s88 offen offset:2048 nt lds
    s_waitcnt lgkmcnt(6)
    v_mfma_f32_16x16x32_bf16 a[204:207], a[228:231], a[84:87], a[204:207]
    ds_read_b64_tr_b16 a[244:245], v21 offset:24576
    v_mfma_f32_16x16x32_bf16 a[208:211], a[228:231], a[88:91], a[208:211]
    ds_read_b64_tr_b16 a[246:247], v21 offset:25600
    v_mfma_f32_16x16x32_bf16 a[212:215], a[228:231], a[92:95], a[212:215]
    buffer_load_dwordx4 v9, s[44:47], s88 offen offset:3072 nt lds
    s_waitcnt lgkmcnt(6)
    s_waitcnt vmcnt(8)
    s_barrier
    v_mfma_f32_16x16x32_bf16 a[192:195], a[232:235], a[96:99], a[192:195]
    ds_read_b64_tr_b16 a[216:217], v19 offset:0
    s_add_u32 m0, s86, 49152
    v_mfma_f32_16x16x32_bf16 a[196:199], a[232:235], a[100:103], a[196:199]
    ds_read_b64_tr_b16 a[218:219], v19 offset:1024
    s_add_u32 s88, s85, s77
    v_mfma_f32_16x16x32_bf16 a[200:203], a[232:235], a[104:107], a[200:203]
    buffer_load_dwordx4 v6, s[44:47], s88 offen nt lds
    s_waitcnt lgkmcnt(6)
    v_mfma_f32_16x16x32_bf16 a[204:207], a[236:239], a[96:99], a[204:207]
    ds_read_b64_tr_b16 a[220:221], v21 offset:0
    v_mfma_f32_16x16x32_bf16 a[208:211], a[236:239], a[100:103], a[208:211]
    ds_read_b64_tr_b16 a[222:223], v21 offset:1024
    v_mfma_f32_16x16x32_bf16 a[212:215], a[236:239], a[104:107], a[212:215]
    buffer_load_dwordx4 v7, s[44:47], s88 offen offset:1024 nt lds
    s_waitcnt lgkmcnt(6)
    v_mfma_f32_16x16x32_bf16 a[192:195], a[240:243], a[108:111], a[192:195]
    ds_read_b64_tr_b16 a[224:225], v19 offset:8192
    v_mfma_f32_16x16x32_bf16 a[196:199], a[240:243], a[112:115], a[196:199]
    ds_read_b64_tr_b16 a[226:227], v19 offset:9216
    v_mfma_f32_16x16x32_bf16 a[200:203], a[240:243], a[116:119], a[200:203]
    buffer_load_dwordx4 v8, s[44:47], s88 offen offset:2048 nt lds
    s_waitcnt lgkmcnt(6)
    v_mfma_f32_16x16x32_bf16 a[204:207], a[244:247], a[108:111], a[204:207]
    ds_read_b64_tr_b16 a[228:229], v21 offset:8192
    v_mfma_f32_16x16x32_bf16 a[208:211], a[244:247], a[112:115], a[208:211]
    ds_read_b64_tr_b16 a[230:231], v21 offset:9216
    v_mfma_f32_16x16x32_bf16 a[212:215], a[244:247], a[116:119], a[212:215]
    buffer_load_dwordx4 v9, s[44:47], s88 offen offset:3072 nt lds
    s_waitcnt lgkmcnt(6)
    s_waitcnt vmcnt(8)
    s_barrier
    v_mfma_f32_16x16x32_bf16 a[192:195], a[216:219], a[120:123], a[192:195]
    ds_read_b64_tr_b16 a[232:233], v19 offset:32768
    v_mfma_f32_16x16x32_bf16 a[196:199], a[216:219], a[124:127], a[196:199]
    ds_read_b64_tr_b16 a[234:235], v19 offset:33792
    v_mfma_f32_16x16x32_bf16 a[200:203], a[216:219], a[128:131], a[200:203]
    s_waitcnt lgkmcnt(6)
    v_mfma_f32_16x16x32_bf16 a[204:207], a[220:223], a[120:123], a[204:207]
    ds_read_b64_tr_b16 a[236:237], v21 offset:32768
    v_mfma_f32_16x16x32_bf16 a[208:211], a[220:223], a[124:127], a[208:211]
    ds_read_b64_tr_b16 a[238:239], v21 offset:33792
    v_mfma_f32_16x16x32_bf16 a[212:215], a[220:223], a[128:131], a[212:215]
    s_waitcnt lgkmcnt(6)
    v_mfma_f32_16x16x32_bf16 a[192:195], a[224:227], a[132:135], a[192:195]
    ds_read_b64_tr_b16 a[240:241], v19 offset:40960
    v_mfma_f32_16x16x32_bf16 a[196:199], a[224:227], a[136:139], a[196:199]
    ds_read_b64_tr_b16 a[242:243], v19 offset:41984
    v_mfma_f32_16x16x32_bf16 a[200:203], a[224:227], a[140:143], a[200:203]
    s_waitcnt lgkmcnt(6)
    v_mfma_f32_16x16x32_bf16 a[204:207], a[228:231], a[132:135], a[204:207]
    ds_read_b64_tr_b16 a[244:245], v21 offset:40960
    v_mfma_f32_16x16x32_bf16 a[208:211], a[228:231], a[136:139], a[208:211]
    ds_read_b64_tr_b16 a[246:247], v21 offset:41984
    v_mfma_f32_16x16x32_bf16 a[212:215], a[228:231], a[140:143], a[212:215]
    s_waitcnt lgkmcnt(6)
    s_barrier
    v_mfma_f32_16x16x32_bf16 a[192:195], a[232:235], a[144:147], a[192:195]
    ds_read_b64 a[216:217], v23 offset:49152
    v_mfma_f32_16x16x32_bf16 a[196:199], a[232:235], a[148:151], a[196:199]
    ds_read_b64 a[218:219], v25 offset:49152
    v_mfma_f32_16x16x32_bf16 a[200:203], a[232:235], a[152:155], a[200:203]
    s_waitcnt lgkmcnt(6)
    v_mfma_f32_16x16x32_bf16 a[204:207], a[236:239], a[144:147], a[204:207]
    ds_read_b64 a[220:221], v27 offset:49152
    v_mfma_f32_16x16x32_bf16 a[208:211], a[236:239], a[148:151], a[208:211]
    ds_read_b64 a[222:223], v29 offset:49152
    v_mfma_f32_16x16x32_bf16 a[212:215], a[236:239], a[152:155], a[212:215]
    s_waitcnt lgkmcnt(6)
    v_mfma_f32_16x16x32_bf16 a[192:195], a[240:243], a[156:159], a[192:195]
    ds_read_b64 a[224:225], v23 offset:51200
    v_mfma_f32_16x16x32_bf16 a[196:199], a[240:243], a[160:163], a[196:199]
    ds_read_b64 a[226:227], v25 offset:51200
    v_mfma_f32_16x16x32_bf16 a[200:203], a[240:243], a[164:167], a[200:203]
    s_waitcnt lgkmcnt(6)
    v_mfma_f32_16x16x32_bf16 a[204:207], a[244:247], a[156:159], a[204:207]
    ds_read_b64 a[228:229], v27 offset:51200
    v_mfma_f32_16x16x32_bf16 a[208:211], a[244:247], a[160:163], a[208:211]
    ds_read_b64 a[230:231], v29 offset:51200
    v_mfma_f32_16x16x32_bf16 a[212:215], a[244:247], a[164:167], a[212:215]
    v_accvgpr_read_b32 v44, a192
    v_accvgpr_read_b32 v45, a193
    v_accvgpr_read_b32 v46, a194
    v_accvgpr_read_b32 v47, a195
    v_cvt_pk_bf16_f32 v56, v44, v45
    v_cvt_pk_bf16_f32 v57, v46, v47
    v_accvgpr_read_b32 v48, a204
    v_accvgpr_read_b32 v49, a205
    v_accvgpr_read_b32 v50, a206
    v_accvgpr_read_b32 v51, a207
    v_cvt_pk_bf16_f32 v58, v48, v49
    v_cvt_pk_bf16_f32 v59, v50, v51
    ds_write_b128 v40, v[56:59] offset:0
    v_accvgpr_read_b32 v44, a196
    v_accvgpr_read_b32 v45, a197
    v_accvgpr_read_b32 v46, a198
    v_accvgpr_read_b32 v47, a199
    v_cvt_pk_bf16_f32 v60, v44, v45
    v_cvt_pk_bf16_f32 v61, v46, v47
    v_accvgpr_read_b32 v48, a208
    v_accvgpr_read_b32 v49, a209
    v_accvgpr_read_b32 v50, a210
    v_accvgpr_read_b32 v51, a211
    v_cvt_pk_bf16_f32 v62, v48, v49
    v_cvt_pk_bf16_f32 v63, v50, v51
    ds_write_b128 v40, v[60:63] offset:1024
    v_accvgpr_read_b32 v44, a200
    v_accvgpr_read_b32 v45, a201
    v_accvgpr_read_b32 v46, a202
    v_accvgpr_read_b32 v47, a203
    v_cvt_pk_bf16_f32 v56, v44, v45
    v_cvt_pk_bf16_f32 v57, v46, v47
    v_accvgpr_read_b32 v48, a212
    v_accvgpr_read_b32 v49, a213
    v_accvgpr_read_b32 v50, a214
    v_accvgpr_read_b32 v51, a215
    v_cvt_pk_bf16_f32 v58, v48, v49
    v_cvt_pk_bf16_f32 v59, v50, v51
    ds_write_b128 v40, v[56:59] offset:2048
    s_waitcnt lgkmcnt(0)
    s_barrier
    ds_read_b128 a[192:195], v43 offset:0
    ds_read_b128 a[196:199], v43 offset:1024
    ds_read_b128 a[200:203], v43 offset:2048
    ds_read_b128 a[204:207], v43 offset:6144
    ds_read_b128 a[208:211], v43 offset:7168
    ds_read_b128 a[212:215], v43 offset:8192
    s_waitcnt lgkmcnt(0)
    v_mfma_f32_16x16x32_bf16 v[64:67], a[216:219], a[192:195], v[64:67]
    ds_read_b64 a[232:233], v23 offset:53248
    s_add_u32 m0, s86, 16384
    v_mfma_f32_16x16x32_bf16 v[68:71], a[216:219], a[196:199], v[68:71]
    ds_read_b64 a[234:235], v25 offset:53248
    s_add_u32 s88, s83, s74
    v_mfma_f32_16x16x32_bf16 v[72:75], a[216:219], a[200:203], v[72:75]
    buffer_load_dwordx4 v10, s[48:51], s88 offen nt lds
    v_mfma_f32_16x16x32_bf16 v[64:67], a[220:223], a[204:207], v[64:67]
    ds_read_b64 a[236:237], v27 offset:53248
    v_mfma_f32_16x16x32_bf16 v[68:71], a[220:223], a[208:211], v[68:71]
    ds_read_b64 a[238:239], v29 offset:53248
    v_mfma_f32_16x16x32_bf16 v[72:75], a[220:223], a[212:215], v[72:75]
    buffer_load_dwordx4 v11, s[48:51], s88 offen offset:1024 nt lds
    v_mfma_f32_16x16x32_bf16 v[76:79], a[224:227], a[192:195], v[76:79]
    ds_read_b64 a[240:241], v23 offset:55296
    v_mfma_f32_16x16x32_bf16 v[80:83], a[224:227], a[196:199], v[80:83]
    ds_read_b64 a[242:243], v25 offset:55296
    v_mfma_f32_16x16x32_bf16 v[84:87], a[224:227], a[200:203], v[84:87]
    buffer_load_dwordx4 v12, s[48:51], s88 offen offset:2048 nt lds
    v_mfma_f32_16x16x32_bf16 v[76:79], a[228:231], a[204:207], v[76:79]
    ds_read_b64 a[244:245], v27 offset:55296
    v_mfma_f32_16x16x32_bf16 v[80:83], a[228:231], a[208:211], v[80:83]
    ds_read_b64 a[246:247], v29 offset:55296
    v_mfma_f32_16x16x32_bf16 v[84:87], a[228:231], a[212:215], v[84:87]
    buffer_load_dwordx4 v13, s[48:51], s88 offen offset:3072 nt lds
    s_waitcnt lgkmcnt(6)
    s_barrier
    v_mfma_f32_16x16x32_bf16 v[88:91], a[232:235], a[192:195], v[88:91]
    ds_read_b64 a[216:217], v22 offset:0
    v_mfma_f32_16x16x32_bf16 v[92:95], a[232:235], a[196:199], v[92:95]
    ds_read_b64 a[218:219], v24 offset:0
    v_mfma_f32_16x16x32_bf16 v[96:99], a[232:235], a[200:203], v[96:99]
    s_waitcnt lgkmcnt(6)
    v_mfma_f32_16x16x32_bf16 v[88:91], a[236:239], a[204:207], v[88:91]
    ds_read_b64 a[220:221], v26 offset:0
    v_mfma_f32_16x16x32_bf16 v[92:95], a[236:239], a[208:211], v[92:95]
    ds_read_b64 a[222:223], v28 offset:0
    v_mfma_f32_16x16x32_bf16 v[96:99], a[236:239], a[212:215], v[96:99]
    s_waitcnt lgkmcnt(6)
    v_mfma_f32_16x16x32_bf16 v[100:103], a[240:243], a[192:195], v[100:103]
    ds_read_b64 a[224:225], v22 offset:2048
    v_mfma_f32_16x16x32_bf16 v[104:107], a[240:243], a[196:199], v[104:107]
    ds_read_b64 a[226:227], v24 offset:2048
    v_mfma_f32_16x16x32_bf16 v[108:111], a[240:243], a[200:203], v[108:111]
    s_waitcnt lgkmcnt(6)
    v_mfma_f32_16x16x32_bf16 v[100:103], a[244:247], a[204:207], v[100:103]
    ds_read_b64 a[228:229], v26 offset:2048
    v_mfma_f32_16x16x32_bf16 v[104:107], a[244:247], a[208:211], v[104:107]
    ds_read_b64 a[230:231], v28 offset:2048
    v_mfma_f32_16x16x32_bf16 v[108:111], a[244:247], a[212:215], v[108:111]
    s_waitcnt lgkmcnt(6)
    v_mfma_f32_16x16x32_bf16 v[112:115], a[216:219], a[192:195], v[112:115]
    ds_read_b64 a[232:233], v22 offset:4096
    s_add_u32 m0, s86, 81920
    v_mfma_f32_16x16x32_bf16 v[116:119], a[216:219], a[196:199], v[116:119]
    ds_read_b64 a[234:235], v24 offset:4096
    s_add_u32 s88, s82, s74
    v_mfma_f32_16x16x32_bf16 v[120:123], a[216:219], a[200:203], v[120:123]
    buffer_load_dwordx4 v10, s[48:51], s88 offen nt lds
    s_waitcnt lgkmcnt(6)
    v_mfma_f32_16x16x32_bf16 v[112:115], a[220:223], a[204:207], v[112:115]
    ds_read_b64 a[236:237], v26 offset:4096
    v_max3_f32 v50, v64, v65, v66
    v_mfma_f32_16x16x32_bf16 v[116:119], a[220:223], a[208:211], v[116:119]
    ds_read_b64 a[238:239], v28 offset:4096
    v_max_f32 v50, v50, v67
    v_mfma_f32_16x16x32_bf16 v[120:123], a[220:223], a[212:215], v[120:123]
    buffer_load_dwordx4 v11, s[48:51], s88 offen offset:1024 nt lds
    s_waitcnt lgkmcnt(6)
    v_mfma_f32_16x16x32_bf16 v[124:127], a[224:227], a[192:195], v[124:127]
    ds_read_b64 a[240:241], v22 offset:6144
    v_max3_f32 v52, v68, v69, v70
    v_mfma_f32_16x16x32_bf16 v[128:131], a[224:227], a[196:199], v[128:131]
    ds_read_b64 a[242:243], v24 offset:6144
    v_max_f32 v52, v52, v71
    v_mfma_f32_16x16x32_bf16 v[132:135], a[224:227], a[200:203], v[132:135]
    buffer_load_dwordx4 v12, s[48:51], s88 offen offset:2048 nt lds
    s_waitcnt lgkmcnt(6)
    v_mfma_f32_16x16x32_bf16 v[124:127], a[228:231], a[204:207], v[124:127]
    ds_read_b64 a[244:245], v26 offset:6144
    v_max3_f32 v54, v72, v73, v74
    v_mfma_f32_16x16x32_bf16 v[128:131], a[228:231], a[208:211], v[128:131]
    ds_read_b64 a[246:247], v28 offset:6144
    v_max_f32 v54, v54, v75
    v_mfma_f32_16x16x32_bf16 v[132:135], a[228:231], a[212:215], v[132:135]
    buffer_load_dwordx4 v13, s[48:51], s88 offen offset:3072 nt lds
    s_waitcnt lgkmcnt(6)
    s_waitcnt vmcnt(12)
    s_barrier
    v_mfma_f32_16x16x32_bf16 v[136:139], a[232:235], a[192:195], v[136:139]
    ds_read_b64 a[216:217], v22 offset:32768
    v_max3_f32 v50, v50, v76, v77
    v_mfma_f32_16x16x32_bf16 v[140:143], a[232:235], a[196:199], v[140:143]
    ds_read_b64 a[218:219], v24 offset:32768
    v_max3_f32 v50, v50, v78, v79
    v_mfma_f32_16x16x32_bf16 v[144:147], a[232:235], a[200:203], v[144:147]
    v_max3_f32 v52, v52, v80, v81
    s_waitcnt lgkmcnt(6)
    v_mfma_f32_16x16x32_bf16 v[136:139], a[236:239], a[204:207], v[136:139]
    ds_read_b64 a[220:221], v26 offset:32768
    v_max3_f32 v52, v52, v82, v83
    v_mfma_f32_16x16x32_bf16 v[140:143], a[236:239], a[208:211], v[140:143]
    ds_read_b64 a[222:223], v28 offset:32768
    v_max3_f32 v54, v54, v84, v85
    v_mfma_f32_16x16x32_bf16 v[144:147], a[236:239], a[212:215], v[144:147]
    v_max3_f32 v54, v54, v86, v87
    s_waitcnt lgkmcnt(6)
    v_mfma_f32_16x16x32_bf16 v[148:151], a[240:243], a[192:195], v[148:151]
    ds_read_b64 a[224:225], v22 offset:34816
    v_max3_f32 v50, v50, v88, v89
    v_mfma_f32_16x16x32_bf16 v[152:155], a[240:243], a[196:199], v[152:155]
    ds_read_b64 a[226:227], v24 offset:34816
    v_max3_f32 v50, v50, v90, v91
    v_mfma_f32_16x16x32_bf16 v[156:159], a[240:243], a[200:203], v[156:159]
    v_max3_f32 v52, v52, v92, v93
    s_waitcnt lgkmcnt(6)
    v_mfma_f32_16x16x32_bf16 v[148:151], a[244:247], a[204:207], v[148:151]
    ds_read_b64 a[228:229], v26 offset:34816
    v_max3_f32 v52, v52, v94, v95
    v_mfma_f32_16x16x32_bf16 v[152:155], a[244:247], a[208:211], v[152:155]
    ds_read_b64 a[230:231], v28 offset:34816
    v_max3_f32 v54, v54, v96, v97
    v_mfma_f32_16x16x32_bf16 v[156:159], a[244:247], a[212:215], v[156:159]
    v_max3_f32 v54, v54, v98, v99
    s_waitcnt lgkmcnt(6)
    v_mfma_f32_16x16x32_bf16 v[160:163], a[216:219], a[192:195], v[160:163]
    ds_read_b64 a[232:233], v22 offset:36864
    v_max3_f32 v50, v50, v100, v101
    v_mfma_f32_16x16x32_bf16 v[164:167], a[216:219], a[196:199], v[164:167]
    ds_read_b64 a[234:235], v24 offset:36864
    v_max3_f32 v50, v50, v102, v103
    v_mfma_f32_16x16x32_bf16 v[168:171], a[216:219], a[200:203], v[168:171]
    v_max3_f32 v52, v52, v104, v105
    s_waitcnt lgkmcnt(6)
    v_mfma_f32_16x16x32_bf16 v[160:163], a[220:223], a[204:207], v[160:163]
    ds_read_b64 a[236:237], v26 offset:36864
    v_max3_f32 v52, v52, v106, v107
    v_mfma_f32_16x16x32_bf16 v[164:167], a[220:223], a[208:211], v[164:167]
    ds_read_b64 a[238:239], v28 offset:36864
    v_max3_f32 v54, v54, v108, v109
    v_mfma_f32_16x16x32_bf16 v[168:171], a[220:223], a[212:215], v[168:171]
    v_max3_f32 v54, v54, v110, v111
    s_waitcnt lgkmcnt(6)
    v_mfma_f32_16x16x32_bf16 v[172:175], a[224:227], a[192:195], v[172:175]
    ds_read_b64 a[240:241], v22 offset:38912
    v_max3_f32 v50, v50, v112, v113
    v_mfma_f32_16x16x32_bf16 v[176:179], a[224:227], a[196:199], v[176:179]
    ds_read_b64 a[242:243], v24 offset:38912
    v_max3_f32 v50, v50, v114, v115
    v_mfma_f32_16x16x32_bf16 v[180:183], a[224:227], a[200:203], v[180:183]
    v_max3_f32 v52, v52, v116, v117
    s_waitcnt lgkmcnt(6)
    v_mfma_f32_16x16x32_bf16 v[172:175], a[228:231], a[204:207], v[172:175]
    ds_read_b64 a[244:245], v26 offset:38912
    v_max3_f32 v52, v52, v118, v119
    v_mfma_f32_16x16x32_bf16 v[176:179], a[228:231], a[208:211], v[176:179]
    ds_read_b64 a[246:247], v28 offset:38912
    v_max3_f32 v54, v54, v120, v121
    v_mfma_f32_16x16x32_bf16 v[180:183], a[228:231], a[212:215], v[180:183]
    v_max3_f32 v54, v54, v122, v123
    s_waitcnt lgkmcnt(6)
    s_waitcnt vmcnt(8)
    s_barrier
    v_mfma_f32_16x16x32_bf16 v[184:187], a[232:235], a[192:195], v[184:187]
    ds_read_b64 a[216:217], v22 offset:49152
    v_max3_f32 v50, v50, v124, v125
    v_mfma_f32_16x16x32_bf16 v[188:191], a[232:235], a[196:199], v[188:191]
    ds_read_b64 a[218:219], v24 offset:49152
    v_max3_f32 v50, v50, v126, v127
    v_mfma_f32_16x16x32_bf16 v[192:195], a[232:235], a[200:203], v[192:195]
    v_max3_f32 v52, v52, v128, v129
    s_waitcnt lgkmcnt(6)
    v_mfma_f32_16x16x32_bf16 v[184:187], a[236:239], a[204:207], v[184:187]
    ds_read_b64 a[220:221], v26 offset:49152
    v_max3_f32 v52, v52, v130, v131
    v_mfma_f32_16x16x32_bf16 v[188:191], a[236:239], a[208:211], v[188:191]
    ds_read_b64 a[222:223], v28 offset:49152
    v_max3_f32 v54, v54, v132, v133
    v_mfma_f32_16x16x32_bf16 v[192:195], a[236:239], a[212:215], v[192:195]
    v_max3_f32 v54, v54, v134, v135
    s_waitcnt lgkmcnt(6)
    v_mfma_f32_16x16x32_bf16 v[196:199], a[240:243], a[192:195], v[196:199]
    ds_read_b64 a[224:225], v22 offset:51200
    v_max3_f32 v50, v50, v136, v137
    v_mfma_f32_16x16x32_bf16 v[200:203], a[240:243], a[196:199], v[200:203]
    ds_read_b64 a[226:227], v24 offset:51200
    v_max3_f32 v50, v50, v138, v139
    v_mfma_f32_16x16x32_bf16 v[204:207], a[240:243], a[200:203], v[204:207]
    v_max3_f32 v52, v52, v140, v141
    s_waitcnt lgkmcnt(6)
    v_mfma_f32_16x16x32_bf16 v[196:199], a[244:247], a[204:207], v[196:199]
    ds_read_b64 a[228:229], v26 offset:51200
    v_max3_f32 v52, v52, v142, v143
    v_mfma_f32_16x16x32_bf16 v[200:203], a[244:247], a[208:211], v[200:203]
    ds_read_b64 a[230:231], v28 offset:51200
    v_max3_f32 v54, v54, v144, v145
    v_mfma_f32_16x16x32_bf16 v[204:207], a[244:247], a[212:215], v[204:207]
    v_max3_f32 v54, v54, v146, v147
    s_waitcnt lgkmcnt(6)
    v_mfma_f32_16x16x32_bf16 v[208:211], a[216:219], a[192:195], v[208:211]
    ds_read_b64 a[232:233], v22 offset:53248
    v_max3_f32 v50, v50, v148, v149
    v_mfma_f32_16x16x32_bf16 v[212:215], a[216:219], a[196:199], v[212:215]
    ds_read_b64 a[234:235], v24 offset:53248
    v_max3_f32 v50, v50, v150, v151
    v_mfma_f32_16x16x32_bf16 v[216:219], a[216:219], a[200:203], v[216:219]
    v_max3_f32 v52, v52, v152, v153
    s_waitcnt lgkmcnt(6)
    v_mfma_f32_16x16x32_bf16 v[208:211], a[220:223], a[204:207], v[208:211]
    ds_read_b64 a[236:237], v26 offset:53248
    v_max3_f32 v52, v52, v154, v155
    v_mfma_f32_16x16x32_bf16 v[212:215], a[220:223], a[208:211], v[212:215]
    ds_read_b64 a[238:239], v28 offset:53248
    v_max3_f32 v54, v54, v156, v157
    v_mfma_f32_16x16x32_bf16 v[216:219], a[220:223], a[212:215], v[216:219]
    v_max3_f32 v54, v54, v158, v159
    s_waitcnt lgkmcnt(6)
    v_mfma_f32_16x16x32_bf16 v[220:223], a[224:227], a[192:195], v[220:223]
    ds_read_b64 a[240:241], v22 offset:55296
    v_max3_f32 v50, v50, v160, v161
    v_mfma_f32_16x16x32_bf16 v[224:227], a[224:227], a[196:199], v[224:227]
    ds_read_b64 a[242:243], v24 offset:55296
    v_max3_f32 v50, v50, v162, v163
    v_mfma_f32_16x16x32_bf16 v[228:231], a[224:227], a[200:203], v[228:231]
    v_max3_f32 v52, v52, v164, v165
    s_waitcnt lgkmcnt(6)
    v_mfma_f32_16x16x32_bf16 v[220:223], a[228:231], a[204:207], v[220:223]
    ds_read_b64 a[244:245], v26 offset:55296
    v_max3_f32 v52, v52, v166, v167
    v_mfma_f32_16x16x32_bf16 v[224:227], a[228:231], a[208:211], v[224:227]
    ds_read_b64 a[246:247], v28 offset:55296
    v_max3_f32 v54, v54, v168, v169
    v_mfma_f32_16x16x32_bf16 v[228:231], a[228:231], a[212:215], v[228:231]
    v_max3_f32 v54, v54, v170, v171
    s_waitcnt lgkmcnt(6)
    v_mfma_f32_16x16x32_bf16 v[232:235], a[232:235], a[192:195], v[232:235]
    v_max3_f32 v50, v50, v172, v173
    v_max3_f32 v50, v50, v174, v175
    v_mfma_f32_16x16x32_bf16 v[236:239], a[232:235], a[196:199], v[236:239]
    v_max3_f32 v52, v52, v176, v177
    v_max3_f32 v52, v52, v178, v179
    v_mfma_f32_16x16x32_bf16 v[240:243], a[232:235], a[200:203], v[240:243]
    v_max3_f32 v54, v54, v180, v181
    s_waitcnt lgkmcnt(4)
    v_mfma_f32_16x16x32_bf16 v[232:235], a[236:239], a[204:207], v[232:235]
    v_max3_f32 v54, v54, v182, v183
    v_max3_f32 v50, v50, v184, v185
    v_mfma_f32_16x16x32_bf16 v[236:239], a[236:239], a[208:211], v[236:239]
    v_max3_f32 v50, v50, v186, v187
    v_max3_f32 v52, v52, v188, v189
    v_mfma_f32_16x16x32_bf16 v[240:243], a[236:239], a[212:215], v[240:243]
    v_max3_f32 v52, v52, v190, v191
    s_waitcnt lgkmcnt(2)
    v_mfma_f32_16x16x32_bf16 v[244:247], a[240:243], a[192:195], v[244:247]
    v_max3_f32 v54, v54, v192, v193
    v_max3_f32 v54, v54, v194, v195
    v_mfma_f32_16x16x32_bf16 v[248:251], a[240:243], a[196:199], v[248:251]
    v_max3_f32 v50, v50, v196, v197
    v_max3_f32 v50, v50, v198, v199
    v_mfma_f32_16x16x32_bf16 v[252:255], a[240:243], a[200:203], v[252:255]
    v_max3_f32 v52, v52, v200, v201
    s_waitcnt lgkmcnt(0)
    v_mfma_f32_16x16x32_bf16 v[244:247], a[244:247], a[204:207], v[244:247]
    v_max3_f32 v52, v52, v202, v203
    v_max3_f32 v54, v54, v204, v205
    v_mfma_f32_16x16x32_bf16 v[248:251], a[244:247], a[208:211], v[248:251]
    v_max3_f32 v54, v54, v206, v207
    v_mfma_f32_16x16x32_bf16 v[252:255], a[244:247], a[212:215], v[252:255]
    s_barrier
    v_max3_f32 v50, v50, v208, v209
    v_max3_f32 v50, v50, v210, v211
    v_max3_f32 v52, v52, v212, v213
    v_max3_f32 v52, v52, v214, v215
    v_max3_f32 v54, v54, v216, v217
    v_max3_f32 v54, v54, v218, v219
    v_max3_f32 v50, v50, v220, v221
    v_max3_f32 v50, v50, v222, v223
    v_max3_f32 v52, v52, v224, v225
    v_max3_f32 v52, v52, v226, v227
    v_max3_f32 v54, v54, v228, v229
    v_max3_f32 v54, v54, v230, v231
    v_max3_f32 v50, v50, v232, v233
    v_max3_f32 v50, v50, v234, v235
    v_max3_f32 v52, v52, v236, v237
    v_max3_f32 v52, v52, v238, v239
    v_max3_f32 v54, v54, v240, v241
    v_max3_f32 v54, v54, v242, v243
    v_max3_f32 v50, v50, v244, v245
    v_max3_f32 v50, v50, v246, v247
    v_max3_f32 v52, v52, v248, v249
    v_max3_f32 v52, v52, v250, v251
    v_max3_f32 v54, v54, v252, v253
    v_max3_f32 v54, v54, v254, v255
    v_mov_b32 v56, v50
    v_mov_b32 v57, v52
    v_mov_b32 v58, v54
    v_permlane16_swap_b32 v50, v56
    v_permlane16_swap_b32 v52, v57
    v_permlane16_swap_b32 v54, v58
    v_max_f32 v50, v50, v56
    v_max_f32 v52, v52, v57
    v_max_f32 v54, v54, v58
    v_mov_b32 v56, v50
    v_mov_b32 v57, v52
    v_mov_b32 v58, v54
    v_permlane32_swap_b32 v50, v56
    v_permlane32_swap_b32 v52, v57
    v_permlane32_swap_b32 v54, v58
    v_max_f32 v50, v50, v56
    v_max_f32 v52, v52, v57
    v_max_f32 v54, v54, v58
    v_mul_f32 v50, s94, v50
    v_mul_f32 v52, s94, v52
    v_mul_f32 v54, s94, v54
    v_mov_b32 v56, 0x3f803f80
    v_accvgpr_write_b32 a248, v56
    v_accvgpr_write_b32 a249, v56
    v_accvgpr_write_b32 a250, v56
    v_accvgpr_write_b32 a251, v56
    v_pk_fma_f32 v[64:65], v[64:65], s[94:95], v[50:51] op_sel_hi:[1,1,0] neg_lo:[0,0,1] neg_hi:[0,0,1]
    v_pk_fma_f32 v[66:67], v[66:67], s[94:95], v[50:51] op_sel_hi:[1,1,0] neg_lo:[0,0,1] neg_hi:[0,0,1]
    v_pk_fma_f32 v[76:77], v[76:77], s[94:95], v[50:51] op_sel_hi:[1,1,0] neg_lo:[0,0,1] neg_hi:[0,0,1]
    v_pk_fma_f32 v[78:79], v[78:79], s[94:95], v[50:51] op_sel_hi:[1,1,0] neg_lo:[0,0,1] neg_hi:[0,0,1]
    v_exp_f32 v64, v64
    v_exp_f32 v65, v65
    v_exp_f32 v66, v66
    v_exp_f32 v67, v67
    v_exp_f32 v76, v76
    v_exp_f32 v77, v77
    v_exp_f32 v78, v78
    v_exp_f32 v79, v79
    v_cvt_pk_bf16_f32 v64, v64, v65
    v_cvt_pk_bf16_f32 v65, v66, v67
    v_cvt_pk_bf16_f32 v66, v76, v77
    v_cvt_pk_bf16_f32 v67, v78, v79
    s_add_u32 m0, s86, 65536
    s_add_u32 s88, s85, s74
    buffer_load_dwordx4 v10, s[48:51], s88 offen nt lds
    v_pk_fma_f32 v[68:69], v[68:69], s[94:95], v[52:53] op_sel_hi:[1,1,0] neg_lo:[0,0,1] neg_hi:[0,0,1]
    v_pk_fma_f32 v[70:71], v[70:71], s[94:95], v[52:53] op_sel_hi:[1,1,0] neg_lo:[0,0,1] neg_hi:[0,0,1]
    v_pk_fma_f32 v[80:81], v[80:81], s[94:95], v[52:53] op_sel_hi:[1,1,0] neg_lo:[0,0,1] neg_hi:[0,0,1]
    v_pk_fma_f32 v[82:83], v[82:83], s[94:95], v[52:53] op_sel_hi:[1,1,0] neg_lo:[0,0,1] neg_hi:[0,0,1]
    v_exp_f32 v68, v68
    v_exp_f32 v69, v69
    v_exp_f32 v70, v70
    v_exp_f32 v71, v71
    v_exp_f32 v80, v80
    v_exp_f32 v81, v81
    v_exp_f32 v82, v82
    v_exp_f32 v83, v83
    v_cvt_pk_bf16_f32 v68, v68, v69
    v_cvt_pk_bf16_f32 v69, v70, v71
    v_cvt_pk_bf16_f32 v70, v80, v81
    v_cvt_pk_bf16_f32 v71, v82, v83
    v_pk_fma_f32 v[72:73], v[72:73], s[94:95], v[54:55] op_sel_hi:[1,1,0] neg_lo:[0,0,1] neg_hi:[0,0,1]
    v_pk_fma_f32 v[74:75], v[74:75], s[94:95], v[54:55] op_sel_hi:[1,1,0] neg_lo:[0,0,1] neg_hi:[0,0,1]
    v_pk_fma_f32 v[84:85], v[84:85], s[94:95], v[54:55] op_sel_hi:[1,1,0] neg_lo:[0,0,1] neg_hi:[0,0,1]
    v_pk_fma_f32 v[86:87], v[86:87], s[94:95], v[54:55] op_sel_hi:[1,1,0] neg_lo:[0,0,1] neg_hi:[0,0,1]
    v_exp_f32 v72, v72
    v_exp_f32 v73, v73
    v_exp_f32 v74, v74
    v_exp_f32 v75, v75
    v_exp_f32 v84, v84
    v_exp_f32 v85, v85
    v_exp_f32 v86, v86
    v_exp_f32 v87, v87
    v_cvt_pk_bf16_f32 v72, v72, v73
    v_cvt_pk_bf16_f32 v73, v74, v75
    v_cvt_pk_bf16_f32 v74, v84, v85
    v_cvt_pk_bf16_f32 v75, v86, v87
    buffer_load_dwordx4 v11, s[48:51], s88 offen offset:1024 nt lds
    v_pk_fma_f32 v[88:89], v[88:89], s[94:95], v[50:51] op_sel_hi:[1,1,0] neg_lo:[0,0,1] neg_hi:[0,0,1]
    v_pk_fma_f32 v[90:91], v[90:91], s[94:95], v[50:51] op_sel_hi:[1,1,0] neg_lo:[0,0,1] neg_hi:[0,0,1]
    v_pk_fma_f32 v[100:101], v[100:101], s[94:95], v[50:51] op_sel_hi:[1,1,0] neg_lo:[0,0,1] neg_hi:[0,0,1]
    v_pk_fma_f32 v[102:103], v[102:103], s[94:95], v[50:51] op_sel_hi:[1,1,0] neg_lo:[0,0,1] neg_hi:[0,0,1]
    v_exp_f32 v88, v88
    v_exp_f32 v89, v89
    v_exp_f32 v90, v90
    v_exp_f32 v91, v91
    v_exp_f32 v100, v100
    v_exp_f32 v101, v101
    v_exp_f32 v102, v102
    v_exp_f32 v103, v103
    v_cvt_pk_bf16_f32 v88, v88, v89
    v_cvt_pk_bf16_f32 v89, v90, v91
    v_cvt_pk_bf16_f32 v90, v100, v101
    v_cvt_pk_bf16_f32 v91, v102, v103
    v_pk_fma_f32 v[92:93], v[92:93], s[94:95], v[52:53] op_sel_hi:[1,1,0] neg_lo:[0,0,1] neg_hi:[0,0,1]
    v_pk_fma_f32 v[94:95], v[94:95], s[94:95], v[52:53] op_sel_hi:[1,1,0] neg_lo:[0,0,1] neg_hi:[0,0,1]
    v_pk_fma_f32 v[104:105], v[104:105], s[94:95], v[52:53] op_sel_hi:[1,1,0] neg_lo:[0,0,1] neg_hi:[0,0,1]
    v_pk_fma_f32 v[106:107], v[106:107], s[94:95], v[52:53] op_sel_hi:[1,1,0] neg_lo:[0,0,1] neg_hi:[0,0,1]
    v_exp_f32 v92, v92
    v_exp_f32 v93, v93
    v_exp_f32 v94, v94
    v_exp_f32 v95, v95
    v_exp_f32 v104, v104
    v_exp_f32 v105, v105
    v_exp_f32 v106, v106
    v_exp_f32 v107, v107
    v_cvt_pk_bf16_f32 v92, v92, v93
    v_cvt_pk_bf16_f32 v93, v94, v95
    v_cvt_pk_bf16_f32 v94, v104, v105
    v_cvt_pk_bf16_f32 v95, v106, v107
    buffer_load_dwordx4 v12, s[48:51], s88 offen offset:2048 nt lds
    v_pk_fma_f32 v[96:97], v[96:97], s[94:95], v[54:55] op_sel_hi:[1,1,0] neg_lo:[0,0,1] neg_hi:[0,0,1]
    v_pk_fma_f32 v[98:99], v[98:99], s[94:95], v[54:55] op_sel_hi:[1,1,0] neg_lo:[0,0,1] neg_hi:[0,0,1]
    v_pk_fma_f32 v[108:109], v[108:109], s[94:95], v[54:55] op_sel_hi:[1,1,0] neg_lo:[0,0,1] neg_hi:[0,0,1]
    v_pk_fma_f32 v[110:111], v[110:111], s[94:95], v[54:55] op_sel_hi:[1,1,0] neg_lo:[0,0,1] neg_hi:[0,0,1]
    v_exp_f32 v96, v96
    v_exp_f32 v97, v97
    v_exp_f32 v98, v98
    v_exp_f32 v99, v99
    v_exp_f32 v108, v108
    v_exp_f32 v109, v109
    v_exp_f32 v110, v110
    v_exp_f32 v111, v111
    v_cvt_pk_bf16_f32 v96, v96, v97
    v_cvt_pk_bf16_f32 v97, v98, v99
    v_cvt_pk_bf16_f32 v98, v108, v109
    v_cvt_pk_bf16_f32 v99, v110, v111
    v_pk_fma_f32 v[112:113], v[112:113], s[94:95], v[50:51] op_sel_hi:[1,1,0] neg_lo:[0,0,1] neg_hi:[0,0,1]
    v_pk_fma_f32 v[114:115], v[114:115], s[94:95], v[50:51] op_sel_hi:[1,1,0] neg_lo:[0,0,1] neg_hi:[0,0,1]
    v_pk_fma_f32 v[124:125], v[124:125], s[94:95], v[50:51] op_sel_hi:[1,1,0] neg_lo:[0,0,1] neg_hi:[0,0,1]
    v_pk_fma_f32 v[126:127], v[126:127], s[94:95], v[50:51] op_sel_hi:[1,1,0] neg_lo:[0,0,1] neg_hi:[0,0,1]
    v_exp_f32 v112, v112
    v_exp_f32 v113, v113
    v_exp_f32 v114, v114
    v_exp_f32 v115, v115
    v_exp_f32 v124, v124
    v_exp_f32 v125, v125
    v_exp_f32 v126, v126
    v_exp_f32 v127, v127
    v_cvt_pk_bf16_f32 v112, v112, v113
    v_cvt_pk_bf16_f32 v113, v114, v115
    v_cvt_pk_bf16_f32 v114, v124, v125
    v_cvt_pk_bf16_f32 v115, v126, v127
    buffer_load_dwordx4 v13, s[48:51], s88 offen offset:3072 nt lds
    s_add_u32 m0, s86, 98304
    s_add_u32 s88, s84, s74
    v_pk_fma_f32 v[116:117], v[116:117], s[94:95], v[52:53] op_sel_hi:[1,1,0] neg_lo:[0,0,1] neg_hi:[0,0,1]
    v_pk_fma_f32 v[118:119], v[118:119], s[94:95], v[52:53] op_sel_hi:[1,1,0] neg_lo:[0,0,1] neg_hi:[0,0,1]
    v_pk_fma_f32 v[128:129], v[128:129], s[94:95], v[52:53] op_sel_hi:[1,1,0] neg_lo:[0,0,1] neg_hi:[0,0,1]
    v_pk_fma_f32 v[130:131], v[130:131], s[94:95], v[52:53] op_sel_hi:[1,1,0] neg_lo:[0,0,1] neg_hi:[0,0,1]
    v_exp_f32 v116, v116
    v_exp_f32 v117, v117
    v_exp_f32 v118, v118
    v_exp_f32 v119, v119
    v_exp_f32 v128, v128
    v_exp_f32 v129, v129
    v_exp_f32 v130, v130
    v_exp_f32 v131, v131
    v_cvt_pk_bf16_f32 v116, v116, v117
    v_cvt_pk_bf16_f32 v117, v118, v119
    v_cvt_pk_bf16_f32 v118, v128, v129
    v_cvt_pk_bf16_f32 v119, v130, v131
    v_pk_fma_f32 v[120:121], v[120:121], s[94:95], v[54:55] op_sel_hi:[1,1,0] neg_lo:[0,0,1] neg_hi:[0,0,1]
    v_pk_fma_f32 v[122:123], v[122:123], s[94:95], v[54:55] op_sel_hi:[1,1,0] neg_lo:[0,0,1] neg_hi:[0,0,1]
    v_pk_fma_f32 v[132:133], v[132:133], s[94:95], v[54:55] op_sel_hi:[1,1,0] neg_lo:[0,0,1] neg_hi:[0,0,1]
    v_pk_fma_f32 v[134:135], v[134:135], s[94:95], v[54:55] op_sel_hi:[1,1,0] neg_lo:[0,0,1] neg_hi:[0,0,1]
    v_exp_f32 v120, v120
    v_exp_f32 v121, v121
    v_exp_f32 v122, v122
    v_exp_f32 v123, v123
    v_exp_f32 v132, v132
    v_exp_f32 v133, v133
    v_exp_f32 v134, v134
    v_exp_f32 v135, v135
    v_cvt_pk_bf16_f32 v120, v120, v121
    v_cvt_pk_bf16_f32 v121, v122, v123
    v_cvt_pk_bf16_f32 v122, v132, v133
    v_cvt_pk_bf16_f32 v123, v134, v135
    buffer_load_dwordx4 v10, s[48:51], s88 offen nt lds

    s_lshl_b32 s96, s93, 3
    s_add_u32 s96, s96, 0
    v_mov_b32 v56, s96
    v_mov_b32 v57, 1
    v_mov_b32 v58, 0
    s_mov_b64 s[26:27], exec
    s_mov_b64 exec, 1
    s_cmp_eq_u32 s87, 0
    s_cbranch_scc1 L_sigA2
    buffer_load_dword v63, v58, s[40:43], 0 offen
    s_branch L_sigB2
L_sigA2:
    global_atomic_add v56, v57, s[30:31] sc1
L_sigB2:
    s_mov_b64 exec, s[26:27]

    v_pk_fma_f32 v[136:137], v[136:137], s[94:95], v[50:51] op_sel_hi:[1,1,0] neg_lo:[0,0,1] neg_hi:[0,0,1]
    v_pk_fma_f32 v[138:139], v[138:139], s[94:95], v[50:51] op_sel_hi:[1,1,0] neg_lo:[0,0,1] neg_hi:[0,0,1]
    v_pk_fma_f32 v[148:149], v[148:149], s[94:95], v[50:51] op_sel_hi:[1,1,0] neg_lo:[0,0,1] neg_hi:[0,0,1]
    v_pk_fma_f32 v[150:151], v[150:151], s[94:95], v[50:51] op_sel_hi:[1,1,0] neg_lo:[0,0,1] neg_hi:[0,0,1]
    v_exp_f32 v136, v136
    v_exp_f32 v137, v137
    v_exp_f32 v138, v138
    v_exp_f32 v139, v139
    v_exp_f32 v148, v148
    v_exp_f32 v149, v149
    v_exp_f32 v150, v150
    v_exp_f32 v151, v151
    v_cvt_pk_bf16_f32 v136, v136, v137
    v_cvt_pk_bf16_f32 v137, v138, v139
    v_cvt_pk_bf16_f32 v138, v148, v149
    v_cvt_pk_bf16_f32 v139, v150, v151
    v_pk_fma_f32 v[140:141], v[140:141], s[94:95], v[52:53] op_sel_hi:[1,1,0] neg_lo:[0,0,1] neg_hi:[0,0,1]
    v_pk_fma_f32 v[142:143], v[142:143], s[94:95], v[52:53] op_sel_hi:[1,1,0] neg_lo:[0,0,1] neg_hi:[0,0,1]
    v_pk_fma_f32 v[152:153], v[152:153], s[94:95], v[52:53] op_sel_hi:[1,1,0] neg_lo:[0,0,1] neg_hi:[0,0,1]
    v_pk_fma_f32 v[154:155], v[154:155], s[94:95], v[52:53] op_sel_hi:[1,1,0] neg_lo:[0,0,1] neg_hi:[0,0,1]
    v_exp_f32 v140, v140
    v_exp_f32 v141, v141
    v_exp_f32 v142, v142
    v_exp_f32 v143, v143
    v_exp_f32 v152, v152
    v_exp_f32 v153, v153
    v_exp_f32 v154, v154
    v_exp_f32 v155, v155
    v_cvt_pk_bf16_f32 v140, v140, v141
    v_cvt_pk_bf16_f32 v141, v142, v143
    v_cvt_pk_bf16_f32 v142, v152, v153
    v_cvt_pk_bf16_f32 v143, v154, v155
    buffer_load_dwordx4 v11, s[48:51], s88 offen offset:1024 nt lds
    v_pk_fma_f32 v[144:145], v[144:145], s[94:95], v[54:55] op_sel_hi:[1,1,0] neg_lo:[0,0,1] neg_hi:[0,0,1]
    v_pk_fma_f32 v[146:147], v[146:147], s[94:95], v[54:55] op_sel_hi:[1,1,0] neg_lo:[0,0,1] neg_hi:[0,0,1]
    v_pk_fma_f32 v[156:157], v[156:157], s[94:95], v[54:55] op_sel_hi:[1,1,0] neg_lo:[0,0,1] neg_hi:[0,0,1]
    v_pk_fma_f32 v[158:159], v[158:159], s[94:95], v[54:55] op_sel_hi:[1,1,0] neg_lo:[0,0,1] neg_hi:[0,0,1]
    v_exp_f32 v144, v144
    v_exp_f32 v145, v145
    v_exp_f32 v146, v146
    v_exp_f32 v147, v147
    v_exp_f32 v156, v156
    v_exp_f32 v157, v157
    v_exp_f32 v158, v158
    v_exp_f32 v159, v159
    v_cvt_pk_bf16_f32 v144, v144, v145
    v_cvt_pk_bf16_f32 v145, v146, v147
    v_cvt_pk_bf16_f32 v146, v156, v157
    v_cvt_pk_bf16_f32 v147, v158, v159
    v_pk_fma_f32 v[160:161], v[160:161], s[94:95], v[50:51] op_sel_hi:[1,1,0] neg_lo:[0,0,1] neg_hi:[0,0,1]
    v_pk_fma_f32 v[162:163], v[162:163], s[94:95], v[50:51] op_sel_hi:[1,1,0] neg_lo:[0,0,1] neg_hi:[0,0,1]
    v_pk_fma_f32 v[172:173], v[172:173], s[94:95], v[50:51] op_sel_hi:[1,1,0] neg_lo:[0,0,1] neg_hi:[0,0,1]
    v_pk_fma_f32 v[174:175], v[174:175], s[94:95], v[50:51] op_sel_hi:[1,1,0] neg_lo:[0,0,1] neg_hi:[0,0,1]
    v_exp_f32 v160, v160
    v_exp_f32 v161, v161
    v_exp_f32 v162, v162
    v_exp_f32 v163, v163
    v_exp_f32 v172, v172
    v_exp_f32 v173, v173
    v_exp_f32 v174, v174
    v_exp_f32 v175, v175
    v_cvt_pk_bf16_f32 v160, v160, v161
    v_cvt_pk_bf16_f32 v161, v162, v163
    v_cvt_pk_bf16_f32 v162, v172, v173
    v_cvt_pk_bf16_f32 v163, v174, v175
    buffer_load_dwordx4 v12, s[48:51], s88 offen offset:2048 nt lds
    v_pk_fma_f32 v[164:165], v[164:165], s[94:95], v[52:53] op_sel_hi:[1,1,0] neg_lo:[0,0,1] neg_hi:[0,0,1]
    v_pk_fma_f32 v[166:167], v[166:167], s[94:95], v[52:53] op_sel_hi:[1,1,0] neg_lo:[0,0,1] neg_hi:[0,0,1]
    v_pk_fma_f32 v[176:177], v[176:177], s[94:95], v[52:53] op_sel_hi:[1,1,0] neg_lo:[0,0,1] neg_hi:[0,0,1]
    v_pk_fma_f32 v[178:179], v[178:179], s[94:95], v[52:53] op_sel_hi:[1,1,0] neg_lo:[0,0,1] neg_hi:[0,0,1]
    v_exp_f32 v164, v164
    v_exp_f32 v165, v165
    v_exp_f32 v166, v166
    v_exp_f32 v167, v167
    v_exp_f32 v176, v176
    v_exp_f32 v177, v177
    v_exp_f32 v178, v178
    v_exp_f32 v179, v179
    v_cvt_pk_bf16_f32 v164, v164, v165
    v_cvt_pk_bf16_f32 v165, v166, v167
    v_cvt_pk_bf16_f32 v166, v176, v177
    v_cvt_pk_bf16_f32 v167, v178, v179
    v_pk_fma_f32 v[168:169], v[168:169], s[94:95], v[54:55] op_sel_hi:[1,1,0] neg_lo:[0,0,1] neg_hi:[0,0,1]
    v_pk_fma_f32 v[170:171], v[170:171], s[94:95], v[54:55] op_sel_hi:[1,1,0] neg_lo:[0,0,1] neg_hi:[0,0,1]
    v_pk_fma_f32 v[180:181], v[180:181], s[94:95], v[54:55] op_sel_hi:[1,1,0] neg_lo:[0,0,1] neg_hi:[0,0,1]
    v_pk_fma_f32 v[182:183], v[182:183], s[94:95], v[54:55] op_sel_hi:[1,1,0] neg_lo:[0,0,1] neg_hi:[0,0,1]
    v_exp_f32 v168, v168
    v_exp_f32 v169, v169
    v_exp_f32 v170, v170
    v_exp_f32 v171, v171
    v_exp_f32 v180, v180
    v_exp_f32 v181, v181
    v_exp_f32 v182, v182
    v_exp_f32 v183, v183
    v_cvt_pk_bf16_f32 v168, v168, v169
    v_cvt_pk_bf16_f32 v169, v170, v171
    v_cvt_pk_bf16_f32 v170, v180, v181
    v_cvt_pk_bf16_f32 v171, v182, v183
    buffer_load_dwordx4 v13, s[48:51], s88 offen offset:3072 nt lds
    v_pk_fma_f32 v[184:185], v[184:185], s[94:95], v[50:51] op_sel_hi:[1,1,0] neg_lo:[0,0,1] neg_hi:[0,0,1]
    v_pk_fma_f32 v[186:187], v[186:187], s[94:95], v[50:51] op_sel_hi:[1,1,0] neg_lo:[0,0,1] neg_hi:[0,0,1]
    v_pk_fma_f32 v[196:197], v[196:197], s[94:95], v[50:51] op_sel_hi:[1,1,0] neg_lo:[0,0,1] neg_hi:[0,0,1]
    v_pk_fma_f32 v[198:199], v[198:199], s[94:95], v[50:51] op_sel_hi:[1,1,0] neg_lo:[0,0,1] neg_hi:[0,0,1]
    v_exp_f32 v184, v184
    v_exp_f32 v185, v185
    v_exp_f32 v186, v186
    v_exp_f32 v187, v187
    v_exp_f32 v196, v196
    v_exp_f32 v197, v197
    v_exp_f32 v198, v198
    v_exp_f32 v199, v199
    v_cvt_pk_bf16_f32 v184, v184, v185
    v_cvt_pk_bf16_f32 v185, v186, v187
    v_cvt_pk_bf16_f32 v186, v196, v197
    v_cvt_pk_bf16_f32 v187, v198, v199
    v_pk_fma_f32 v[188:189], v[188:189], s[94:95], v[52:53] op_sel_hi:[1,1,0] neg_lo:[0,0,1] neg_hi:[0,0,1]
    v_pk_fma_f32 v[190:191], v[190:191], s[94:95], v[52:53] op_sel_hi:[1,1,0] neg_lo:[0,0,1] neg_hi:[0,0,1]
    v_pk_fma_f32 v[200:201], v[200:201], s[94:95], v[52:53] op_sel_hi:[1,1,0] neg_lo:[0,0,1] neg_hi:[0,0,1]
    v_pk_fma_f32 v[202:203], v[202:203], s[94:95], v[52:53] op_sel_hi:[1,1,0] neg_lo:[0,0,1] neg_hi:[0,0,1]
    v_exp_f32 v188, v188
    v_exp_f32 v189, v189
    v_exp_f32 v190, v190
    v_exp_f32 v191, v191
    v_exp_f32 v200, v200
    v_exp_f32 v201, v201
    v_exp_f32 v202, v202
    v_exp_f32 v203, v203
    v_cvt_pk_bf16_f32 v188, v188, v189
    v_cvt_pk_bf16_f32 v189, v190, v191
    v_cvt_pk_bf16_f32 v190, v200, v201
    v_cvt_pk_bf16_f32 v191, v202, v203
    v_pk_fma_f32 v[192:193], v[192:193], s[94:95], v[54:55] op_sel_hi:[1,1,0] neg_lo:[0,0,1] neg_hi:[0,0,1]
    v_pk_fma_f32 v[194:195], v[194:195], s[94:95], v[54:55] op_sel_hi:[1,1,0] neg_lo:[0,0,1] neg_hi:[0,0,1]
    v_pk_fma_f32 v[204:205], v[204:205], s[94:95], v[54:55] op_sel_hi:[1,1,0] neg_lo:[0,0,1] neg_hi:[0,0,1]
    v_pk_fma_f32 v[206:207], v[206:207], s[94:95], v[54:55] op_sel_hi:[1,1,0] neg_lo:[0,0,1] neg_hi:[0,0,1]
    v_exp_f32 v192, v192
    v_exp_f32 v193, v193
    v_exp_f32 v194, v194
    v_exp_f32 v195, v195
    v_exp_f32 v204, v204
    v_exp_f32 v205, v205
    v_exp_f32 v206, v206
    v_exp_f32 v207, v207
    v_cvt_pk_bf16_f32 v192, v192, v193
    v_cvt_pk_bf16_f32 v193, v194, v195
    v_cvt_pk_bf16_f32 v194, v204, v205
    v_cvt_pk_bf16_f32 v195, v206, v207
    v_pk_fma_f32 v[208:209], v[208:209], s[94:95], v[50:51] op_sel_hi:[1,1,0] neg_lo:[0,0,1] neg_hi:[0,0,1]
    v_pk_fma_f32 v[210:211], v[210:211], s[94:95], v[50:51] op_sel_hi:[1,1,0] neg_lo:[0,0,1] neg_hi:[0,0,1]
    v_pk_fma_f32 v[220:221], v[220:221], s[94:95], v[50:51] op_sel_hi:[1,1,0] neg_lo:[0,0,1] neg_hi:[0,0,1]
    v_pk_fma_f32 v[222:223], v[222:223], s[94:95], v[50:51] op_sel_hi:[1,1,0] neg_lo:[0,0,1] neg_hi:[0,0,1]
    v_exp_f32 v208, v208
    v_exp_f32 v209, v209
    v_exp_f32 v210, v210
    v_exp_f32 v211, v211
    v_exp_f32 v220, v220
    v_exp_f32 v221, v221
    v_exp_f32 v222, v222
    v_exp_f32 v223, v223
    v_cvt_pk_bf16_f32 v208, v208, v209
    v_cvt_pk_bf16_f32 v209, v210, v211
    v_cvt_pk_bf16_f32 v210, v220, v221
    v_cvt_pk_bf16_f32 v211, v222, v223
    v_pk_fma_f32 v[212:213], v[212:213], s[94:95], v[52:53] op_sel_hi:[1,1,0] neg_lo:[0,0,1] neg_hi:[0,0,1]
    v_pk_fma_f32 v[214:215], v[214:215], s[94:95], v[52:53] op_sel_hi:[1,1,0] neg_lo:[0,0,1] neg_hi:[0,0,1]
    v_pk_fma_f32 v[224:225], v[224:225], s[94:95], v[52:53] op_sel_hi:[1,1,0] neg_lo:[0,0,1] neg_hi:[0,0,1]
    v_pk_fma_f32 v[226:227], v[226:227], s[94:95], v[52:53] op_sel_hi:[1,1,0] neg_lo:[0,0,1] neg_hi:[0,0,1]
    v_exp_f32 v212, v212
    v_exp_f32 v213, v213
    v_exp_f32 v214, v214
    v_exp_f32 v215, v215
    v_exp_f32 v224, v224
    v_exp_f32 v225, v225
    v_exp_f32 v226, v226
    v_exp_f32 v227, v227
    v_cvt_pk_bf16_f32 v212, v212, v213
    v_cvt_pk_bf16_f32 v213, v214, v215
    v_cvt_pk_bf16_f32 v214, v224, v225
    v_cvt_pk_bf16_f32 v215, v226, v227
    v_pk_fma_f32 v[216:217], v[216:217], s[94:95], v[54:55] op_sel_hi:[1,1,0] neg_lo:[0,0,1] neg_hi:[0,0,1]
    v_pk_fma_f32 v[218:219], v[218:219], s[94:95], v[54:55] op_sel_hi:[1,1,0] neg_lo:[0,0,1] neg_hi:[0,0,1]
    v_pk_fma_f32 v[228:229], v[228:229], s[94:95], v[54:55] op_sel_hi:[1,1,0] neg_lo:[0,0,1] neg_hi:[0,0,1]
    v_pk_fma_f32 v[230:231], v[230:231], s[94:95], v[54:55] op_sel_hi:[1,1,0] neg_lo:[0,0,1] neg_hi:[0,0,1]
    v_exp_f32 v216, v216
    v_exp_f32 v217, v217
    v_exp_f32 v218, v218
    v_exp_f32 v219, v219
    v_exp_f32 v228, v228
    v_exp_f32 v229, v229
    v_exp_f32 v230, v230
    v_exp_f32 v231, v231
    v_cvt_pk_bf16_f32 v216, v216, v217
    v_cvt_pk_bf16_f32 v217, v218, v219
    v_cvt_pk_bf16_f32 v218, v228, v229
    v_cvt_pk_bf16_f32 v219, v230, v231
    v_pk_fma_f32 v[232:233], v[232:233], s[94:95], v[50:51] op_sel_hi:[1,1,0] neg_lo:[0,0,1] neg_hi:[0,0,1]
    v_pk_fma_f32 v[234:235], v[234:235], s[94:95], v[50:51] op_sel_hi:[1,1,0] neg_lo:[0,0,1] neg_hi:[0,0,1]
    v_pk_fma_f32 v[244:245], v[244:245], s[94:95], v[50:51] op_sel_hi:[1,1,0] neg_lo:[0,0,1] neg_hi:[0,0,1]
    v_pk_fma_f32 v[246:247], v[246:247], s[94:95], v[50:51] op_sel_hi:[1,1,0] neg_lo:[0,0,1] neg_hi:[0,0,1]
    v_exp_f32 v232, v232
    v_exp_f32 v233, v233
    v_exp_f32 v234, v234
    v_exp_f32 v235, v235
    v_exp_f32 v244, v244
    v_exp_f32 v245, v245
    v_exp_f32 v246, v246
    v_exp_f32 v247, v247
    v_cvt_pk_bf16_f32 v232, v232, v233
    v_cvt_pk_bf16_f32 v233, v234, v235
    v_cvt_pk_bf16_f32 v234, v244, v245
    v_cvt_pk_bf16_f32 v235, v246, v247
    v_pk_fma_f32 v[236:237], v[236:237], s[94:95], v[52:53] op_sel_hi:[1,1,0] neg_lo:[0,0,1] neg_hi:[0,0,1]
    v_pk_fma_f32 v[238:239], v[238:239], s[94:95], v[52:53] op_sel_hi:[1,1,0] neg_lo:[0,0,1] neg_hi:[0,0,1]
    v_pk_fma_f32 v[248:249], v[248:249], s[94:95], v[52:53] op_sel_hi:[1,1,0] neg_lo:[0,0,1] neg_hi:[0,0,1]
    v_pk_fma_f32 v[250:251], v[250:251], s[94:95], v[52:53] op_sel_hi:[1,1,0] neg_lo:[0,0,1] neg_hi:[0,0,1]
    v_exp_f32 v236, v236
    v_exp_f32 v237, v237
    v_exp_f32 v238, v238
    v_exp_f32 v239, v239
    v_exp_f32 v248, v248
    v_exp_f32 v249, v249
    v_exp_f32 v250, v250
    v_exp_f32 v251, v251
    v_cvt_pk_bf16_f32 v236, v236, v237
    v_cvt_pk_bf16_f32 v237, v238, v239
    v_cvt_pk_bf16_f32 v238, v248, v249
    v_cvt_pk_bf16_f32 v239, v250, v251
    v_pk_fma_f32 v[240:241], v[240:241], s[94:95], v[54:55] op_sel_hi:[1,1,0] neg_lo:[0,0,1] neg_hi:[0,0,1]
    v_pk_fma_f32 v[242:243], v[242:243], s[94:95], v[54:55] op_sel_hi:[1,1,0] neg_lo:[0,0,1] neg_hi:[0,0,1]
    v_pk_fma_f32 v[252:253], v[252:253], s[94:95], v[54:55] op_sel_hi:[1,1,0] neg_lo:[0,0,1] neg_hi:[0,0,1]
    v_pk_fma_f32 v[254:255], v[254:255], s[94:95], v[54:55] op_sel_hi:[1,1,0] neg_lo:[0,0,1] neg_hi:[0,0,1]
    v_exp_f32 v240, v240
    v_exp_f32 v241, v241
    v_exp_f32 v242, v242
    v_exp_f32 v243, v243
    v_exp_f32 v252, v252
    v_exp_f32 v253, v253
    v_exp_f32 v254, v254
    v_exp_f32 v255, v255
    v_cvt_pk_bf16_f32 v240, v240, v241
    v_cvt_pk_bf16_f32 v241, v242, v243
    v_cvt_pk_bf16_f32 v242, v252, v253
    v_cvt_pk_bf16_f32 v243, v254, v255
    s_waitcnt vmcnt(9)
    s_barrier
    ds_read_b64_tr_b16 a[216:217], v31 offset:16384
    ds_read_b64_tr_b16 a[218:219], v31 offset:18432
    ds_read_b64_tr_b16 a[220:221], v33 offset:16384
    ds_read_b64_tr_b16 a[222:223], v33 offset:18432
    ds_read_b64_tr_b16 a[224:225], v35 offset:16384
    ds_read_b64_tr_b16 a[226:227], v35 offset:18432
    ds_read_b64_tr_b16 a[228:229], v37 offset:16384
    ds_read_b64_tr_b16 a[230:231], v37 offset:18432
    s_waitcnt lgkmcnt(6)
    v_mfma_f32_16x16x32_bf16 v[76:79], a[216:219], v[64:67], 0
    ds_read_b64_tr_b16 a[232:233], v31 offset:20480
    s_add_u32 m0, s86, 114688
    v_mfma_f32_16x16x32_bf16 v[80:83], a[216:219], v[68:71], 0
    ds_read_b64_tr_b16 a[234:235], v31 offset:22528
    s_add_u32 s88, s67, s78
    v_mfma_f32_16x16x32_bf16 v[84:87], a[216:219], v[72:75], 0
    buffer_load_dwordx4 v14, s[52:55], s88 offen lds
    s_waitcnt lgkmcnt(6)
    v_mfma_f32_16x16x32_bf16 v[100:103], a[220:223], v[64:67], 0
    ds_read_b64_tr_b16 a[236:237], v33 offset:20480
    v_mfma_f32_16x16x32_bf16 v[104:107], a[220:223], v[68:71], 0
    ds_read_b64_tr_b16 a[238:239], v33 offset:22528
    v_mfma_f32_16x16x32_bf16 v[108:111], a[220:223], v[72:75], 0
    buffer_load_dwordx4 v15, s[52:55], s88 offen offset:1024 lds
    v_mfma_f32_16x16x32_bf16 v[220:223], a[248:251], v[64:67], 0
    v_mfma_f32_16x16x32_bf16 v[224:227], a[248:251], v[68:71], 0
    v_mfma_f32_16x16x32_bf16 v[228:231], a[248:251], v[72:75], 0
    buffer_load_dwordx4 v16, s[52:55], s88 offen offset:2048 lds
    s_waitcnt lgkmcnt(6)
    v_mfma_f32_16x16x32_bf16 v[124:127], a[224:227], v[64:67], 0
    ds_read_b64_tr_b16 a[240:241], v35 offset:20480
    v_mfma_f32_16x16x32_bf16 v[128:131], a[224:227], v[68:71], 0
    ds_read_b64_tr_b16 a[242:243], v35 offset:22528
    v_mfma_f32_16x16x32_bf16 v[132:135], a[224:227], v[72:75], 0
    buffer_load_dwordx4 v17, s[52:55], s88 offen offset:3072 lds
    s_waitcnt lgkmcnt(6)
    v_mfma_f32_16x16x32_bf16 v[148:151], a[228:231], v[64:67], 0
    ds_read_b64_tr_b16 a[244:245], v37 offset:20480
    s_add_u32 m0, s86, 0
    v_mfma_f32_16x16x32_bf16 v[152:155], a[228:231], v[68:71], 0
    ds_read_b64_tr_b16 a[246:247], v37 offset:22528
    s_add_u32 s88, s69, s78
    v_mfma_f32_16x16x32_bf16 v[156:159], a[228:231], v[72:75], 0
    buffer_load_dwordx4 v14, s[52:55], s88 offen lds
    s_waitcnt lgkmcnt(6)
    s_barrier
    v_mfma_f32_16x16x32_bf16 v[76:79], a[232:235], v[88:91], v[76:79]
    ds_read_b64_tr_b16 a[216:217], v30 offset:16384
    v_mfma_f32_16x16x32_bf16 v[80:83], a[232:235], v[92:95], v[80:83]
    ds_read_b64_tr_b16 a[218:219], v30 offset:18432
    v_mfma_f32_16x16x32_bf16 v[84:87], a[232:235], v[96:99], v[84:87]
    buffer_load_dwordx4 v15, s[52:55], s88 offen offset:1024 lds
    s_waitcnt lgkmcnt(6)
    v_mfma_f32_16x16x32_bf16 v[100:103], a[236:239], v[88:91], v[100:103]
    ds_read_b64_tr_b16 a[220:221], v32 offset:16384
    v_mfma_f32_16x16x32_bf16 v[104:107], a[236:239], v[92:95], v[104:107]
    ds_read_b64_tr_b16 a[222:223], v32 offset:18432
    v_mfma_f32_16x16x32_bf16 v[108:111], a[236:239], v[96:99], v[108:111]
    buffer_load_dwordx4 v16, s[52:55], s88 offen offset:2048 lds
    v_mfma_f32_16x16x32_bf16 v[220:223], a[248:251], v[88:91], v[220:223]
    v_mfma_f32_16x16x32_bf16 v[224:227], a[248:251], v[92:95], v[224:227]
    v_mfma_f32_16x16x32_bf16 v[228:231], a[248:251], v[96:99], v[228:231]
    buffer_load_dwordx4 v17, s[52:55], s88 offen offset:3072 lds
    s_waitcnt lgkmcnt(6)
    v_mfma_f32_16x16x32_bf16 v[124:127], a[240:243], v[88:91], v[124:127]
    ds_read_b64_tr_b16 a[224:225], v34 offset:16384
    v_mfma_f32_16x16x32_bf16 v[128:131], a[240:243], v[92:95], v[128:131]
    ds_read_b64_tr_b16 a[226:227], v34 offset:18432
    v_mfma_f32_16x16x32_bf16 v[132:135], a[240:243], v[96:99], v[132:135]
    s_waitcnt lgkmcnt(6)
    v_mfma_f32_16x16x32_bf16 v[148:151], a[244:247], v[88:91], v[148:151]
    ds_read_b64_tr_b16 a[228:229], v36 offset:16384
    v_mfma_f32_16x16x32_bf16 v[152:155], a[244:247], v[92:95], v[152:155]
    ds_read_b64_tr_b16 a[230:231], v36 offset:18432
    v_mfma_f32_16x16x32_bf16 v[156:159], a[244:247], v[96:99], v[156:159]
    s_waitcnt lgkmcnt(6)
    v_mfma_f32_16x16x32_bf16 v[76:79], a[216:219], v[112:115], v[76:79]
    ds_read_b64_tr_b16 a[232:233], v30 offset:20480
    v_mfma_f32_16x16x32_bf16 v[80:83], a[216:219], v[116:119], v[80:83]
    ds_read_b64_tr_b16 a[234:235], v30 offset:22528
    v_mfma_f32_16x16x32_bf16 v[84:87], a[216:219], v[120:123], v[84:87]
    s_waitcnt lgkmcnt(6)
    v_mfma_f32_16x16x32_bf16 v[100:103], a[220:223], v[112:115], v[100:103]
    ds_read_b64_tr_b16 a[236:237], v32 offset:20480
    v_mfma_f32_16x16x32_bf16 v[104:107], a[220:223], v[116:119], v[104:107]
    ds_read_b64_tr_b16 a[238:239], v32 offset:22528
    v_mfma_f32_16x16x32_bf16 v[108:111], a[220:223], v[120:123], v[108:111]
    v_mfma_f32_16x16x32_bf16 v[220:223], a[248:251], v[112:115], v[220:223]
    v_mfma_f32_16x16x32_bf16 v[224:227], a[248:251], v[116:119], v[224:227]
    v_mfma_f32_16x16x32_bf16 v[228:231], a[248:251], v[120:123], v[228:231]
    s_waitcnt lgkmcnt(6)
    v_mfma_f32_16x16x32_bf16 v[124:127], a[224:227], v[112:115], v[124:127]
    ds_read_b64_tr_b16 a[240:241], v34 offset:20480
    v_mfma_f32_16x16x32_bf16 v[128:131], a[224:227], v[116:119], v[128:131]
    ds_read_b64_tr_b16 a[242:243], v34 offset:22528
    v_mfma_f32_16x16x32_bf16 v[132:135], a[224:227], v[120:123], v[132:135]
    s_waitcnt lgkmcnt(6)
    v_mfma_f32_16x16x32_bf16 v[148:151], a[228:231], v[112:115], v[148:151]
    ds_read_b64_tr_b16 a[244:245], v36 offset:20480
    v_mfma_f32_16x16x32_bf16 v[152:155], a[228:231], v[116:119], v[152:155]
    ds_read_b64_tr_b16 a[246:247], v36 offset:22528
    v_mfma_f32_16x16x32_bf16 v[156:159], a[228:231], v[120:123], v[156:159]
    s_waitcnt lgkmcnt(6)
    s_waitcnt vmcnt(8)
    s_barrier
    v_mfma_f32_16x16x32_bf16 v[76:79], a[232:235], v[136:139], v[76:79]
    ds_read_b64_tr_b16 a[216:217], v31 offset:32768
    v_mfma_f32_16x16x32_bf16 v[80:83], a[232:235], v[140:143], v[80:83]
    ds_read_b64_tr_b16 a[218:219], v31 offset:34816
    v_mfma_f32_16x16x32_bf16 v[84:87], a[232:235], v[144:147], v[84:87]
    s_waitcnt lgkmcnt(6)
    v_mfma_f32_16x16x32_bf16 v[100:103], a[236:239], v[136:139], v[100:103]
    ds_read_b64_tr_b16 a[220:221], v33 offset:32768
    v_mfma_f32_16x16x32_bf16 v[104:107], a[236:239], v[140:143], v[104:107]
    ds_read_b64_tr_b16 a[222:223], v33 offset:34816
    v_mfma_f32_16x16x32_bf16 v[108:111], a[236:239], v[144:147], v[108:111]
    v_mfma_f32_16x16x32_bf16 v[220:223], a[248:251], v[136:139], v[220:223]
    v_mfma_f32_16x16x32_bf16 v[224:227], a[248:251], v[140:143], v[224:227]
    v_mfma_f32_16x16x32_bf16 v[228:231], a[248:251], v[144:147], v[228:231]
    s_waitcnt lgkmcnt(6)
    v_mfma_f32_16x16x32_bf16 v[124:127], a[240:243], v[136:139], v[124:127]
    ds_read_b64_tr_b16 a[224:225], v35 offset:32768
    v_mfma_f32_16x16x32_bf16 v[128:131], a[240:243], v[140:143], v[128:131]
    ds_read_b64_tr_b16 a[226:227], v35 offset:34816
    v_mfma_f32_16x16x32_bf16 v[132:135], a[240:243], v[144:147], v[132:135]
    s_waitcnt lgkmcnt(6)
    v_mfma_f32_16x16x32_bf16 v[148:151], a[244:247], v[136:139], v[148:151]
    ds_read_b64_tr_b16 a[228:229], v37 offset:32768
    v_mfma_f32_16x16x32_bf16 v[152:155], a[244:247], v[140:143], v[152:155]
    ds_read_b64_tr_b16 a[230:231], v37 offset:34816
    v_mfma_f32_16x16x32_bf16 v[156:159], a[244:247], v[144:147], v[156:159]
    s_waitcnt lgkmcnt(6)
    v_mfma_f32_16x16x32_bf16 v[76:79], a[216:219], v[160:163], v[76:79]
    ds_read_b64_tr_b16 a[232:233], v31 offset:36864
    s_add_u32 m0, s86, 32768
    v_mfma_f32_16x16x32_bf16 v[80:83], a[216:219], v[164:167], v[80:83]
    ds_read_b64_tr_b16 a[234:235], v31 offset:38912
    s_add_u32 s88, s68, s78
    v_mfma_f32_16x16x32_bf16 v[84:87], a[216:219], v[168:171], v[84:87]
    buffer_load_dwordx4 v14, s[52:55], s88 offen lds
    s_waitcnt lgkmcnt(6)
    v_mfma_f32_16x16x32_bf16 v[100:103], a[220:223], v[160:163], v[100:103]
    ds_read_b64_tr_b16 a[236:237], v33 offset:36864
    v_mfma_f32_16x16x32_bf16 v[104:107], a[220:223], v[164:167], v[104:107]
    ds_read_b64_tr_b16 a[238:239], v33 offset:38912
    v_mfma_f32_16x16x32_bf16 v[108:111], a[220:223], v[168:171], v[108:111]
    buffer_load_dwordx4 v15, s[52:55], s88 offen offset:1024 lds
    v_mfma_f32_16x16x32_bf16 v[220:223], a[248:251], v[160:163], v[220:223]
    v_mfma_f32_16x16x32_bf16 v[224:227], a[248:251], v[164:167], v[224:227]
    v_mfma_f32_16x16x32_bf16 v[228:231], a[248:251], v[168:171], v[228:231]
    buffer_load_dwordx4 v16, s[52:55], s88 offen offset:2048 lds
    s_waitcnt lgkmcnt(6)
    v_mfma_f32_16x16x32_bf16 v[124:127], a[224:227], v[160:163], v[124:127]
    ds_read_b64_tr_b16 a[240:241], v35 offset:36864
    v_mfma_f32_16x16x32_bf16 v[128:131], a[224:227], v[164:167], v[128:131]
    ds_read_b64_tr_b16 a[242:243], v35 offset:38912
    v_mfma_f32_16x16x32_bf16 v[132:135], a[224:227], v[168:171], v[132:135]
    buffer_load_dwordx4 v17, s[52:55], s88 offen offset:3072 lds
    s_waitcnt lgkmcnt(6)
    v_mfma_f32_16x16x32_bf16 v[148:151], a[228:231], v[160:163], v[148:151]
    ds_read_b64_tr_b16 a[244:245], v37 offset:36864
    v_mfma_f32_16x16x32_bf16 v[152:155], a[228:231], v[164:167], v[152:155]
    ds_read_b64_tr_b16 a[246:247], v37 offset:38912
    v_mfma_f32_16x16x32_bf16 v[156:159], a[228:231], v[168:171], v[156:159]
    s_waitcnt lgkmcnt(6)
    s_barrier
    v_mfma_f32_16x16x32_bf16 v[76:79], a[232:235], v[184:187], v[76:79]
    ds_read_b64_tr_b16 a[216:217], v35 offset:0
    v_mfma_f32_16x16x32_bf16 v[80:83], a[232:235], v[188:191], v[80:83]
    ds_read_b64_tr_b16 a[218:219], v35 offset:2048
    v_mfma_f32_16x16x32_bf16 v[84:87], a[232:235], v[192:195], v[84:87]
    s_waitcnt lgkmcnt(6)
    v_mfma_f32_16x16x32_bf16 v[100:103], a[236:239], v[184:187], v[100:103]
    ds_read_b64_tr_b16 a[220:221], v37 offset:0
    v_mfma_f32_16x16x32_bf16 v[104:107], a[236:239], v[188:191], v[104:107]
    ds_read_b64_tr_b16 a[222:223], v37 offset:2048
    v_mfma_f32_16x16x32_bf16 v[108:111], a[236:239], v[192:195], v[108:111]
    v_mfma_f32_16x16x32_bf16 v[220:223], a[248:251], v[184:187], v[220:223]
    v_mfma_f32_16x16x32_bf16 v[224:227], a[248:251], v[188:191], v[224:227]
    v_mfma_f32_16x16x32_bf16 v[228:231], a[248:251], v[192:195], v[228:231]
    s_waitcnt lgkmcnt(6)
    v_mfma_f32_16x16x32_bf16 v[124:127], a[240:243], v[184:187], v[124:127]
    ds_read_b64_tr_b16 a[224:225], v31 offset:0
    v_mfma_f32_16x16x32_bf16 v[128:131], a[240:243], v[188:191], v[128:131]
    ds_read_b64_tr_b16 a[226:227], v31 offset:2048
    v_mfma_f32_16x16x32_bf16 v[132:135], a[240:243], v[192:195], v[132:135]
    s_waitcnt lgkmcnt(6)
    v_mfma_f32_16x16x32_bf16 v[148:151], a[244:247], v[184:187], v[148:151]
    ds_read_b64_tr_b16 a[228:229], v33 offset:0
    v_mfma_f32_16x16x32_bf16 v[152:155], a[244:247], v[188:191], v[152:155]
    ds_read_b64_tr_b16 a[230:231], v33 offset:2048
    v_mfma_f32_16x16x32_bf16 v[156:159], a[244:247], v[192:195], v[156:159]
    s_waitcnt lgkmcnt(6)
    v_mfma_f32_16x16x32_bf16 v[124:127], a[216:219], v[208:211], v[124:127]
    ds_read_b64_tr_b16 a[232:233], v35 offset:4096
    s_add_u32 m0, s86, 49152
    v_mfma_f32_16x16x32_bf16 v[128:131], a[216:219], v[212:215], v[128:131]
    ds_read_b64_tr_b16 a[234:235], v35 offset:6144
    s_add_u32 s88, s70, s78
    v_mfma_f32_16x16x32_bf16 v[132:135], a[216:219], v[216:219], v[132:135]
    buffer_load_dwordx4 v14, s[52:55], s88 offen lds
    s_waitcnt lgkmcnt(6)
    v_mfma_f32_16x16x32_bf16 v[148:151], a[220:223], v[208:211], v[148:151]
    ds_read_b64_tr_b16 a[236:237], v37 offset:4096
    v_mfma_f32_16x16x32_bf16 v[152:155], a[220:223], v[212:215], v[152:155]
    ds_read_b64_tr_b16 a[238:239], v37 offset:6144
    v_mfma_f32_16x16x32_bf16 v[156:159], a[220:223], v[216:219], v[156:159]
    buffer_load_dwordx4 v15, s[52:55], s88 offen offset:1024 lds
    s_waitcnt lgkmcnt(6)
    v_mfma_f32_16x16x32_bf16 v[76:79], a[224:227], v[208:211], v[76:79]
    ds_read_b64_tr_b16 a[240:241], v31 offset:4096
    v_mfma_f32_16x16x32_bf16 v[80:83], a[224:227], v[212:215], v[80:83]
    ds_read_b64_tr_b16 a[242:243], v31 offset:6144
    v_mfma_f32_16x16x32_bf16 v[84:87], a[224:227], v[216:219], v[84:87]
    buffer_load_dwordx4 v16, s[52:55], s88 offen offset:2048 lds
    s_waitcnt lgkmcnt(6)
    v_mfma_f32_16x16x32_bf16 v[100:103], a[228:231], v[208:211], v[100:103]
    ds_read_b64_tr_b16 a[244:245], v33 offset:4096
    v_mfma_f32_16x16x32_bf16 v[104:107], a[228:231], v[212:215], v[104:107]
    ds_read_b64_tr_b16 a[246:247], v33 offset:6144
    v_mfma_f32_16x16x32_bf16 v[108:111], a[228:231], v[216:219], v[108:111]
    buffer_load_dwordx4 v17, s[52:55], s88 offen offset:3072 lds
    v_mfma_f32_16x16x32_bf16 v[220:223], a[248:251], v[208:211], v[220:223]
    s_add_u32 m0, s86, 81920
    s_add_u32 s88, s82, s75
    v_mfma_f32_16x16x32_bf16 v[224:227], a[248:251], v[212:215], v[224:227]
    v_mfma_f32_16x16x32_bf16 v[228:231], a[248:251], v[216:219], v[228:231]
    buffer_load_dwordx4 v10, s[48:51], s88 offen nt lds
    s_waitcnt lgkmcnt(6)
    s_waitcnt vmcnt(13)
    s_barrier
    v_mfma_f32_16x16x32_bf16 v[124:127], a[232:235], v[232:235], v[124:127]
    ds_read_b64_tr_b16 a[216:217], v39 offset:49152
    v_mfma_f32_16x16x32_bf16 v[128:131], a[232:235], v[236:239], v[128:131]
    ds_read_b64_tr_b16 a[218:219], v39 offset:51200
    v_mfma_f32_16x16x32_bf16 v[132:135], a[232:235], v[240:243], v[132:135]
    buffer_load_dwordx4 v11, s[48:51], s88 offen offset:1024 nt lds
    s_waitcnt lgkmcnt(6)
    v_mfma_f32_16x16x32_bf16 v[148:151], a[236:239], v[232:235], v[148:151]
    ds_read_b64_tr_b16 a[220:221], v39 offset:53248
    v_mfma_f32_16x16x32_bf16 v[152:155], a[236:239], v[236:239], v[152:155]
    ds_read_b64_tr_b16 a[222:223], v39 offset:55296
    v_mfma_f32_16x16x32_bf16 v[156:159], a[236:239], v[240:243], v[156:159]
    buffer_load_dwordx4 v12, s[48:51], s88 offen offset:2048 nt lds
    s_waitcnt lgkmcnt(6)
    v_mfma_f32_16x16x32_bf16 v[76:79], a[240:243], v[232:235], v[76:79]
    ds_read_b64_tr_b16 a[224:225], v39 offset:57344
    ds_write_b128 v40, v[124:127] offset:0
    v_mfma_f32_16x16x32_bf16 v[80:83], a[240:243], v[236:239], v[80:83]
    ds_read_b64_tr_b16 a[226:227], v39 offset:59392
    ds_write_b128 v40, v[128:131] offset:1024
    v_mfma_f32_16x16x32_bf16 v[84:87], a[240:243], v[240:243], v[84:87]
    buffer_load_dwordx4 v13, s[48:51], s88 offen offset:3072 nt lds
    s_waitcnt lgkmcnt(8)
    v_mfma_f32_16x16x32_bf16 v[100:103], a[244:247], v[232:235], v[100:103]
    ds_read_b64_tr_b16 a[228:229], v39 offset:61440
    s_add_u32 m0, s86, 16384
    v_mfma_f32_16x16x32_bf16 v[104:107], a[244:247], v[236:239], v[104:107]
    ds_read_b64_tr_b16 a[230:231], v39 offset:63488
    s_add_u32 s88, s83, s75
    v_mfma_f32_16x16x32_bf16 v[108:111], a[244:247], v[240:243], v[108:111]
    buffer_load_dwordx4 v10, s[48:51], s88 offen nt lds
    v_mfma_f32_16x16x32_bf16 v[220:223], a[248:251], v[232:235], v[220:223]
    ds_write_b128 v40, v[132:135] offset:2048
    ds_write_b128 v40, v[148:151] offset:3072
    v_mfma_f32_16x16x32_bf16 v[224:227], a[248:251], v[236:239], v[224:227]
    ds_write_b128 v40, v[152:155] offset:4096
    ds_write_b128 v40, v[156:159] offset:5120
    v_mfma_f32_16x16x32_bf16 v[228:231], a[248:251], v[240:243], v[228:231]
    buffer_load_dwordx4 v11, s[48:51], s88 offen offset:1024 nt lds
    s_mul_i32 s96, s87, 1536
    v_lshlrev_b32 v56, 2, v1
    v_add_u32 v56, s96, v56
    v_add_u32 v56, 155648, v56
    ds_write_b32 v56, v50 offset:0
    ds_write_b32 v56, v220 offset:768
    ds_write_b32 v56, v52 offset:256
    ds_write_b32 v56, v224 offset:1024
    ds_write_b32 v56, v54 offset:512
    ds_write_b32 v56, v228 offset:1280
    s_waitcnt lgkmcnt(0)
    s_barrier
    s_xor_b32 s96, s87, 1
    buffer_load_dwordx4 v12, s[48:51], s88 offen offset:2048 nt lds
    s_mul_i32 s96, s96, 1536
    v_lshlrev_b32 v56, 2, v1
    v_add_u32 v56, s96, v56
    v_add_u32 v56, 155648, v56
    ds_read_b32 v57, v56 offset:0
    ds_read_b32 v58, v56 offset:256
    ds_read_b32 v59, v56 offset:512
    ds_read_b32 v60, v56 offset:768
    ds_read_b32 v61, v56 offset:1024
    ds_read_b32 v62, v56 offset:1280
    s_waitcnt lgkmcnt(0)
    buffer_load_dwordx4 v13, s[48:51], s88 offen offset:3072 nt lds
    s_add_u32 m0, s86, 98304
    s_add_u32 s88, s73, s78
    v_max_f32 v56, v50, v57
    v_sub_f32 v50, v50, v56
    v_sub_f32 v57, v57, v56
    v_exp_f32 v50, v50
    v_exp_f32 v57, v57
    s_nop 0
    v_mul_f32 v60, v60, v57
    v_fma_f32 v60, v220, v50, v60
    v_rcp_f32 v60, v60
    s_nop 0
    v_mul_f32 v44, v50, v60
    v_mul_f32 v45, v57, v60
    v_max_f32 v56, v52, v58
    buffer_load_dwordx4 v14, s[52:55], s88 offen lds
    v_sub_f32 v52, v52, v56
    v_sub_f32 v58, v58, v56
    v_exp_f32 v52, v52
    v_exp_f32 v58, v58
    s_nop 0
    v_mul_f32 v61, v61, v58
    v_fma_f32 v61, v224, v52, v61
    v_rcp_f32 v61, v61
    s_nop 0
    v_mul_f32 v46, v52, v61
    v_mul_f32 v47, v58, v61
    v_max_f32 v56, v54, v59
    v_sub_f32 v54, v54, v56
    buffer_load_dwordx4 v15, s[52:55], s88 offen offset:1024 lds
    v_sub_f32 v59, v59, v56
    v_exp_f32 v54, v54
    v_exp_f32 v59, v59
    s_nop 0
    v_mul_f32 v62, v62, v59
    v_fma_f32 v62, v228, v54, v62
    v_rcp_f32 v62, v62
    s_nop 0
    v_mul_f32 v48, v54, v62
    v_mul_f32 v49, v59, v62
    ds_read_b128 v[172:175], v41 offset:0
    ds_read_b128 v[196:199], v41 offset:3072
    ds_read_b128 v[176:179], v41 offset:1024
    buffer_load_dwordx4 v16, s[52:55], s88 offen offset:2048 lds
    ds_read_b128 v[200:203], v41 offset:4096
    ds_read_b128 v[180:183], v41 offset:2048
    ds_read_b128 v[204:207], v41 offset:5120
    v_pk_mul_f32 v[76:77], v[76:77], v[44:45] op_sel_hi:[1,0]
    v_pk_mul_f32 v[78:79], v[78:79], v[44:45] op_sel_hi:[1,0]
    v_pk_mul_f32 v[100:101], v[100:101], v[44:45] op_sel_hi:[1,0]
    v_pk_mul_f32 v[102:103], v[102:103], v[44:45] op_sel_hi:[1,0]
    v_pk_mul_f32 v[80:81], v[80:81], v[46:47] op_sel_hi:[1,0]
    v_pk_mul_f32 v[82:83], v[82:83], v[46:47] op_sel_hi:[1,0]
    v_pk_mul_f32 v[104:105], v[104:105], v[46:47] op_sel_hi:[1,0]
    v_pk_mul_f32 v[106:107], v[106:107], v[46:47] op_sel_hi:[1,0]
    buffer_load_dwordx4 v17, s[52:55], s88 offen offset:3072 lds
    v_pk_mul_f32 v[84:85], v[84:85], v[48:49] op_sel_hi:[1,0]
    v_pk_mul_f32 v[86:87], v[86:87], v[48:49] op_sel_hi:[1,0]
    v_pk_mul_f32 v[108:109], v[108:109], v[48:49] op_sel_hi:[1,0]
    v_pk_mul_f32 v[110:111], v[110:111], v[48:49] op_sel_hi:[1,0]
    s_waitcnt lgkmcnt(5)
    v_pk_fma_f32 v[76:77], v[172:173], v[44:45], v[76:77] op_sel:[0,1,0] op_sel_hi:[1,1,1]
    v_pk_fma_f32 v[78:79], v[174:175], v[44:45], v[78:79] op_sel:[0,1,0] op_sel_hi:[1,1,1]
    s_waitcnt lgkmcnt(4)
    v_pk_fma_f32 v[100:101], v[196:197], v[44:45], v[100:101] op_sel:[0,1,0] op_sel_hi:[1,1,1]
    v_pk_fma_f32 v[102:103], v[198:199], v[44:45], v[102:103] op_sel:[0,1,0] op_sel_hi:[1,1,1]
    v_cvt_pk_bf16_f32 v172, v76, v77
    v_cvt_pk_bf16_f32 v173, v78, v79
    v_cvt_pk_bf16_f32 v174, v100, v101
    v_cvt_pk_bf16_f32 v175, v102, v103
    ds_write_b128 v41, v[172:175] offset:0
    s_waitcnt lgkmcnt(4)
    v_pk_fma_f32 v[80:81], v[176:177], v[46:47], v[80:81] op_sel:[0,1,0] op_sel_hi:[1,1,1]
    v_pk_fma_f32 v[82:83], v[178:179], v[46:47], v[82:83] op_sel:[0,1,0] op_sel_hi:[1,1,1]
    s_waitcnt lgkmcnt(3)
    v_pk_fma_f32 v[104:105], v[200:201], v[46:47], v[104:105] op_sel:[0,1,0] op_sel_hi:[1,1,1]
    v_pk_fma_f32 v[106:107], v[202:203], v[46:47], v[106:107] op_sel:[0,1,0] op_sel_hi:[1,1,1]
    v_cvt_pk_bf16_f32 v176, v80, v81
    v_cvt_pk_bf16_f32 v177, v82, v83
    v_cvt_pk_bf16_f32 v178, v104, v105
    v_cvt_pk_bf16_f32 v179, v106, v107
    ds_write_b128 v41, v[176:179] offset:1024
    s_waitcnt lgkmcnt(3)
    v_pk_fma_f32 v[84:85], v[180:181], v[48:49], v[84:85] op_sel:[0,1,0] op_sel_hi:[1,1,1]
    v_pk_fma_f32 v[86:87], v[182:183], v[48:49], v[86:87] op_sel:[0,1,0] op_sel_hi:[1,1,1]
    s_waitcnt lgkmcnt(2)
    v_pk_fma_f32 v[108:109], v[204:205], v[48:49], v[108:109] op_sel:[0,1,0] op_sel_hi:[1,1,1]
    v_pk_fma_f32 v[110:111], v[206:207], v[48:49], v[110:111] op_sel:[0,1,0] op_sel_hi:[1,1,1]
    v_cvt_pk_bf16_f32 v180, v84, v85
    v_cvt_pk_bf16_f32 v181, v86, v87
    v_cvt_pk_bf16_f32 v182, v108, v109
    v_cvt_pk_bf16_f32 v183, v110, v111
    ds_write_b128 v41, v[180:183] offset:2048
    s_waitcnt lgkmcnt(0)
    s_barrier
    ds_read_b128 a[84:87], v42 offset:6144
    ds_read_b128 a[88:91], v42 offset:7168
    ds_read_b128 a[92:95], v42 offset:8192
    ds_read_b128 a[96:99], v42 offset:0
    ds_read_b128 a[100:103], v42 offset:1024
    ds_read_b128 a[104:107], v42 offset:2048
    ds_read_b128 a[108:111], v42 offset:18432
    ds_read_b128 a[112:115], v42 offset:19456
    ds_read_b128 a[116:119], v42 offset:20480
    ds_read_b128 a[120:123], v42 offset:12288
    ds_read_b128 a[124:127], v42 offset:13312
    ds_read_b128 a[128:131], v42 offset:14336
    s_waitcnt lgkmcnt(0)
    s_waitcnt vmcnt(16)
    s_barrier
    v_mfma_f32_16x16x32_bf16 a[0:3], a[216:219], a[84:87], 0
    ds_read_b64_tr_b16 a[232:233], v38 offset:32768
    s_add_u32 m0, s86, 65536
    v_mfma_f32_16x16x32_bf16 a[4:7], a[216:219], a[88:91], 0
    ds_read_b64_tr_b16 a[234:235], v38 offset:34816
    s_add_u32 s88, s71, s78
    v_mfma_f32_16x16x32_bf16 a[8:11], a[216:219], a[92:95], 0
    buffer_load_dwordx4 v14, s[52:55], s88 offen lds
    v_mfma_f32_16x16x32_bf16 a[0:3], a[220:223], a[96:99], a[0:3]
    ds_read_b64_tr_b16 a[236:237], v38 offset:36864
    v_mfma_f32_16x16x32_bf16 a[4:7], a[220:223], a[100:103], a[4:7]
    ds_read_b64_tr_b16 a[238:239], v38 offset:38912
    v_mfma_f32_16x16x32_bf16 a[8:11], a[220:223], a[104:107], a[8:11]
    buffer_load_dwordx4 v15, s[52:55], s88 offen offset:1024 lds
    v_mfma_f32_16x16x32_bf16 a[0:3], a[224:227], a[108:111], a[0:3]
    ds_read_b64_tr_b16 a[240:241], v38 offset:40960
    v_mfma_f32_16x16x32_bf16 a[4:7], a[224:227], a[112:115], a[4:7]
    ds_read_b64_tr_b16 a[242:243], v38 offset:43008
    v_mfma_f32_16x16x32_bf16 a[8:11], a[224:227], a[116:119], a[8:11]
    buffer_load_dwordx4 v16, s[52:55], s88 offen offset:2048 lds
    v_mfma_f32_16x16x32_bf16 a[0:3], a[228:231], a[120:123], a[0:3]
    ds_read_b64_tr_b16 a[244:245], v38 offset:45056
    v_mfma_f32_16x16x32_bf16 a[4:7], a[228:231], a[124:127], a[4:7]
    ds_read_b64_tr_b16 a[246:247], v38 offset:47104
    v_mfma_f32_16x16x32_bf16 a[8:11], a[228:231], a[128:131], a[8:11]
    buffer_load_dwordx4 v17, s[52:55], s88 offen offset:3072 lds
    s_waitcnt lgkmcnt(6)
    s_barrier
    v_mfma_f32_16x16x32_bf16 a[12:15], a[232:235], a[84:87], 0
    ds_read_b64_tr_b16 a[216:217], v38 offset:0
    s_add_u32 m0, s86, 114688
    v_mfma_f32_16x16x32_bf16 a[16:19], a[232:235], a[88:91], 0
    ds_read_b64_tr_b16 a[218:219], v38 offset:2048
    s_add_u32 s88, s72, s78
    v_mfma_f32_16x16x32_bf16 a[20:23], a[232:235], a[92:95], 0
    buffer_load_dwordx4 v14, s[52:55], s88 offen lds
    s_waitcnt lgkmcnt(6)
    v_mfma_f32_16x16x32_bf16 a[12:15], a[236:239], a[96:99], a[12:15]
    ds_read_b64_tr_b16 a[220:221], v38 offset:4096
    v_mfma_f32_16x16x32_bf16 a[16:19], a[236:239], a[100:103], a[16:19]
    ds_read_b64_tr_b16 a[222:223], v38 offset:6144
    v_mfma_f32_16x16x32_bf16 a[20:23], a[236:239], a[104:107], a[20:23]
    buffer_load_dwordx4 v15, s[52:55], s88 offen offset:1024 lds
    s_waitcnt lgkmcnt(6)
    v_mfma_f32_16x16x32_bf16 a[12:15], a[240:243], a[108:111], a[12:15]
    ds_read_b64_tr_b16 a[224:225], v38 offset:8192
    v_mfma_f32_16x16x32_bf16 a[16:19], a[240:243], a[112:115], a[16:19]
    ds_read_b64_tr_b16 a[226:227], v38 offset:10240
    v_mfma_f32_16x16x32_bf16 a[20:23], a[240:243], a[116:119], a[20:23]
    buffer_load_dwordx4 v16, s[52:55], s88 offen offset:2048 lds
    s_waitcnt lgkmcnt(6)
    v_mfma_f32_16x16x32_bf16 a[12:15], a[244:247], a[120:123], a[12:15]
    ds_read_b64_tr_b16 a[228:229], v38 offset:12288
    v_mfma_f32_16x16x32_bf16 a[16:19], a[244:247], a[124:127], a[16:19]
    ds_read_b64_tr_b16 a[230:231], v38 offset:14336
    v_mfma_f32_16x16x32_bf16 a[20:23], a[244:247], a[128:131], a[20:23]
    buffer_load_dwordx4 v17, s[52:55], s88 offen offset:3072 lds
    s_waitcnt lgkmcnt(6)
    s_waitcnt vmcnt(20)
    s_barrier
    v_mfma_f32_16x16x32_bf16 a[24:27], a[216:219], a[84:87], 0
    ds_read_b64_tr_b16 a[232:233], v38 offset:49152
    s_add_u32 m0, s86, 32768
    v_mfma_f32_16x16x32_bf16 a[28:31], a[216:219], a[88:91], 0
    ds_read_b64_tr_b16 a[234:235], v38 offset:51200
    s_add_u32 s88, s84, s75
    v_mfma_f32_16x16x32_bf16 a[32:35], a[216:219], a[92:95], 0
    buffer_load_dwordx4 v10, s[48:51], s88 offen nt lds
    s_waitcnt lgkmcnt(6)
    v_mfma_f32_16x16x32_bf16 a[24:27], a[220:223], a[96:99], a[24:27]
    ds_read_b64_tr_b16 a[236:237], v38 offset:53248
    v_mfma_f32_16x16x32_bf16 a[28:31], a[220:223], a[100:103], a[28:31]
    ds_read_b64_tr_b16 a[238:239], v38 offset:55296
    v_mfma_f32_16x16x32_bf16 a[32:35], a[220:223], a[104:107], a[32:35]
    buffer_load_dwordx4 v11, s[48:51], s88 offen offset:1024 nt lds
    s_waitcnt lgkmcnt(6)
    v_mfma_f32_16x16x32_bf16 a[24:27], a[224:227], a[108:111], a[24:27]
    ds_read_b64_tr_b16 a[240:241], v38 offset:57344
    v_mfma_f32_16x16x32_bf16 a[28:31], a[224:227], a[112:115], a[28:31]
    ds_read_b64_tr_b16 a[242:243], v38 offset:59392
    v_mfma_f32_16x16x32_bf16 a[32:35], a[224:227], a[116:119], a[32:35]
    buffer_load_dwordx4 v12, s[48:51], s88 offen offset:2048 nt lds
    s_waitcnt lgkmcnt(6)
    v_mfma_f32_16x16x32_bf16 a[24:27], a[228:231], a[120:123], a[24:27]
    ds_read_b64_tr_b16 a[244:245], v38 offset:61440
    v_mfma_f32_16x16x32_bf16 a[28:31], a[228:231], a[124:127], a[28:31]
    ds_read_b64_tr_b16 a[246:247], v38 offset:63488
    v_mfma_f32_16x16x32_bf16 a[32:35], a[228:231], a[128:131], a[32:35]
    buffer_load_dwordx4 v13, s[48:51], s88 offen offset:3072 nt lds
    s_waitcnt lgkmcnt(6)
    s_waitcnt vmcnt(8)
    s_barrier
    v_mfma_f32_16x16x32_bf16 a[36:39], a[232:235], a[84:87], 0
    ds_read_b64_tr_b16 a[216:217], v39 offset:0
    s_add_u32 m0, s86, 0
    v_mfma_f32_16x16x32_bf16 a[40:43], a[232:235], a[88:91], 0
    ds_read_b64_tr_b16 a[218:219], v39 offset:2048
    s_add_u32 s88, s85, s75
    v_mfma_f32_16x16x32_bf16 a[44:47], a[232:235], a[92:95], 0
    buffer_load_dwordx4 v10, s[48:51], s88 offen nt lds
    s_waitcnt lgkmcnt(6)
    v_mfma_f32_16x16x32_bf16 a[36:39], a[236:239], a[96:99], a[36:39]
    ds_read_b64_tr_b16 a[220:221], v39 offset:4096
    v_mfma_f32_16x16x32_bf16 a[40:43], a[236:239], a[100:103], a[40:43]
    ds_read_b64_tr_b16 a[222:223], v39 offset:6144
    v_mfma_f32_16x16x32_bf16 a[44:47], a[236:239], a[104:107], a[44:47]
    buffer_load_dwordx4 v11, s[48:51], s88 offen offset:1024 nt lds
    s_waitcnt lgkmcnt(6)
    v_mfma_f32_16x16x32_bf16 a[36:39], a[240:243], a[108:111], a[36:39]
    ds_read_b64_tr_b16 a[224:225], v39 offset:8192
    v_mfma_f32_16x16x32_bf16 a[40:43], a[240:243], a[112:115], a[40:43]
    ds_read_b64_tr_b16 a[226:227], v39 offset:10240
    v_mfma_f32_16x16x32_bf16 a[44:47], a[240:243], a[116:119], a[44:47]
    buffer_load_dwordx4 v12, s[48:51], s88 offen offset:2048 nt lds
    s_waitcnt lgkmcnt(6)
    v_mfma_f32_16x16x32_bf16 a[36:39], a[244:247], a[120:123], a[36:39]
    ds_read_b64_tr_b16 a[228:229], v39 offset:12288
    v_mfma_f32_16x16x32_bf16 a[40:43], a[244:247], a[124:127], a[40:43]
    ds_read_b64_tr_b16 a[230:231], v39 offset:14336
    v_mfma_f32_16x16x32_bf16 a[44:47], a[244:247], a[128:131], a[44:47]
    buffer_load_dwordx4 v13, s[48:51], s88 offen offset:3072 nt lds
    s_waitcnt lgkmcnt(6)
    s_waitcnt vmcnt(8)
    s_barrier
    v_mfma_f32_16x16x32_bf16 a[48:51], a[216:219], a[84:87], 0
    ds_read_b64_tr_b16 a[232:233], v39 offset:49152
    v_mfma_f32_16x16x32_bf16 a[52:55], a[216:219], a[88:91], 0
    ds_read_b64_tr_b16 a[234:235], v39 offset:51200
    v_mfma_f32_16x16x32_bf16 a[56:59], a[216:219], a[92:95], 0
    s_waitcnt lgkmcnt(6)
    v_mfma_f32_16x16x32_bf16 a[48:51], a[220:223], a[96:99], a[48:51]
    ds_read_b64_tr_b16 a[236:237], v39 offset:53248
    v_mfma_f32_16x16x32_bf16 a[52:55], a[220:223], a[100:103], a[52:55]
    ds_read_b64_tr_b16 a[238:239], v39 offset:55296
    v_mfma_f32_16x16x32_bf16 a[56:59], a[220:223], a[104:107], a[56:59]
    s_waitcnt lgkmcnt(6)
    v_mfma_f32_16x16x32_bf16 a[48:51], a[224:227], a[108:111], a[48:51]
    ds_read_b64_tr_b16 a[240:241], v39 offset:57344
    v_mfma_f32_16x16x32_bf16 a[52:55], a[224:227], a[112:115], a[52:55]
    ds_read_b64_tr_b16 a[242:243], v39 offset:59392
    v_mfma_f32_16x16x32_bf16 a[56:59], a[224:227], a[116:119], a[56:59]
    s_waitcnt lgkmcnt(6)
    v_mfma_f32_16x16x32_bf16 a[48:51], a[228:231], a[120:123], a[48:51]
    ds_read_b64_tr_b16 a[244:245], v39 offset:61440
    v_mfma_f32_16x16x32_bf16 a[52:55], a[228:231], a[124:127], a[52:55]
    ds_read_b64_tr_b16 a[246:247], v39 offset:63488
    v_mfma_f32_16x16x32_bf16 a[56:59], a[228:231], a[128:131], a[56:59]
    s_waitcnt lgkmcnt(6)
    s_barrier
    v_mfma_f32_16x16x32_bf16 a[60:63], a[232:235], a[84:87], 0
    ds_read_b64_tr_b16 a[216:217], v39 offset:32768
    v_mfma_f32_16x16x32_bf16 a[64:67], a[232:235], a[88:91], 0
    ds_read_b64_tr_b16 a[218:219], v39 offset:34816
    v_mfma_f32_16x16x32_bf16 a[68:71], a[232:235], a[92:95], 0
    s_waitcnt lgkmcnt(6)
    v_mfma_f32_16x16x32_bf16 a[60:63], a[236:239], a[96:99], a[60:63]
    ds_read_b64_tr_b16 a[220:221], v39 offset:36864
    v_mfma_f32_16x16x32_bf16 a[64:67], a[236:239], a[100:103], a[64:67]
    ds_read_b64_tr_b16 a[222:223], v39 offset:38912
    v_mfma_f32_16x16x32_bf16 a[68:71], a[236:239], a[104:107], a[68:71]
    s_waitcnt lgkmcnt(6)
    v_mfma_f32_16x16x32_bf16 a[60:63], a[240:243], a[108:111], a[60:63]
    ds_read_b64_tr_b16 a[224:225], v39 offset:40960
    v_mfma_f32_16x16x32_bf16 a[64:67], a[240:243], a[112:115], a[64:67]
    ds_read_b64_tr_b16 a[226:227], v39 offset:43008
    v_mfma_f32_16x16x32_bf16 a[68:71], a[240:243], a[116:119], a[68:71]
    s_waitcnt lgkmcnt(6)
    v_mfma_f32_16x16x32_bf16 a[60:63], a[244:247], a[120:123], a[60:63]
    ds_read_b64_tr_b16 a[228:229], v39 offset:45056
    v_mfma_f32_16x16x32_bf16 a[64:67], a[244:247], a[124:127], a[64:67]
    ds_read_b64_tr_b16 a[230:231], v39 offset:47104
    v_mfma_f32_16x16x32_bf16 a[68:71], a[244:247], a[128:131], a[68:71]
    s_waitcnt lgkmcnt(6)
    s_barrier
    v_mfma_f32_16x16x32_bf16 a[72:75], a[216:219], a[84:87], 0
    ds_read_b64_tr_b16 a[232:233], v31 offset:16384
    s_add_u32 m0, s86, 49152
    v_mfma_f32_16x16x32_bf16 a[76:79], a[216:219], a[88:91], 0
    ds_read_b64_tr_b16 a[234:235], v31 offset:18432
    s_add_u32 s88, s67, s79
    v_mfma_f32_16x16x32_bf16 a[80:83], a[216:219], a[92:95], 0
    buffer_load_dwordx4 v14, s[52:55], s88 offen lds
    s_waitcnt lgkmcnt(6)
    v_mfma_f32_16x16x32_bf16 a[72:75], a[220:223], a[96:99], a[72:75]
    ds_read_b64_tr_b16 a[236:237], v33 offset:16384
    v_mfma_f32_16x16x32_bf16 a[76:79], a[220:223], a[100:103], a[76:79]
    ds_read_b64_tr_b16 a[238:239], v33 offset:18432
    v_mfma_f32_16x16x32_bf16 a[80:83], a[220:223], a[104:107], a[80:83]
    buffer_load_dwordx4 v15, s[52:55], s88 offen offset:1024 lds
    s_waitcnt lgkmcnt(6)
    v_mfma_f32_16x16x32_bf16 a[72:75], a[224:227], a[108:111], a[72:75]
    ds_read_b64_tr_b16 a[240:241], v35 offset:16384
    v_mfma_f32_16x16x32_bf16 a[76:79], a[224:227], a[112:115], a[76:79]
    ds_read_b64_tr_b16 a[242:243], v35 offset:18432
    v_mfma_f32_16x16x32_bf16 a[80:83], a[224:227], a[116:119], a[80:83]
    buffer_load_dwordx4 v16, s[52:55], s88 offen offset:2048 lds
    s_waitcnt lgkmcnt(6)
    v_mfma_f32_16x16x32_bf16 a[72:75], a[228:231], a[120:123], a[72:75]
    ds_read_b64_tr_b16 a[244:245], v37 offset:16384
    v_mfma_f32_16x16x32_bf16 a[76:79], a[228:231], a[124:127], a[76:79]
    ds_read_b64_tr_b16 a[246:247], v37 offset:18432
    v_mfma_f32_16x16x32_bf16 a[80:83], a[228:231], a[128:131], a[80:83]
    buffer_load_dwordx4 v17, s[52:55], s88 offen offset:3072 lds
    s_waitcnt lgkmcnt(6)
    v_mfma_f32_16x16x32_bf16 v[76:79], a[232:235], v[64:67], 0
    ds_read_b64_tr_b16 a[216:217], v31 offset:20480
    s_add_u32 m0, s86, 65536
    v_mfma_f32_16x16x32_bf16 v[80:83], a[232:235], v[68:71], 0
    ds_read_b64_tr_b16 a[218:219], v31 offset:22528
    s_add_u32 s88, s69, s79
    v_mfma_f32_16x16x32_bf16 v[84:87], a[232:235], v[72:75], 0
    buffer_load_dwordx4 v14, s[52:55], s88 offen lds
    s_waitcnt lgkmcnt(6)
    v_mfma_f32_16x16x32_bf16 v[100:103], a[236:239], v[64:67], 0
    ds_read_b64_tr_b16 a[220:221], v33 offset:20480
    v_mfma_f32_16x16x32_bf16 v[104:107], a[236:239], v[68:71], 0
    ds_read_b64_tr_b16 a[222:223], v33 offset:22528
    v_mfma_f32_16x16x32_bf16 v[108:111], a[236:239], v[72:75], 0
    buffer_load_dwordx4 v15, s[52:55], s88 offen offset:1024 lds
    s_waitcnt lgkmcnt(6)
    v_mfma_f32_16x16x32_bf16 v[124:127], a[240:243], v[64:67], 0
    ds_read_b64_tr_b16 a[224:225], v35 offset:20480
    v_mfma_f32_16x16x32_bf16 v[128:131], a[240:243], v[68:71], 0
    ds_read_b64_tr_b16 a[226:227], v35 offset:22528
    v_mfma_f32_16x16x32_bf16 v[132:135], a[240:243], v[72:75], 0
    buffer_load_dwordx4 v16, s[52:55], s88 offen offset:2048 lds
    s_waitcnt lgkmcnt(6)
    v_mfma_f32_16x16x32_bf16 v[148:151], a[244:247], v[64:67], 0
    ds_read_b64_tr_b16 a[228:229], v37 offset:20480
    v_mfma_f32_16x16x32_bf16 v[152:155], a[244:247], v[68:71], 0
    ds_read_b64_tr_b16 a[230:231], v37 offset:22528
    v_mfma_f32_16x16x32_bf16 v[156:159], a[244:247], v[72:75], 0
    buffer_load_dwordx4 v17, s[52:55], s88 offen offset:3072 lds
    s_waitcnt lgkmcnt(6)
    s_barrier
    v_mfma_f32_16x16x32_bf16 v[76:79], a[216:219], v[88:91], v[76:79]
    ds_read_b64_tr_b16 a[232:233], v30 offset:16384
    v_mfma_f32_16x16x32_bf16 v[80:83], a[216:219], v[92:95], v[80:83]
    ds_read_b64_tr_b16 a[234:235], v30 offset:18432
    v_mfma_f32_16x16x32_bf16 v[84:87], a[216:219], v[96:99], v[84:87]
    s_waitcnt lgkmcnt(6)
    v_mfma_f32_16x16x32_bf16 v[100:103], a[220:223], v[88:91], v[100:103]
    ds_read_b64_tr_b16 a[236:237], v32 offset:16384
    v_mfma_f32_16x16x32_bf16 v[104:107], a[220:223], v[92:95], v[104:107]
    ds_read_b64_tr_b16 a[238:239], v32 offset:18432
    v_mfma_f32_16x16x32_bf16 v[108:111], a[220:223], v[96:99], v[108:111]
    s_waitcnt lgkmcnt(6)
    v_mfma_f32_16x16x32_bf16 v[124:127], a[224:227], v[88:91], v[124:127]
    ds_read_b64_tr_b16 a[240:241], v34 offset:16384
    v_mfma_f32_16x16x32_bf16 v[128:131], a[224:227], v[92:95], v[128:131]
    ds_read_b64_tr_b16 a[242:243], v34 offset:18432
    v_mfma_f32_16x16x32_bf16 v[132:135], a[224:227], v[96:99], v[132:135]
    s_waitcnt lgkmcnt(6)
    v_mfma_f32_16x16x32_bf16 v[148:151], a[228:231], v[88:91], v[148:151]
    ds_read_b64_tr_b16 a[244:245], v36 offset:16384
    v_mfma_f32_16x16x32_bf16 v[152:155], a[228:231], v[92:95], v[152:155]
    ds_read_b64_tr_b16 a[246:247], v36 offset:18432
    v_mfma_f32_16x16x32_bf16 v[156:159], a[228:231], v[96:99], v[156:159]
    s_waitcnt lgkmcnt(6)
    v_mfma_f32_16x16x32_bf16 v[76:79], a[232:235], v[112:115], v[76:79]
    ds_read_b64_tr_b16 a[216:217], v30 offset:20480
    s_add_u32 m0, s86, 114688
    v_mfma_f32_16x16x32_bf16 v[80:83], a[232:235], v[116:119], v[80:83]
    ds_read_b64_tr_b16 a[218:219], v30 offset:22528
    s_add_u32 s88, s70, s79
    v_mfma_f32_16x16x32_bf16 v[84:87], a[232:235], v[120:123], v[84:87]
    buffer_load_dwordx4 v14, s[52:55], s88 offen lds
    s_waitcnt lgkmcnt(6)
    v_mfma_f32_16x16x32_bf16 v[100:103], a[236:239], v[112:115], v[100:103]
    ds_read_b64_tr_b16 a[220:221], v32 offset:20480
    v_mfma_f32_16x16x32_bf16 v[104:107], a[236:239], v[116:119], v[104:107]
    ds_read_b64_tr_b16 a[222:223], v32 offset:22528
    v_mfma_f32_16x16x32_bf16 v[108:111], a[236:239], v[120:123], v[108:111]
    buffer_load_dwordx4 v15, s[52:55], s88 offen offset:1024 lds
    s_waitcnt lgkmcnt(6)
    v_mfma_f32_16x16x32_bf16 v[124:127], a[240:243], v[112:115], v[124:127]
    ds_read_b64_tr_b16 a[224:225], v34 offset:20480
    v_mfma_f32_16x16x32_bf16 v[128:131], a[240:243], v[116:119], v[128:131]
    ds_read_b64_tr_b16 a[226:227], v34 offset:22528
    v_mfma_f32_16x16x32_bf16 v[132:135], a[240:243], v[120:123], v[132:135]
    buffer_load_dwordx4 v16, s[52:55], s88 offen offset:2048 lds
    s_waitcnt lgkmcnt(6)
    v_mfma_f32_16x16x32_bf16 v[148:151], a[244:247], v[112:115], v[148:151]
    ds_read_b64_tr_b16 a[228:229], v36 offset:20480
    v_mfma_f32_16x16x32_bf16 v[152:155], a[244:247], v[116:119], v[152:155]
    ds_read_b64_tr_b16 a[230:231], v36 offset:22528
    v_mfma_f32_16x16x32_bf16 v[156:159], a[244:247], v[120:123], v[156:159]
    buffer_load_dwordx4 v17, s[52:55], s88 offen offset:3072 lds
    s_waitcnt lgkmcnt(6)
    s_waitcnt vmcnt(16)
    s_barrier
    v_mfma_f32_16x16x32_bf16 v[76:79], a[216:219], v[136:139], v[76:79]
    ds_read_b64_tr_b16 a[232:233], v30 offset:32768
    v_mfma_f32_16x16x32_bf16 v[80:83], a[216:219], v[140:143], v[80:83]
    ds_read_b64_tr_b16 a[234:235], v30 offset:34816
    v_mfma_f32_16x16x32_bf16 v[84:87], a[216:219], v[144:147], v[84:87]
    s_waitcnt lgkmcnt(6)
    v_mfma_f32_16x16x32_bf16 v[100:103], a[220:223], v[136:139], v[100:103]
    ds_read_b64_tr_b16 a[236:237], v32 offset:32768
    v_mfma_f32_16x16x32_bf16 v[104:107], a[220:223], v[140:143], v[104:107]
    ds_read_b64_tr_b16 a[238:239], v32 offset:34816
    v_mfma_f32_16x16x32_bf16 v[108:111], a[220:223], v[144:147], v[108:111]
    s_waitcnt lgkmcnt(6)
    v_mfma_f32_16x16x32_bf16 v[124:127], a[224:227], v[136:139], v[124:127]
    ds_read_b64_tr_b16 a[240:241], v34 offset:32768
    v_mfma_f32_16x16x32_bf16 v[128:131], a[224:227], v[140:143], v[128:131]
    ds_read_b64_tr_b16 a[242:243], v34 offset:34816
    v_mfma_f32_16x16x32_bf16 v[132:135], a[224:227], v[144:147], v[132:135]
    s_waitcnt lgkmcnt(6)
    v_mfma_f32_16x16x32_bf16 v[148:151], a[228:231], v[136:139], v[148:151]
    ds_read_b64_tr_b16 a[244:245], v36 offset:32768
    v_mfma_f32_16x16x32_bf16 v[152:155], a[228:231], v[140:143], v[152:155]
    ds_read_b64_tr_b16 a[246:247], v36 offset:34816
    v_mfma_f32_16x16x32_bf16 v[156:159], a[228:231], v[144:147], v[156:159]
    s_waitcnt lgkmcnt(6)
    v_mfma_f32_16x16x32_bf16 v[76:79], a[232:235], v[160:163], v[76:79]
    ds_read_b64_tr_b16 a[216:217], v30 offset:36864
    s_add_u32 m0, s86, 98304
    v_mfma_f32_16x16x32_bf16 v[80:83], a[232:235], v[164:167], v[80:83]
    ds_read_b64_tr_b16 a[218:219], v30 offset:38912
    s_add_u32 s88, s68, s79
    v_mfma_f32_16x16x32_bf16 v[84:87], a[232:235], v[168:171], v[84:87]
    buffer_load_dwordx4 v14, s[52:55], s88 offen lds
    s_waitcnt lgkmcnt(6)
    v_mfma_f32_16x16x32_bf16 v[100:103], a[236:239], v[160:163], v[100:103]
    ds_read_b64_tr_b16 a[220:221], v32 offset:36864
    v_mfma_f32_16x16x32_bf16 v[104:107], a[236:239], v[164:167], v[104:107]
    ds_read_b64_tr_b16 a[222:223], v32 offset:38912
    v_mfma_f32_16x16x32_bf16 v[108:111], a[236:239], v[168:171], v[108:111]
    buffer_load_dwordx4 v15, s[52:55], s88 offen offset:1024 lds
    s_waitcnt lgkmcnt(6)
    v_mfma_f32_16x16x32_bf16 v[124:127], a[240:243], v[160:163], v[124:127]
    ds_read_b64_tr_b16 a[224:225], v34 offset:36864
    v_mfma_f32_16x16x32_bf16 v[128:131], a[240:243], v[164:167], v[128:131]
    ds_read_b64_tr_b16 a[226:227], v34 offset:38912
    v_mfma_f32_16x16x32_bf16 v[132:135], a[240:243], v[168:171], v[132:135]
    buffer_load_dwordx4 v16, s[52:55], s88 offen offset:2048 lds
    s_waitcnt lgkmcnt(6)
    v_mfma_f32_16x16x32_bf16 v[148:151], a[244:247], v[160:163], v[148:151]
    ds_read_b64_tr_b16 a[228:229], v36 offset:36864
    v_mfma_f32_16x16x32_bf16 v[152:155], a[244:247], v[164:167], v[152:155]
    ds_read_b64_tr_b16 a[230:231], v36 offset:38912
    v_mfma_f32_16x16x32_bf16 v[156:159], a[244:247], v[168:171], v[156:159]
    buffer_load_dwordx4 v17, s[52:55], s88 offen offset:3072 lds
    s_waitcnt lgkmcnt(6)
    s_waitcnt vmcnt(16)
    s_barrier
    v_mfma_f32_16x16x32_bf16 v[76:79], a[216:219], v[184:187], v[76:79]
    ds_read_b64_tr_b16 a[232:233], v34 offset:0
    s_add_u32 m0, s86, 81920
    v_mfma_f32_16x16x32_bf16 v[80:83], a[216:219], v[188:191], v[80:83]
    ds_read_b64_tr_b16 a[234:235], v34 offset:2048
    s_add_u32 s88, s71, s79
    v_mfma_f32_16x16x32_bf16 v[84:87], a[216:219], v[192:195], v[84:87]
    buffer_load_dwordx4 v14, s[52:55], s88 offen lds
    s_waitcnt lgkmcnt(6)
    v_mfma_f32_16x16x32_bf16 v[100:103], a[220:223], v[184:187], v[100:103]
    ds_read_b64_tr_b16 a[236:237], v36 offset:0
    v_mfma_f32_16x16x32_bf16 v[104:107], a[220:223], v[188:191], v[104:107]
    ds_read_b64_tr_b16 a[238:239], v36 offset:2048
    v_mfma_f32_16x16x32_bf16 v[108:111], a[220:223], v[192:195], v[108:111]
    buffer_load_dwordx4 v15, s[52:55], s88 offen offset:1024 lds
    s_waitcnt lgkmcnt(6)
    v_mfma_f32_16x16x32_bf16 v[124:127], a[224:227], v[184:187], v[124:127]
    ds_read_b64_tr_b16 a[240:241], v30 offset:0
    v_mfma_f32_16x16x32_bf16 v[128:131], a[224:227], v[188:191], v[128:131]
    ds_read_b64_tr_b16 a[242:243], v30 offset:2048
    v_mfma_f32_16x16x32_bf16 v[132:135], a[224:227], v[192:195], v[132:135]
    buffer_load_dwordx4 v16, s[52:55], s88 offen offset:2048 lds
    s_waitcnt lgkmcnt(6)
    v_mfma_f32_16x16x32_bf16 v[148:151], a[228:231], v[184:187], v[148:151]
    ds_read_b64_tr_b16 a[244:245], v32 offset:0
    v_mfma_f32_16x16x32_bf16 v[152:155], a[228:231], v[188:191], v[152:155]
    ds_read_b64_tr_b16 a[246:247], v32 offset:2048
    v_mfma_f32_16x16x32_bf16 v[156:159], a[228:231], v[192:195], v[156:159]
    buffer_load_dwordx4 v17, s[52:55], s88 offen offset:3072 lds
    s_waitcnt lgkmcnt(6)
    v_mfma_f32_16x16x32_bf16 v[124:127], a[232:235], v[208:211], v[124:127]
    ds_read_b64_tr_b16 a[216:217], v34 offset:4096
    s_add_u32 m0, s86, 16384
    v_mfma_f32_16x16x32_bf16 v[128:131], a[232:235], v[212:215], v[128:131]
    ds_read_b64_tr_b16 a[218:219], v34 offset:6144
    s_add_u32 s88, s82, s76
    v_mfma_f32_16x16x32_bf16 v[132:135], a[232:235], v[216:219], v[132:135]
    buffer_load_dwordx4 v10, s[48:51], s88 offen nt lds
    s_waitcnt lgkmcnt(6)
    v_mfma_f32_16x16x32_bf16 v[148:151], a[236:239], v[208:211], v[148:151]
    ds_read_b64_tr_b16 a[220:221], v36 offset:4096
    v_mfma_f32_16x16x32_bf16 v[152:155], a[236:239], v[212:215], v[152:155]
    ds_read_b64_tr_b16 a[222:223], v36 offset:6144
    v_mfma_f32_16x16x32_bf16 v[156:159], a[236:239], v[216:219], v[156:159]
    buffer_load_dwordx4 v11, s[48:51], s88 offen offset:1024 nt lds
    s_waitcnt lgkmcnt(6)
    v_mfma_f32_16x16x32_bf16 v[76:79], a[240:243], v[208:211], v[76:79]
    ds_read_b64_tr_b16 a[224:225], v30 offset:4096
    v_mfma_f32_16x16x32_bf16 v[80:83], a[240:243], v[212:215], v[80:83]
    ds_read_b64_tr_b16 a[226:227], v30 offset:6144
    v_mfma_f32_16x16x32_bf16 v[84:87], a[240:243], v[216:219], v[84:87]
    buffer_load_dwordx4 v12, s[48:51], s88 offen offset:2048 nt lds
    s_waitcnt lgkmcnt(6)
    v_mfma_f32_16x16x32_bf16 v[100:103], a[244:247], v[208:211], v[100:103]
    ds_read_b64_tr_b16 a[228:229], v32 offset:4096
    v_mfma_f32_16x16x32_bf16 v[104:107], a[244:247], v[212:215], v[104:107]
    ds_read_b64_tr_b16 a[230:231], v32 offset:6144
    v_mfma_f32_16x16x32_bf16 v[108:111], a[244:247], v[216:219], v[108:111]
    buffer_load_dwordx4 v13, s[48:51], s88 offen offset:3072 nt lds
    s_waitcnt lgkmcnt(6)
    s_waitcnt vmcnt(20)
    s_barrier
    v_mfma_f32_16x16x32_bf16 v[124:127], a[216:219], v[232:235], v[124:127]
    ds_read_b64_tr_b16 a[232:233], v38 offset:49152
    s_add_u32 m0, s86, 32768
    v_mfma_f32_16x16x32_bf16 v[128:131], a[216:219], v[236:239], v[128:131]
    ds_read_b64_tr_b16 a[234:235], v38 offset:51200
    s_add_u32 s88, s83, s76
    v_mfma_f32_16x16x32_bf16 v[132:135], a[216:219], v[240:243], v[132:135]
    buffer_load_dwordx4 v10, s[48:51], s88 offen nt lds
    s_waitcnt lgkmcnt(6)
    v_mfma_f32_16x16x32_bf16 v[148:151], a[220:223], v[232:235], v[148:151]
    ds_read_b64_tr_b16 a[236:237], v38 offset:53248
    v_mfma_f32_16x16x32_bf16 v[152:155], a[220:223], v[236:239], v[152:155]
    ds_read_b64_tr_b16 a[238:239], v38 offset:55296
    v_mfma_f32_16x16x32_bf16 v[156:159], a[220:223], v[240:243], v[156:159]
    buffer_load_dwordx4 v11, s[48:51], s88 offen offset:1024 nt lds
    s_waitcnt lgkmcnt(6)
    v_mfma_f32_16x16x32_bf16 v[76:79], a[224:227], v[232:235], v[76:79]
    ds_read_b64_tr_b16 a[240:241], v38 offset:57344
    ds_write_b128 v40, v[124:127] offset:0
    v_mfma_f32_16x16x32_bf16 v[80:83], a[224:227], v[236:239], v[80:83]
    ds_read_b64_tr_b16 a[242:243], v38 offset:59392
    ds_write_b128 v40, v[128:131] offset:1024
    v_mfma_f32_16x16x32_bf16 v[84:87], a[224:227], v[240:243], v[84:87]
    buffer_load_dwordx4 v12, s[48:51], s88 offen offset:2048 nt lds
    s_waitcnt lgkmcnt(8)
    v_mfma_f32_16x16x32_bf16 v[100:103], a[228:231], v[232:235], v[100:103]
    ds_read_b64_tr_b16 a[244:245], v38 offset:61440
    ds_write_b128 v40, v[132:135] offset:2048
    v_mfma_f32_16x16x32_bf16 v[104:107], a[228:231], v[236:239], v[104:107]
    ds_read_b64_tr_b16 a[246:247], v38 offset:63488
    ds_write_b128 v40, v[148:151] offset:3072
    v_mfma_f32_16x16x32_bf16 v[108:111], a[228:231], v[240:243], v[108:111]
    buffer_load_dwordx4 v13, s[48:51], s88 offen offset:3072 nt lds
    ds_write_b128 v40, v[152:155] offset:4096
    ds_write_b128 v40, v[156:159] offset:5120
    v_pk_mul_f32 v[76:77], v[76:77], v[44:45] op_sel_hi:[1,0]
    v_pk_mul_f32 v[78:79], v[78:79], v[44:45] op_sel_hi:[1,0]
    v_pk_mul_f32 v[100:101], v[100:101], v[44:45] op_sel_hi:[1,0]
    v_pk_mul_f32 v[102:103], v[102:103], v[44:45] op_sel_hi:[1,0]
    v_pk_mul_f32 v[80:81], v[80:81], v[46:47] op_sel_hi:[1,0]
    v_pk_mul_f32 v[82:83], v[82:83], v[46:47] op_sel_hi:[1,0]
    v_pk_mul_f32 v[104:105], v[104:105], v[46:47] op_sel_hi:[1,0]
    v_pk_mul_f32 v[106:107], v[106:107], v[46:47] op_sel_hi:[1,0]
    v_pk_mul_f32 v[84:85], v[84:85], v[48:49] op_sel_hi:[1,0]
    v_pk_mul_f32 v[86:87], v[86:87], v[48:49] op_sel_hi:[1,0]
    v_pk_mul_f32 v[108:109], v[108:109], v[48:49] op_sel_hi:[1,0]
    v_pk_mul_f32 v[110:111], v[110:111], v[48:49] op_sel_hi:[1,0]
    s_waitcnt lgkmcnt(0)
    s_barrier
    ds_read_b128 v[172:175], v41 offset:0
    ds_read_b128 v[196:199], v41 offset:3072
    ds_read_b128 v[176:179], v41 offset:1024
    ds_read_b128 v[200:203], v41 offset:4096
    ds_read_b128 v[180:183], v41 offset:2048
    ds_read_b128 v[204:207], v41 offset:5120
    s_waitcnt lgkmcnt(5)
    v_pk_fma_f32 v[76:77], v[172:173], v[44:45], v[76:77] op_sel:[0,1,0] op_sel_hi:[1,1,1]
    v_pk_fma_f32 v[78:79], v[174:175], v[44:45], v[78:79] op_sel:[0,1,0] op_sel_hi:[1,1,1]
    s_waitcnt lgkmcnt(4)
    v_pk_fma_f32 v[100:101], v[196:197], v[44:45], v[100:101] op_sel:[0,1,0] op_sel_hi:[1,1,1]
    v_pk_fma_f32 v[102:103], v[198:199], v[44:45], v[102:103] op_sel:[0,1,0] op_sel_hi:[1,1,1]
    v_cvt_pk_bf16_f32 v172, v76, v77
    v_cvt_pk_bf16_f32 v173, v78, v79
    v_cvt_pk_bf16_f32 v174, v100, v101
    v_cvt_pk_bf16_f32 v175, v102, v103
    ds_write_b128 v41, v[172:175] offset:0
    s_waitcnt lgkmcnt(4)
    v_pk_fma_f32 v[80:81], v[176:177], v[46:47], v[80:81] op_sel:[0,1,0] op_sel_hi:[1,1,1]
    v_pk_fma_f32 v[82:83], v[178:179], v[46:47], v[82:83] op_sel:[0,1,0] op_sel_hi:[1,1,1]
    s_waitcnt lgkmcnt(3)
    v_pk_fma_f32 v[104:105], v[200:201], v[46:47], v[104:105] op_sel:[0,1,0] op_sel_hi:[1,1,1]
    v_pk_fma_f32 v[106:107], v[202:203], v[46:47], v[106:107] op_sel:[0,1,0] op_sel_hi:[1,1,1]
    v_cvt_pk_bf16_f32 v176, v80, v81
    v_cvt_pk_bf16_f32 v177, v82, v83
    v_cvt_pk_bf16_f32 v178, v104, v105
    v_cvt_pk_bf16_f32 v179, v106, v107
    ds_write_b128 v41, v[176:179] offset:1024
    s_waitcnt lgkmcnt(3)
    v_pk_fma_f32 v[84:85], v[180:181], v[48:49], v[84:85] op_sel:[0,1,0] op_sel_hi:[1,1,1]
    v_pk_fma_f32 v[86:87], v[182:183], v[48:49], v[86:87] op_sel:[0,1,0] op_sel_hi:[1,1,1]
    s_waitcnt lgkmcnt(2)
    v_pk_fma_f32 v[108:109], v[204:205], v[48:49], v[108:109] op_sel:[0,1,0] op_sel_hi:[1,1,1]
    v_pk_fma_f32 v[110:111], v[206:207], v[48:49], v[110:111] op_sel:[0,1,0] op_sel_hi:[1,1,1]
    v_cvt_pk_bf16_f32 v180, v84, v85
    v_cvt_pk_bf16_f32 v181, v86, v87
    v_cvt_pk_bf16_f32 v182, v108, v109
    v_cvt_pk_bf16_f32 v183, v110, v111
    ds_write_b128 v41, v[180:183] offset:2048
    s_waitcnt lgkmcnt(0)
    s_barrier
    ds_read_b128 a[132:135], v42 offset:6144
    ds_read_b128 a[136:139], v42 offset:7168
    ds_read_b128 a[140:143], v42 offset:8192
    ds_read_b128 a[144:147], v42 offset:0
    ds_read_b128 a[148:151], v42 offset:1024
    ds_read_b128 a[152:155], v42 offset:2048
    ds_read_b128 a[156:159], v42 offset:18432
    ds_read_b128 a[160:163], v42 offset:19456
    ds_read_b128 a[164:167], v42 offset:20480
    ds_read_b128 a[168:171], v42 offset:12288
    ds_read_b128 a[172:175], v42 offset:13312
    ds_read_b128 a[176:179], v42 offset:14336
    s_waitcnt lgkmcnt(0)
    s_waitcnt vmcnt(12)
    s_barrier
    v_mfma_f32_16x16x32_bf16 a[0:3], a[232:235], a[132:135], a[0:3]
    ds_read_b64_tr_b16 a[216:217], v39 offset:32768
    s_add_u32 m0, s86, 0
    v_mfma_f32_16x16x32_bf16 a[4:7], a[232:235], a[136:139], a[4:7]
    ds_read_b64_tr_b16 a[218:219], v39 offset:34816
    s_add_u32 s88, s73, s79
    v_mfma_f32_16x16x32_bf16 a[8:11], a[232:235], a[140:143], a[8:11]
    buffer_load_dwordx4 v14, s[52:55], s88 offen lds
    v_mfma_f32_16x16x32_bf16 a[0:3], a[236:239], a[144:147], a[0:3]
    ds_read_b64_tr_b16 a[220:221], v39 offset:36864
    v_mfma_f32_16x16x32_bf16 a[4:7], a[236:239], a[148:151], a[4:7]
    ds_read_b64_tr_b16 a[222:223], v39 offset:38912
    v_mfma_f32_16x16x32_bf16 a[8:11], a[236:239], a[152:155], a[8:11]
    buffer_load_dwordx4 v15, s[52:55], s88 offen offset:1024 lds
    v_mfma_f32_16x16x32_bf16 a[0:3], a[240:243], a[156:159], a[0:3]
    ds_read_b64_tr_b16 a[224:225], v39 offset:40960
    v_mfma_f32_16x16x32_bf16 a[4:7], a[240:243], a[160:163], a[4:7]
    ds_read_b64_tr_b16 a[226:227], v39 offset:43008
    v_mfma_f32_16x16x32_bf16 a[8:11], a[240:243], a[164:167], a[8:11]
    buffer_load_dwordx4 v16, s[52:55], s88 offen offset:2048 lds
    v_mfma_f32_16x16x32_bf16 a[0:3], a[244:247], a[168:171], a[0:3]
    ds_read_b64_tr_b16 a[228:229], v39 offset:45056
    v_mfma_f32_16x16x32_bf16 a[4:7], a[244:247], a[172:175], a[4:7]
    ds_read_b64_tr_b16 a[230:231], v39 offset:47104
    v_mfma_f32_16x16x32_bf16 a[8:11], a[244:247], a[176:179], a[8:11]
    buffer_load_dwordx4 v17, s[52:55], s88 offen offset:3072 lds
    s_waitcnt lgkmcnt(6)
    s_barrier
    v_mfma_f32_16x16x32_bf16 a[12:15], a[216:219], a[132:135], a[12:15]
    ds_read_b64_tr_b16 a[232:233], v39 offset:0
    s_add_u32 m0, s86, 49152
    v_mfma_f32_16x16x32_bf16 a[16:19], a[216:219], a[136:139], a[16:19]
    ds_read_b64_tr_b16 a[234:235], v39 offset:2048
    s_add_u32 s88, s72, s79
    v_mfma_f32_16x16x32_bf16 a[20:23], a[216:219], a[140:143], a[20:23]
    buffer_load_dwordx4 v14, s[52:55], s88 offen lds
    s_waitcnt lgkmcnt(6)
    v_mfma_f32_16x16x32_bf16 a[12:15], a[220:223], a[144:147], a[12:15]
    ds_read_b64_tr_b16 a[236:237], v39 offset:4096
    v_mfma_f32_16x16x32_bf16 a[16:19], a[220:223], a[148:151], a[16:19]
    ds_read_b64_tr_b16 a[238:239], v39 offset:6144
    v_mfma_f32_16x16x32_bf16 a[20:23], a[220:223], a[152:155], a[20:23]
    buffer_load_dwordx4 v15, s[52:55], s88 offen offset:1024 lds
    s_waitcnt lgkmcnt(6)
    v_mfma_f32_16x16x32_bf16 a[12:15], a[224:227], a[156:159], a[12:15]
    ds_read_b64_tr_b16 a[240:241], v39 offset:8192
    v_mfma_f32_16x16x32_bf16 a[16:19], a[224:227], a[160:163], a[16:19]
    ds_read_b64_tr_b16 a[242:243], v39 offset:10240
    v_mfma_f32_16x16x32_bf16 a[20:23], a[224:227], a[164:167], a[20:23]
    buffer_load_dwordx4 v16, s[52:55], s88 offen offset:2048 lds
    s_waitcnt lgkmcnt(6)
    v_mfma_f32_16x16x32_bf16 a[12:15], a[228:231], a[168:171], a[12:15]
    ds_read_b64_tr_b16 a[244:245], v39 offset:12288
    v_mfma_f32_16x16x32_bf16 a[16:19], a[228:231], a[172:175], a[16:19]
    ds_read_b64_tr_b16 a[246:247], v39 offset:14336
    v_mfma_f32_16x16x32_bf16 a[20:23], a[228:231], a[176:179], a[20:23]
    buffer_load_dwordx4 v17, s[52:55], s88 offen offset:3072 lds
    s_waitcnt lgkmcnt(6)
    s_barrier
    v_mfma_f32_16x16x32_bf16 a[24:27], a[232:235], a[132:135], a[24:27]
    ds_read_b64_tr_b16 a[216:217], v39 offset:49152
    s_add_u32 m0, s86, 98304
    v_mfma_f32_16x16x32_bf16 a[28:31], a[232:235], a[136:139], a[28:31]
    ds_read_b64_tr_b16 a[218:219], v39 offset:51200
    s_add_u32 s88, s84, s76
    v_mfma_f32_16x16x32_bf16 a[32:35], a[232:235], a[140:143], a[32:35]
    buffer_load_dwordx4 v10, s[48:51], s88 offen nt lds
    s_waitcnt lgkmcnt(6)
    v_mfma_f32_16x16x32_bf16 a[24:27], a[236:239], a[144:147], a[24:27]
    ds_read_b64_tr_b16 a[220:221], v39 offset:53248
    v_mfma_f32_16x16x32_bf16 a[28:31], a[236:239], a[148:151], a[28:31]
    ds_read_b64_tr_b16 a[222:223], v39 offset:55296
    v_mfma_f32_16x16x32_bf16 a[32:35], a[236:239], a[152:155], a[32:35]
    buffer_load_dwordx4 v11, s[48:51], s88 offen offset:1024 nt lds
    s_waitcnt lgkmcnt(6)
    v_mfma_f32_16x16x32_bf16 a[24:27], a[240:243], a[156:159], a[24:27]
    ds_read_b64_tr_b16 a[224:225], v39 offset:57344
    v_mfma_f32_16x16x32_bf16 a[28:31], a[240:243], a[160:163], a[28:31]
    ds_read_b64_tr_b16 a[226:227], v39 offset:59392
    v_mfma_f32_16x16x32_bf16 a[32:35], a[240:243], a[164:167], a[32:35]
    buffer_load_dwordx4 v12, s[48:51], s88 offen offset:2048 nt lds
    s_waitcnt lgkmcnt(6)
    v_mfma_f32_16x16x32_bf16 a[24:27], a[244:247], a[168:171], a[24:27]
    ds_read_b64_tr_b16 a[228:229], v39 offset:61440
    v_mfma_f32_16x16x32_bf16 a[28:31], a[244:247], a[172:175], a[28:31]
    ds_read_b64_tr_b16 a[230:231], v39 offset:63488
    v_mfma_f32_16x16x32_bf16 a[32:35], a[244:247], a[176:179], a[32:35]
    buffer_load_dwordx4 v13, s[48:51], s88 offen offset:3072 nt lds
    s_waitcnt lgkmcnt(6)
    s_waitcnt vmcnt(20)
    s_barrier
    v_mfma_f32_16x16x32_bf16 a[36:39], a[216:219], a[132:135], a[36:39]
    ds_read_b64_tr_b16 a[232:233], v39 offset:16384
    s_add_u32 m0, s86, 65536
    v_mfma_f32_16x16x32_bf16 a[40:43], a[216:219], a[136:139], a[40:43]
    ds_read_b64_tr_b16 a[234:235], v39 offset:18432
    s_add_u32 s88, s85, s76
    v_mfma_f32_16x16x32_bf16 a[44:47], a[216:219], a[140:143], a[44:47]
    buffer_load_dwordx4 v10, s[48:51], s88 offen nt lds
    s_waitcnt lgkmcnt(6)
    v_mfma_f32_16x16x32_bf16 a[36:39], a[220:223], a[144:147], a[36:39]
    ds_read_b64_tr_b16 a[236:237], v39 offset:20480
    v_mfma_f32_16x16x32_bf16 a[40:43], a[220:223], a[148:151], a[40:43]
    ds_read_b64_tr_b16 a[238:239], v39 offset:22528
    v_mfma_f32_16x16x32_bf16 a[44:47], a[220:223], a[152:155], a[44:47]
    buffer_load_dwordx4 v11, s[48:51], s88 offen offset:1024 nt lds
    s_waitcnt lgkmcnt(6)
    v_mfma_f32_16x16x32_bf16 a[36:39], a[224:227], a[156:159], a[36:39]
    ds_read_b64_tr_b16 a[240:241], v39 offset:24576
    v_mfma_f32_16x16x32_bf16 a[40:43], a[224:227], a[160:163], a[40:43]
    ds_read_b64_tr_b16 a[242:243], v39 offset:26624
    v_mfma_f32_16x16x32_bf16 a[44:47], a[224:227], a[164:167], a[44:47]
    buffer_load_dwordx4 v12, s[48:51], s88 offen offset:2048 nt lds
    s_waitcnt lgkmcnt(6)
    v_mfma_f32_16x16x32_bf16 a[36:39], a[228:231], a[168:171], a[36:39]
    ds_read_b64_tr_b16 a[244:245], v39 offset:28672
    v_mfma_f32_16x16x32_bf16 a[40:43], a[228:231], a[172:175], a[40:43]
    ds_read_b64_tr_b16 a[246:247], v39 offset:30720
    v_mfma_f32_16x16x32_bf16 a[44:47], a[228:231], a[176:179], a[44:47]
    buffer_load_dwordx4 v13, s[48:51], s88 offen offset:3072 nt lds
    s_waitcnt lgkmcnt(6)
    s_waitcnt vmcnt(8)
    s_barrier
    v_mfma_f32_16x16x32_bf16 a[48:51], a[232:235], a[132:135], a[48:51]
    ds_read_b64_tr_b16 a[216:217], v38 offset:49152
    v_mfma_f32_16x16x32_bf16 a[52:55], a[232:235], a[136:139], a[52:55]
    ds_read_b64_tr_b16 a[218:219], v38 offset:51200
    v_mfma_f32_16x16x32_bf16 a[56:59], a[232:235], a[140:143], a[56:59]
    s_waitcnt lgkmcnt(6)
    v_mfma_f32_16x16x32_bf16 a[48:51], a[236:239], a[144:147], a[48:51]
    ds_read_b64_tr_b16 a[220:221], v38 offset:53248
    v_mfma_f32_16x16x32_bf16 a[52:55], a[236:239], a[148:151], a[52:55]
    ds_read_b64_tr_b16 a[222:223], v38 offset:55296
    v_mfma_f32_16x16x32_bf16 a[56:59], a[236:239], a[152:155], a[56:59]
    s_waitcnt lgkmcnt(6)
    v_mfma_f32_16x16x32_bf16 a[48:51], a[240:243], a[156:159], a[48:51]
    ds_read_b64_tr_b16 a[224:225], v38 offset:57344
    v_mfma_f32_16x16x32_bf16 a[52:55], a[240:243], a[160:163], a[52:55]
    ds_read_b64_tr_b16 a[226:227], v38 offset:59392
    v_mfma_f32_16x16x32_bf16 a[56:59], a[240:243], a[164:167], a[56:59]
    s_waitcnt lgkmcnt(6)
    v_mfma_f32_16x16x32_bf16 a[48:51], a[244:247], a[168:171], a[48:51]
    ds_read_b64_tr_b16 a[228:229], v38 offset:61440
    v_mfma_f32_16x16x32_bf16 a[52:55], a[244:247], a[172:175], a[52:55]
    ds_read_b64_tr_b16 a[230:231], v38 offset:63488
    v_mfma_f32_16x16x32_bf16 a[56:59], a[244:247], a[176:179], a[56:59]
    s_waitcnt lgkmcnt(6)
    s_barrier
    v_mfma_f32_16x16x32_bf16 a[60:63], a[216:219], a[132:135], a[60:63]
    ds_read_b64_tr_b16 a[232:233], v38 offset:0
    v_mfma_f32_16x16x32_bf16 a[64:67], a[216:219], a[136:139], a[64:67]
    ds_read_b64_tr_b16 a[234:235], v38 offset:2048
    v_mfma_f32_16x16x32_bf16 a[68:71], a[216:219], a[140:143], a[68:71]
    s_waitcnt lgkmcnt(6)
    v_mfma_f32_16x16x32_bf16 a[60:63], a[220:223], a[144:147], a[60:63]
    ds_read_b64_tr_b16 a[236:237], v38 offset:4096
    v_mfma_f32_16x16x32_bf16 a[64:67], a[220:223], a[148:151], a[64:67]
    ds_read_b64_tr_b16 a[238:239], v38 offset:6144
    v_mfma_f32_16x16x32_bf16 a[68:71], a[220:223], a[152:155], a[68:71]
    s_waitcnt lgkmcnt(6)
    v_mfma_f32_16x16x32_bf16 a[60:63], a[224:227], a[156:159], a[60:63]
    ds_read_b64_tr_b16 a[240:241], v38 offset:8192
    v_mfma_f32_16x16x32_bf16 a[64:67], a[224:227], a[160:163], a[64:67]
    ds_read_b64_tr_b16 a[242:243], v38 offset:10240
    v_mfma_f32_16x16x32_bf16 a[68:71], a[224:227], a[164:167], a[68:71]
    s_waitcnt lgkmcnt(6)
    v_mfma_f32_16x16x32_bf16 a[60:63], a[228:231], a[168:171], a[60:63]
    ds_read_b64_tr_b16 a[244:245], v38 offset:12288
    v_mfma_f32_16x16x32_bf16 a[64:67], a[228:231], a[172:175], a[64:67]
    ds_read_b64_tr_b16 a[246:247], v38 offset:14336
    v_mfma_f32_16x16x32_bf16 a[68:71], a[228:231], a[176:179], a[68:71]
    s_waitcnt lgkmcnt(6)
    s_barrier
    v_mfma_f32_16x16x32_bf16 a[72:75], a[232:235], a[132:135], a[72:75]
    ds_read_b64_tr_b16 a[216:217], v30 offset:16384
    s_add_u32 m0, s86, 114688
    v_mfma_f32_16x16x32_bf16 a[76:79], a[232:235], a[136:139], a[76:79]
    ds_read_b64_tr_b16 a[218:219], v30 offset:18432
    s_add_u32 s88, s67, s80
    v_mfma_f32_16x16x32_bf16 a[80:83], a[232:235], a[140:143], a[80:83]
    buffer_load_dwordx4 v14, s[52:55], s88 offen lds
    s_waitcnt lgkmcnt(6)
    v_mfma_f32_16x16x32_bf16 a[72:75], a[236:239], a[144:147], a[72:75]
    ds_read_b64_tr_b16 a[220:221], v32 offset:16384
    v_mfma_f32_16x16x32_bf16 a[76:79], a[236:239], a[148:151], a[76:79]
    ds_read_b64_tr_b16 a[222:223], v32 offset:18432
    v_mfma_f32_16x16x32_bf16 a[80:83], a[236:239], a[152:155], a[80:83]
    buffer_load_dwordx4 v15, s[52:55], s88 offen offset:1024 lds
    s_waitcnt lgkmcnt(6)
    v_mfma_f32_16x16x32_bf16 a[72:75], a[240:243], a[156:159], a[72:75]
    ds_read_b64_tr_b16 a[224:225], v34 offset:16384
    v_mfma_f32_16x16x32_bf16 a[76:79], a[240:243], a[160:163], a[76:79]
    ds_read_b64_tr_b16 a[226:227], v34 offset:18432
    v_mfma_f32_16x16x32_bf16 a[80:83], a[240:243], a[164:167], a[80:83]
    buffer_load_dwordx4 v16, s[52:55], s88 offen offset:2048 lds
    s_waitcnt lgkmcnt(6)
    v_mfma_f32_16x16x32_bf16 a[72:75], a[244:247], a[168:171], a[72:75]
    ds_read_b64_tr_b16 a[228:229], v36 offset:16384
    v_mfma_f32_16x16x32_bf16 a[76:79], a[244:247], a[172:175], a[76:79]
    ds_read_b64_tr_b16 a[230:231], v36 offset:18432
    v_mfma_f32_16x16x32_bf16 a[80:83], a[244:247], a[176:179], a[80:83]
    buffer_load_dwordx4 v17, s[52:55], s88 offen offset:3072 lds
    s_waitcnt lgkmcnt(6)
    v_mfma_f32_16x16x32_bf16 v[76:79], a[216:219], v[64:67], 0
    ds_read_b64_tr_b16 a[232:233], v30 offset:20480
    s_add_u32 m0, s86, 81920
    v_mfma_f32_16x16x32_bf16 v[80:83], a[216:219], v[68:71], 0
    ds_read_b64_tr_b16 a[234:235], v30 offset:22528
    s_add_u32 s88, s69, s80
    v_mfma_f32_16x16x32_bf16 v[84:87], a[216:219], v[72:75], 0
    buffer_load_dwordx4 v14, s[52:55], s88 offen lds
    s_waitcnt lgkmcnt(6)
    v_mfma_f32_16x16x32_bf16 v[100:103], a[220:223], v[64:67], 0
    ds_read_b64_tr_b16 a[236:237], v32 offset:20480
    v_mfma_f32_16x16x32_bf16 v[104:107], a[220:223], v[68:71], 0
    ds_read_b64_tr_b16 a[238:239], v32 offset:22528
    v_mfma_f32_16x16x32_bf16 v[108:111], a[220:223], v[72:75], 0
    buffer_load_dwordx4 v15, s[52:55], s88 offen offset:1024 lds
    s_waitcnt lgkmcnt(6)
    v_mfma_f32_16x16x32_bf16 v[124:127], a[224:227], v[64:67], 0
    ds_read_b64_tr_b16 a[240:241], v34 offset:20480
    v_mfma_f32_16x16x32_bf16 v[128:131], a[224:227], v[68:71], 0
    ds_read_b64_tr_b16 a[242:243], v34 offset:22528
    v_mfma_f32_16x16x32_bf16 v[132:135], a[224:227], v[72:75], 0
    buffer_load_dwordx4 v16, s[52:55], s88 offen offset:2048 lds
    s_waitcnt lgkmcnt(6)
    v_mfma_f32_16x16x32_bf16 v[148:151], a[228:231], v[64:67], 0
    ds_read_b64_tr_b16 a[244:245], v36 offset:20480
    v_mfma_f32_16x16x32_bf16 v[152:155], a[228:231], v[68:71], 0
    ds_read_b64_tr_b16 a[246:247], v36 offset:22528
    v_mfma_f32_16x16x32_bf16 v[156:159], a[228:231], v[72:75], 0
    buffer_load_dwordx4 v17, s[52:55], s88 offen offset:3072 lds
    s_waitcnt lgkmcnt(6)
    s_barrier
    v_mfma_f32_16x16x32_bf16 v[76:79], a[232:235], v[88:91], v[76:79]
    ds_read_b64_tr_b16 a[216:217], v30 offset:32768
    s_add_u32 m0, s86, 49152
    v_mfma_f32_16x16x32_bf16 v[80:83], a[232:235], v[92:95], v[80:83]
    ds_read_b64_tr_b16 a[218:219], v30 offset:34816
    s_add_u32 s88, s70, s80
    v_mfma_f32_16x16x32_bf16 v[84:87], a[232:235], v[96:99], v[84:87]
    buffer_load_dwordx4 v14, s[52:55], s88 offen lds
    s_waitcnt lgkmcnt(6)
    v_mfma_f32_16x16x32_bf16 v[100:103], a[236:239], v[88:91], v[100:103]
    ds_read_b64_tr_b16 a[220:221], v32 offset:32768
    v_mfma_f32_16x16x32_bf16 v[104:107], a[236:239], v[92:95], v[104:107]
    ds_read_b64_tr_b16 a[222:223], v32 offset:34816
    v_mfma_f32_16x16x32_bf16 v[108:111], a[236:239], v[96:99], v[108:111]
    buffer_load_dwordx4 v15, s[52:55], s88 offen offset:1024 lds
    s_waitcnt lgkmcnt(6)
    v_mfma_f32_16x16x32_bf16 v[124:127], a[240:243], v[88:91], v[124:127]
    ds_read_b64_tr_b16 a[224:225], v34 offset:32768
    v_mfma_f32_16x16x32_bf16 v[128:131], a[240:243], v[92:95], v[128:131]
    ds_read_b64_tr_b16 a[226:227], v34 offset:34816
    v_mfma_f32_16x16x32_bf16 v[132:135], a[240:243], v[96:99], v[132:135]
    buffer_load_dwordx4 v16, s[52:55], s88 offen offset:2048 lds
    s_waitcnt lgkmcnt(6)
    v_mfma_f32_16x16x32_bf16 v[148:151], a[244:247], v[88:91], v[148:151]
    ds_read_b64_tr_b16 a[228:229], v36 offset:32768
    v_mfma_f32_16x16x32_bf16 v[152:155], a[244:247], v[92:95], v[152:155]
    ds_read_b64_tr_b16 a[230:231], v36 offset:34816
    v_mfma_f32_16x16x32_bf16 v[156:159], a[244:247], v[96:99], v[156:159]
    buffer_load_dwordx4 v17, s[52:55], s88 offen offset:3072 lds
    s_waitcnt lgkmcnt(6)
    v_mfma_f32_16x16x32_bf16 v[76:79], a[216:219], v[112:115], v[76:79]
    ds_read_b64_tr_b16 a[232:233], v30 offset:36864
    v_mfma_f32_16x16x32_bf16 v[80:83], a[216:219], v[116:119], v[80:83]
    ds_read_b64_tr_b16 a[234:235], v30 offset:38912
    v_mfma_f32_16x16x32_bf16 v[84:87], a[216:219], v[120:123], v[84:87]
    s_waitcnt lgkmcnt(6)
    v_mfma_f32_16x16x32_bf16 v[100:103], a[220:223], v[112:115], v[100:103]
    ds_read_b64_tr_b16 a[236:237], v32 offset:36864
    v_mfma_f32_16x16x32_bf16 v[104:107], a[220:223], v[116:119], v[104:107]
    ds_read_b64_tr_b16 a[238:239], v32 offset:38912
    v_mfma_f32_16x16x32_bf16 v[108:111], a[220:223], v[120:123], v[108:111]
    s_waitcnt lgkmcnt(6)
    v_mfma_f32_16x16x32_bf16 v[124:127], a[224:227], v[112:115], v[124:127]
    ds_read_b64_tr_b16 a[240:241], v34 offset:36864
    v_mfma_f32_16x16x32_bf16 v[128:131], a[224:227], v[116:119], v[128:131]
    ds_read_b64_tr_b16 a[242:243], v34 offset:38912
    v_mfma_f32_16x16x32_bf16 v[132:135], a[224:227], v[120:123], v[132:135]
    s_waitcnt lgkmcnt(6)
    v_mfma_f32_16x16x32_bf16 v[148:151], a[228:231], v[112:115], v[148:151]
    ds_read_b64_tr_b16 a[244:245], v36 offset:36864
    v_mfma_f32_16x16x32_bf16 v[152:155], a[228:231], v[116:119], v[152:155]
    ds_read_b64_tr_b16 a[246:247], v36 offset:38912
    v_mfma_f32_16x16x32_bf16 v[156:159], a[228:231], v[120:123], v[156:159]
    s_waitcnt lgkmcnt(6)
    s_waitcnt vmcnt(16)
    s_barrier
    v_mfma_f32_16x16x32_bf16 v[76:79], a[232:235], v[136:139], v[76:79]
    ds_read_b64_tr_b16 a[216:217], v31 offset:32768
    v_mfma_f32_16x16x32_bf16 v[80:83], a[232:235], v[140:143], v[80:83]
    ds_read_b64_tr_b16 a[218:219], v31 offset:34816
    v_mfma_f32_16x16x32_bf16 v[84:87], a[232:235], v[144:147], v[84:87]
    s_waitcnt lgkmcnt(6)
    v_mfma_f32_16x16x32_bf16 v[100:103], a[236:239], v[136:139], v[100:103]
    ds_read_b64_tr_b16 a[220:221], v33 offset:32768
    v_mfma_f32_16x16x32_bf16 v[104:107], a[236:239], v[140:143], v[104:107]
    ds_read_b64_tr_b16 a[222:223], v33 offset:34816
    v_mfma_f32_16x16x32_bf16 v[108:111], a[236:239], v[144:147], v[108:111]
    s_waitcnt lgkmcnt(6)
    v_mfma_f32_16x16x32_bf16 v[124:127], a[240:243], v[136:139], v[124:127]
    ds_read_b64_tr_b16 a[224:225], v35 offset:32768
    v_mfma_f32_16x16x32_bf16 v[128:131], a[240:243], v[140:143], v[128:131]
    ds_read_b64_tr_b16 a[226:227], v35 offset:34816
    v_mfma_f32_16x16x32_bf16 v[132:135], a[240:243], v[144:147], v[132:135]
    s_waitcnt lgkmcnt(6)
    v_mfma_f32_16x16x32_bf16 v[148:151], a[244:247], v[136:139], v[148:151]
    ds_read_b64_tr_b16 a[228:229], v37 offset:32768
    v_mfma_f32_16x16x32_bf16 v[152:155], a[244:247], v[140:143], v[152:155]
    ds_read_b64_tr_b16 a[230:231], v37 offset:34816
    v_mfma_f32_16x16x32_bf16 v[156:159], a[244:247], v[144:147], v[156:159]
    s_waitcnt lgkmcnt(6)
    v_mfma_f32_16x16x32_bf16 v[76:79], a[216:219], v[160:163], v[76:79]
    ds_read_b64_tr_b16 a[232:233], v31 offset:36864
    s_add_u32 m0, s86, 0
    v_mfma_f32_16x16x32_bf16 v[80:83], a[216:219], v[164:167], v[80:83]
    ds_read_b64_tr_b16 a[234:235], v31 offset:38912
    s_add_u32 s88, s68, s80
    v_mfma_f32_16x16x32_bf16 v[84:87], a[216:219], v[168:171], v[84:87]
    buffer_load_dwordx4 v14, s[52:55], s88 offen lds
    s_waitcnt lgkmcnt(6)
    v_mfma_f32_16x16x32_bf16 v[100:103], a[220:223], v[160:163], v[100:103]
    ds_read_b64_tr_b16 a[236:237], v33 offset:36864
    v_mfma_f32_16x16x32_bf16 v[104:107], a[220:223], v[164:167], v[104:107]
    ds_read_b64_tr_b16 a[238:239], v33 offset:38912
    v_mfma_f32_16x16x32_bf16 v[108:111], a[220:223], v[168:171], v[108:111]
    buffer_load_dwordx4 v15, s[52:55], s88 offen offset:1024 lds
    s_waitcnt lgkmcnt(6)
    v_mfma_f32_16x16x32_bf16 v[124:127], a[224:227], v[160:163], v[124:127]
    ds_read_b64_tr_b16 a[240:241], v35 offset:36864
    v_mfma_f32_16x16x32_bf16 v[128:131], a[224:227], v[164:167], v[128:131]
    ds_read_b64_tr_b16 a[242:243], v35 offset:38912
    v_mfma_f32_16x16x32_bf16 v[132:135], a[224:227], v[168:171], v[132:135]
    buffer_load_dwordx4 v16, s[52:55], s88 offen offset:2048 lds
    s_waitcnt lgkmcnt(6)
    v_mfma_f32_16x16x32_bf16 v[148:151], a[228:231], v[160:163], v[148:151]
    ds_read_b64_tr_b16 a[244:245], v37 offset:36864
    v_mfma_f32_16x16x32_bf16 v[152:155], a[228:231], v[164:167], v[152:155]
    ds_read_b64_tr_b16 a[246:247], v37 offset:38912
    v_mfma_f32_16x16x32_bf16 v[156:159], a[228:231], v[168:171], v[156:159]
    buffer_load_dwordx4 v17, s[52:55], s88 offen offset:3072 lds
    s_waitcnt lgkmcnt(6)
    s_waitcnt vmcnt(16)
    s_barrier
    v_mfma_f32_16x16x32_bf16 v[76:79], a[232:235], v[184:187], v[76:79]
    ds_read_b64_tr_b16 a[216:217], v35 offset:0
    s_add_u32 m0, s86, 16384
    v_mfma_f32_16x16x32_bf16 v[80:83], a[232:235], v[188:191], v[80:83]
    ds_read_b64_tr_b16 a[218:219], v35 offset:2048
    s_add_u32 s88, s71, s80
    v_mfma_f32_16x16x32_bf16 v[84:87], a[232:235], v[192:195], v[84:87]
    buffer_load_dwordx4 v14, s[52:55], s88 offen lds
    s_waitcnt lgkmcnt(6)
    v_mfma_f32_16x16x32_bf16 v[100:103], a[236:239], v[184:187], v[100:103]
    ds_read_b64_tr_b16 a[220:221], v37 offset:0
    v_mfma_f32_16x16x32_bf16 v[104:107], a[236:239], v[188:191], v[104:107]
    ds_read_b64_tr_b16 a[222:223], v37 offset:2048
    v_mfma_f32_16x16x32_bf16 v[108:111], a[236:239], v[192:195], v[108:111]
    buffer_load_dwordx4 v15, s[52:55], s88 offen offset:1024 lds
    s_waitcnt lgkmcnt(6)
    v_mfma_f32_16x16x32_bf16 v[124:127], a[240:243], v[184:187], v[124:127]
    ds_read_b64_tr_b16 a[224:225], v31 offset:0
    v_mfma_f32_16x16x32_bf16 v[128:131], a[240:243], v[188:191], v[128:131]
    ds_read_b64_tr_b16 a[226:227], v31 offset:2048
    v_mfma_f32_16x16x32_bf16 v[132:135], a[240:243], v[192:195], v[132:135]
    buffer_load_dwordx4 v16, s[52:55], s88 offen offset:2048 lds
    s_waitcnt lgkmcnt(6)
    v_mfma_f32_16x16x32_bf16 v[148:151], a[244:247], v[184:187], v[148:151]
    ds_read_b64_tr_b16 a[228:229], v33 offset:0
    v_mfma_f32_16x16x32_bf16 v[152:155], a[244:247], v[188:191], v[152:155]
    ds_read_b64_tr_b16 a[230:231], v33 offset:2048
    v_mfma_f32_16x16x32_bf16 v[156:159], a[244:247], v[192:195], v[156:159]
    buffer_load_dwordx4 v17, s[52:55], s88 offen offset:3072 lds
    s_waitcnt lgkmcnt(6)
    v_mfma_f32_16x16x32_bf16 v[124:127], a[216:219], v[208:211], v[124:127]
    ds_read_b64_tr_b16 a[232:233], v35 offset:4096
    s_add_u32 m0, s86, 32768
    v_mfma_f32_16x16x32_bf16 v[128:131], a[216:219], v[212:215], v[128:131]
    ds_read_b64_tr_b16 a[234:235], v35 offset:6144
    s_add_u32 s88, s83, s77
    v_mfma_f32_16x16x32_bf16 v[132:135], a[216:219], v[216:219], v[132:135]
    buffer_load_dwordx4 v10, s[48:51], s88 offen nt lds
    s_waitcnt lgkmcnt(6)
    v_mfma_f32_16x16x32_bf16 v[148:151], a[220:223], v[208:211], v[148:151]
    ds_read_b64_tr_b16 a[236:237], v37 offset:4096
    v_mfma_f32_16x16x32_bf16 v[152:155], a[220:223], v[212:215], v[152:155]
    ds_read_b64_tr_b16 a[238:239], v37 offset:6144
    v_mfma_f32_16x16x32_bf16 v[156:159], a[220:223], v[216:219], v[156:159]
    buffer_load_dwordx4 v11, s[48:51], s88 offen offset:1024 nt lds
    s_waitcnt lgkmcnt(6)
    v_mfma_f32_16x16x32_bf16 v[76:79], a[224:227], v[208:211], v[76:79]
    ds_read_b64_tr_b16 a[240:241], v31 offset:4096
    v_mfma_f32_16x16x32_bf16 v[80:83], a[224:227], v[212:215], v[80:83]
    ds_read_b64_tr_b16 a[242:243], v31 offset:6144
    v_mfma_f32_16x16x32_bf16 v[84:87], a[224:227], v[216:219], v[84:87]
    buffer_load_dwordx4 v12, s[48:51], s88 offen offset:2048 nt lds
    s_waitcnt lgkmcnt(6)
    v_mfma_f32_16x16x32_bf16 v[100:103], a[228:231], v[208:211], v[100:103]
    ds_read_b64_tr_b16 a[244:245], v33 offset:4096
    v_mfma_f32_16x16x32_bf16 v[104:107], a[228:231], v[212:215], v[104:107]
    ds_read_b64_tr_b16 a[246:247], v33 offset:6144
    v_mfma_f32_16x16x32_bf16 v[108:111], a[228:231], v[216:219], v[108:111]
    buffer_load_dwordx4 v13, s[48:51], s88 offen offset:3072 nt lds
    s_waitcnt lgkmcnt(6)
    s_waitcnt vmcnt(20)
    s_barrier
    v_mfma_f32_16x16x32_bf16 v[124:127], a[232:235], v[232:235], v[124:127]
    ds_read_b64_tr_b16 a[216:217], v39 offset:49152
    s_add_u32 m0, s86, 98304
    v_mfma_f32_16x16x32_bf16 v[128:131], a[232:235], v[236:239], v[128:131]
    ds_read_b64_tr_b16 a[218:219], v39 offset:51200
    s_add_u32 s88, s82, s77
    v_mfma_f32_16x16x32_bf16 v[132:135], a[232:235], v[240:243], v[132:135]
    buffer_load_dwordx4 v10, s[48:51], s88 offen nt lds
    s_waitcnt lgkmcnt(6)
    v_mfma_f32_16x16x32_bf16 v[148:151], a[236:239], v[232:235], v[148:151]
    ds_read_b64_tr_b16 a[220:221], v39 offset:53248
    v_mfma_f32_16x16x32_bf16 v[152:155], a[236:239], v[236:239], v[152:155]
    ds_read_b64_tr_b16 a[222:223], v39 offset:55296
    v_mfma_f32_16x16x32_bf16 v[156:159], a[236:239], v[240:243], v[156:159]
    buffer_load_dwordx4 v11, s[48:51], s88 offen offset:1024 nt lds
    s_waitcnt lgkmcnt(6)
    v_mfma_f32_16x16x32_bf16 v[76:79], a[240:243], v[232:235], v[76:79]
    ds_read_b64_tr_b16 a[224:225], v39 offset:57344
    ds_write_b128 v40, v[124:127] offset:0
    v_mfma_f32_16x16x32_bf16 v[80:83], a[240:243], v[236:239], v[80:83]
    ds_read_b64_tr_b16 a[226:227], v39 offset:59392
    ds_write_b128 v40, v[128:131] offset:1024
    v_mfma_f32_16x16x32_bf16 v[84:87], a[240:243], v[240:243], v[84:87]
    buffer_load_dwordx4 v12, s[48:51], s88 offen offset:2048 nt lds
    s_waitcnt lgkmcnt(8)
    v_mfma_f32_16x16x32_bf16 v[100:103], a[244:247], v[232:235], v[100:103]
    ds_read_b64_tr_b16 a[228:229], v39 offset:61440
    ds_write_b128 v40, v[132:135] offset:2048
    v_mfma_f32_16x16x32_bf16 v[104:107], a[244:247], v[236:239], v[104:107]
    ds_read_b64_tr_b16 a[230:231], v39 offset:63488
    ds_write_b128 v40, v[148:151] offset:3072
    v_mfma_f32_16x16x32_bf16 v[108:111], a[244:247], v[240:243], v[108:111]
    buffer_load_dwordx4 v13, s[48:51], s88 offen offset:3072 nt lds
    ds_write_b128 v40, v[152:155] offset:4096
    ds_write_b128 v40, v[156:159] offset:5120
    v_pk_mul_f32 v[76:77], v[76:77], v[44:45] op_sel_hi:[1,0]
    v_pk_mul_f32 v[78:79], v[78:79], v[44:45] op_sel_hi:[1,0]
    v_pk_mul_f32 v[100:101], v[100:101], v[44:45] op_sel_hi:[1,0]
    v_pk_mul_f32 v[102:103], v[102:103], v[44:45] op_sel_hi:[1,0]
    v_pk_mul_f32 v[80:81], v[80:81], v[46:47] op_sel_hi:[1,0]
    v_pk_mul_f32 v[82:83], v[82:83], v[46:47] op_sel_hi:[1,0]
    v_pk_mul_f32 v[104:105], v[104:105], v[46:47] op_sel_hi:[1,0]
    v_pk_mul_f32 v[106:107], v[106:107], v[46:47] op_sel_hi:[1,0]
    v_pk_mul_f32 v[84:85], v[84:85], v[48:49] op_sel_hi:[1,0]
    v_pk_mul_f32 v[86:87], v[86:87], v[48:49] op_sel_hi:[1,0]
    v_pk_mul_f32 v[108:109], v[108:109], v[48:49] op_sel_hi:[1,0]
    v_pk_mul_f32 v[110:111], v[110:111], v[48:49] op_sel_hi:[1,0]
    s_waitcnt lgkmcnt(0)
    s_barrier
    ds_read_b128 v[172:175], v41 offset:0
    ds_read_b128 v[196:199], v41 offset:3072
    ds_read_b128 v[176:179], v41 offset:1024
    ds_read_b128 v[200:203], v41 offset:4096
    ds_read_b128 v[180:183], v41 offset:2048
    ds_read_b128 v[204:207], v41 offset:5120
    s_waitcnt lgkmcnt(5)
    v_pk_fma_f32 v[76:77], v[172:173], v[44:45], v[76:77] op_sel:[0,1,0] op_sel_hi:[1,1,1]
    v_pk_fma_f32 v[78:79], v[174:175], v[44:45], v[78:79] op_sel:[0,1,0] op_sel_hi:[1,1,1]
    s_waitcnt lgkmcnt(4)
    v_pk_fma_f32 v[100:101], v[196:197], v[44:45], v[100:101] op_sel:[0,1,0] op_sel_hi:[1,1,1]
    v_pk_fma_f32 v[102:103], v[198:199], v[44:45], v[102:103] op_sel:[0,1,0] op_sel_hi:[1,1,1]
    v_cvt_pk_bf16_f32 v172, v76, v77
    v_cvt_pk_bf16_f32 v173, v78, v79
    v_cvt_pk_bf16_f32 v174, v100, v101
    v_cvt_pk_bf16_f32 v175, v102, v103
    ds_write_b128 v41, v[172:175] offset:0
    s_waitcnt lgkmcnt(4)
    v_pk_fma_f32 v[80:81], v[176:177], v[46:47], v[80:81] op_sel:[0,1,0] op_sel_hi:[1,1,1]
    v_pk_fma_f32 v[82:83], v[178:179], v[46:47], v[82:83] op_sel:[0,1,0] op_sel_hi:[1,1,1]
    s_waitcnt lgkmcnt(3)
    v_pk_fma_f32 v[104:105], v[200:201], v[46:47], v[104:105] op_sel:[0,1,0] op_sel_hi:[1,1,1]
    v_pk_fma_f32 v[106:107], v[202:203], v[46:47], v[106:107] op_sel:[0,1,0] op_sel_hi:[1,1,1]
    v_cvt_pk_bf16_f32 v176, v80, v81
    v_cvt_pk_bf16_f32 v177, v82, v83
    v_cvt_pk_bf16_f32 v178, v104, v105
    v_cvt_pk_bf16_f32 v179, v106, v107
    ds_write_b128 v41, v[176:179] offset:1024
    s_waitcnt lgkmcnt(3)
    v_pk_fma_f32 v[84:85], v[180:181], v[48:49], v[84:85] op_sel:[0,1,0] op_sel_hi:[1,1,1]
    v_pk_fma_f32 v[86:87], v[182:183], v[48:49], v[86:87] op_sel:[0,1,0] op_sel_hi:[1,1,1]
    s_waitcnt lgkmcnt(2)
    v_pk_fma_f32 v[108:109], v[204:205], v[48:49], v[108:109] op_sel:[0,1,0] op_sel_hi:[1,1,1]
    v_pk_fma_f32 v[110:111], v[206:207], v[48:49], v[110:111] op_sel:[0,1,0] op_sel_hi:[1,1,1]
    v_cvt_pk_bf16_f32 v180, v84, v85
    v_cvt_pk_bf16_f32 v181, v86, v87
    v_cvt_pk_bf16_f32 v182, v108, v109
    v_cvt_pk_bf16_f32 v183, v110, v111
    ds_write_b128 v41, v[180:183] offset:2048
    s_waitcnt lgkmcnt(0)
    s_barrier
    ds_read_b128 a[84:87], v42 offset:6144
    ds_read_b128 a[88:91], v42 offset:7168
    ds_read_b128 a[92:95], v42 offset:8192
    ds_read_b128 a[96:99], v42 offset:0
    ds_read_b128 a[100:103], v42 offset:1024
    ds_read_b128 a[104:107], v42 offset:2048
    ds_read_b128 a[108:111], v42 offset:18432
    ds_read_b128 a[112:115], v42 offset:19456
    ds_read_b128 a[116:119], v42 offset:20480
    ds_read_b128 a[120:123], v42 offset:12288
    ds_read_b128 a[124:127], v42 offset:13312
    ds_read_b128 a[128:131], v42 offset:14336
    s_waitcnt lgkmcnt(0)
    s_waitcnt vmcnt(12)
    s_barrier
    v_mfma_f32_16x16x32_bf16 a[0:3], a[216:219], a[84:87], a[0:3]
    ds_read_b64_tr_b16 a[232:233], v38 offset:0
    s_add_u32 m0, s86, 65536
    v_mfma_f32_16x16x32_bf16 a[4:7], a[216:219], a[88:91], a[4:7]
    ds_read_b64_tr_b16 a[234:235], v38 offset:2048
    s_add_u32 s88, s73, s80
    v_mfma_f32_16x16x32_bf16 a[8:11], a[216:219], a[92:95], a[8:11]
    buffer_load_dwordx4 v14, s[52:55], s88 offen lds
    v_mfma_f32_16x16x32_bf16 a[0:3], a[220:223], a[96:99], a[0:3]
    ds_read_b64_tr_b16 a[236:237], v38 offset:4096
    v_mfma_f32_16x16x32_bf16 a[4:7], a[220:223], a[100:103], a[4:7]
    ds_read_b64_tr_b16 a[238:239], v38 offset:6144
    v_mfma_f32_16x16x32_bf16 a[8:11], a[220:223], a[104:107], a[8:11]
    buffer_load_dwordx4 v15, s[52:55], s88 offen offset:1024 lds
    v_mfma_f32_16x16x32_bf16 a[0:3], a[224:227], a[108:111], a[0:3]
    ds_read_b64_tr_b16 a[240:241], v38 offset:8192
    v_mfma_f32_16x16x32_bf16 a[4:7], a[224:227], a[112:115], a[4:7]
    ds_read_b64_tr_b16 a[242:243], v38 offset:10240
    v_mfma_f32_16x16x32_bf16 a[8:11], a[224:227], a[116:119], a[8:11]
    buffer_load_dwordx4 v16, s[52:55], s88 offen offset:2048 lds
    v_mfma_f32_16x16x32_bf16 a[0:3], a[228:231], a[120:123], a[0:3]
    ds_read_b64_tr_b16 a[244:245], v38 offset:12288
    v_mfma_f32_16x16x32_bf16 a[4:7], a[228:231], a[124:127], a[4:7]
    ds_read_b64_tr_b16 a[246:247], v38 offset:14336
    v_mfma_f32_16x16x32_bf16 a[8:11], a[228:231], a[128:131], a[8:11]
    buffer_load_dwordx4 v17, s[52:55], s88 offen offset:3072 lds
    s_waitcnt lgkmcnt(6)
    s_barrier
    v_mfma_f32_16x16x32_bf16 a[12:15], a[232:235], a[84:87], a[12:15]
    ds_read_b64_tr_b16 a[216:217], v39 offset:16384
    s_add_u32 m0, s86, 114688
    v_mfma_f32_16x16x32_bf16 a[16:19], a[232:235], a[88:91], a[16:19]
    ds_read_b64_tr_b16 a[218:219], v39 offset:18432
    s_add_u32 s88, s72, s80
    v_mfma_f32_16x16x32_bf16 a[20:23], a[232:235], a[92:95], a[20:23]
    buffer_load_dwordx4 v14, s[52:55], s88 offen lds
    s_waitcnt lgkmcnt(6)
    v_mfma_f32_16x16x32_bf16 a[12:15], a[236:239], a[96:99], a[12:15]
    ds_read_b64_tr_b16 a[220:221], v39 offset:20480
    v_mfma_f32_16x16x32_bf16 a[16:19], a[236:239], a[100:103], a[16:19]
    ds_read_b64_tr_b16 a[222:223], v39 offset:22528
    v_mfma_f32_16x16x32_bf16 a[20:23], a[236:239], a[104:107], a[20:23]
    buffer_load_dwordx4 v15, s[52:55], s88 offen offset:1024 lds
    s_waitcnt lgkmcnt(6)
    v_mfma_f32_16x16x32_bf16 a[12:15], a[240:243], a[108:111], a[12:15]
    ds_read_b64_tr_b16 a[224:225], v39 offset:24576
    v_mfma_f32_16x16x32_bf16 a[16:19], a[240:243], a[112:115], a[16:19]
    ds_read_b64_tr_b16 a[226:227], v39 offset:26624
    v_mfma_f32_16x16x32_bf16 a[20:23], a[240:243], a[116:119], a[20:23]
    buffer_load_dwordx4 v16, s[52:55], s88 offen offset:2048 lds
    s_waitcnt lgkmcnt(6)
    v_mfma_f32_16x16x32_bf16 a[12:15], a[244:247], a[120:123], a[12:15]
    ds_read_b64_tr_b16 a[228:229], v39 offset:28672
    v_mfma_f32_16x16x32_bf16 a[16:19], a[244:247], a[124:127], a[16:19]
    ds_read_b64_tr_b16 a[230:231], v39 offset:30720
    v_mfma_f32_16x16x32_bf16 a[20:23], a[244:247], a[128:131], a[20:23]
    buffer_load_dwordx4 v17, s[52:55], s88 offen offset:3072 lds
    s_waitcnt lgkmcnt(6)
    s_barrier
    v_mfma_f32_16x16x32_bf16 a[24:27], a[216:219], a[84:87], a[24:27]
    ds_read_b64_tr_b16 a[232:233], v38 offset:49152
    s_add_u32 m0, s86, 0
    v_mfma_f32_16x16x32_bf16 a[28:31], a[216:219], a[88:91], a[28:31]
    ds_read_b64_tr_b16 a[234:235], v38 offset:51200
    s_add_u32 s88, s84, s77
    v_mfma_f32_16x16x32_bf16 a[32:35], a[216:219], a[92:95], a[32:35]
    buffer_load_dwordx4 v10, s[48:51], s88 offen nt lds
    s_waitcnt lgkmcnt(6)
    v_mfma_f32_16x16x32_bf16 a[24:27], a[220:223], a[96:99], a[24:27]
    ds_read_b64_tr_b16 a[236:237], v38 offset:53248
    v_mfma_f32_16x16x32_bf16 a[28:31], a[220:223], a[100:103], a[28:31]
    ds_read_b64_tr_b16 a[238:239], v38 offset:55296
    v_mfma_f32_16x16x32_bf16 a[32:35], a[220:223], a[104:107], a[32:35]
    buffer_load_dwordx4 v11, s[48:51], s88 offen offset:1024 nt lds
    s_waitcnt lgkmcnt(6)
    v_mfma_f32_16x16x32_bf16 a[24:27], a[224:227], a[108:111], a[24:27]
    ds_read_b64_tr_b16 a[240:241], v38 offset:57344
    v_mfma_f32_16x16x32_bf16 a[28:31], a[224:227], a[112:115], a[28:31]
    ds_read_b64_tr_b16 a[242:243], v38 offset:59392
    v_mfma_f32_16x16x32_bf16 a[32:35], a[224:227], a[116:119], a[32:35]
    buffer_load_dwordx4 v12, s[48:51], s88 offen offset:2048 nt lds
    s_waitcnt lgkmcnt(6)
    v_mfma_f32_16x16x32_bf16 a[24:27], a[228:231], a[120:123], a[24:27]
    ds_read_b64_tr_b16 a[244:245], v38 offset:61440
    v_mfma_f32_16x16x32_bf16 a[28:31], a[228:231], a[124:127], a[28:31]
    ds_read_b64_tr_b16 a[246:247], v38 offset:63488
    v_mfma_f32_16x16x32_bf16 a[32:35], a[228:231], a[128:131], a[32:35]
    buffer_load_dwordx4 v13, s[48:51], s88 offen offset:3072 nt lds
    s_waitcnt lgkmcnt(6)
    s_waitcnt vmcnt(20)
    s_barrier
    v_mfma_f32_16x16x32_bf16 a[36:39], a[232:235], a[84:87], a[36:39]
    ds_read_b64_tr_b16 a[216:217], v38 offset:16384
    s_add_u32 m0, s86, 81920
    v_mfma_f32_16x16x32_bf16 a[40:43], a[232:235], a[88:91], a[40:43]
    ds_read_b64_tr_b16 a[218:219], v38 offset:18432
    s_add_u32 s88, s85, s77
    v_mfma_f32_16x16x32_bf16 a[44:47], a[232:235], a[92:95], a[44:47]
    buffer_load_dwordx4 v10, s[48:51], s88 offen nt lds
    s_waitcnt lgkmcnt(6)
    v_mfma_f32_16x16x32_bf16 a[36:39], a[236:239], a[96:99], a[36:39]
    ds_read_b64_tr_b16 a[220:221], v38 offset:20480
    v_mfma_f32_16x16x32_bf16 a[40:43], a[236:239], a[100:103], a[40:43]
    ds_read_b64_tr_b16 a[222:223], v38 offset:22528
    v_mfma_f32_16x16x32_bf16 a[44:47], a[236:239], a[104:107], a[44:47]
    buffer_load_dwordx4 v11, s[48:51], s88 offen offset:1024 nt lds
    s_waitcnt lgkmcnt(6)
    v_mfma_f32_16x16x32_bf16 a[36:39], a[240:243], a[108:111], a[36:39]
    ds_read_b64_tr_b16 a[224:225], v38 offset:24576
    v_mfma_f32_16x16x32_bf16 a[40:43], a[240:243], a[112:115], a[40:43]
    ds_read_b64_tr_b16 a[226:227], v38 offset:26624
    v_mfma_f32_16x16x32_bf16 a[44:47], a[240:243], a[116:119], a[44:47]
    buffer_load_dwordx4 v12, s[48:51], s88 offen offset:2048 nt lds
    s_waitcnt lgkmcnt(6)
    v_mfma_f32_16x16x32_bf16 a[36:39], a[244:247], a[120:123], a[36:39]
    ds_read_b64_tr_b16 a[228:229], v38 offset:28672
    v_mfma_f32_16x16x32_bf16 a[40:43], a[244:247], a[124:127], a[40:43]
    ds_read_b64_tr_b16 a[230:231], v38 offset:30720
    v_mfma_f32_16x16x32_bf16 a[44:47], a[244:247], a[128:131], a[44:47]
    buffer_load_dwordx4 v13, s[48:51], s88 offen offset:3072 nt lds
    s_waitcnt lgkmcnt(6)
    s_waitcnt vmcnt(8)
    s_barrier
    v_mfma_f32_16x16x32_bf16 a[48:51], a[216:219], a[84:87], a[48:51]
    ds_read_b64_tr_b16 a[232:233], v39 offset:49152
    v_mfma_f32_16x16x32_bf16 a[52:55], a[216:219], a[88:91], a[52:55]
    ds_read_b64_tr_b16 a[234:235], v39 offset:51200
    v_mfma_f32_16x16x32_bf16 a[56:59], a[216:219], a[92:95], a[56:59]
    s_waitcnt lgkmcnt(6)
    v_mfma_f32_16x16x32_bf16 a[48:51], a[220:223], a[96:99], a[48:51]
    ds_read_b64_tr_b16 a[236:237], v39 offset:53248
    v_mfma_f32_16x16x32_bf16 a[52:55], a[220:223], a[100:103], a[52:55]
    ds_read_b64_tr_b16 a[238:239], v39 offset:55296
    v_mfma_f32_16x16x32_bf16 a[56:59], a[220:223], a[104:107], a[56:59]
    s_waitcnt lgkmcnt(6)
    v_mfma_f32_16x16x32_bf16 a[48:51], a[224:227], a[108:111], a[48:51]
    ds_read_b64_tr_b16 a[240:241], v39 offset:57344
    v_mfma_f32_16x16x32_bf16 a[52:55], a[224:227], a[112:115], a[52:55]
    ds_read_b64_tr_b16 a[242:243], v39 offset:59392
    v_mfma_f32_16x16x32_bf16 a[56:59], a[224:227], a[116:119], a[56:59]
    s_waitcnt lgkmcnt(6)
    v_mfma_f32_16x16x32_bf16 a[48:51], a[228:231], a[120:123], a[48:51]
    ds_read_b64_tr_b16 a[244:245], v39 offset:61440
    v_mfma_f32_16x16x32_bf16 a[52:55], a[228:231], a[124:127], a[52:55]
    ds_read_b64_tr_b16 a[246:247], v39 offset:63488
    v_mfma_f32_16x16x32_bf16 a[56:59], a[228:231], a[128:131], a[56:59]
    s_waitcnt lgkmcnt(6)
    s_barrier
    v_mfma_f32_16x16x32_bf16 a[60:63], a[232:235], a[84:87], a[60:63]
    ds_read_b64_tr_b16 a[216:217], v39 offset:0
    v_mfma_f32_16x16x32_bf16 a[64:67], a[232:235], a[88:91], a[64:67]
    ds_read_b64_tr_b16 a[218:219], v39 offset:2048
    v_mfma_f32_16x16x32_bf16 a[68:71], a[232:235], a[92:95], a[68:71]
    s_waitcnt lgkmcnt(6)
    v_mfma_f32_16x16x32_bf16 a[60:63], a[236:239], a[96:99], a[60:63]
    ds_read_b64_tr_b16 a[220:221], v39 offset:4096
    v_mfma_f32_16x16x32_bf16 a[64:67], a[236:239], a[100:103], a[64:67]
    ds_read_b64_tr_b16 a[222:223], v39 offset:6144
    v_mfma_f32_16x16x32_bf16 a[68:71], a[236:239], a[104:107], a[68:71]
    s_waitcnt lgkmcnt(6)
    v_mfma_f32_16x16x32_bf16 a[60:63], a[240:243], a[108:111], a[60:63]
    ds_read_b64_tr_b16 a[224:225], v39 offset:8192
    v_mfma_f32_16x16x32_bf16 a[64:67], a[240:243], a[112:115], a[64:67]
    ds_read_b64_tr_b16 a[226:227], v39 offset:10240
    v_mfma_f32_16x16x32_bf16 a[68:71], a[240:243], a[116:119], a[68:71]
    s_waitcnt lgkmcnt(6)
    v_mfma_f32_16x16x32_bf16 a[60:63], a[244:247], a[120:123], a[60:63]
    ds_read_b64_tr_b16 a[228:229], v39 offset:12288
    v_mfma_f32_16x16x32_bf16 a[64:67], a[244:247], a[124:127], a[64:67]
    ds_read_b64_tr_b16 a[230:231], v39 offset:14336
    v_mfma_f32_16x16x32_bf16 a[68:71], a[244:247], a[128:131], a[68:71]
    s_waitcnt lgkmcnt(6)
    s_barrier
    v_mfma_f32_16x16x32_bf16 a[72:75], a[216:219], a[84:87], a[72:75]
    ds_read_b64_tr_b16 a[232:233], v31 offset:32768
    s_add_u32 m0, s86, 49152
    v_mfma_f32_16x16x32_bf16 a[76:79], a[216:219], a[88:91], a[76:79]
    ds_read_b64_tr_b16 a[234:235], v31 offset:34816
    s_add_u32 s88, s67, s81
    v_mfma_f32_16x16x32_bf16 a[80:83], a[216:219], a[92:95], a[80:83]
    buffer_load_dwordx4 v14, s[52:55], s88 offen lds
    s_waitcnt lgkmcnt(6)
    v_mfma_f32_16x16x32_bf16 a[72:75], a[220:223], a[96:99], a[72:75]
    ds_read_b64_tr_b16 a[236:237], v33 offset:32768
    v_mfma_f32_16x16x32_bf16 a[76:79], a[220:223], a[100:103], a[76:79]
    ds_read_b64_tr_b16 a[238:239], v33 offset:34816
    v_mfma_f32_16x16x32_bf16 a[80:83], a[220:223], a[104:107], a[80:83]
    buffer_load_dwordx4 v15, s[52:55], s88 offen offset:1024 lds
    s_waitcnt lgkmcnt(6)
    v_mfma_f32_16x16x32_bf16 a[72:75], a[224:227], a[108:111], a[72:75]
    ds_read_b64_tr_b16 a[240:241], v35 offset:32768
    v_mfma_f32_16x16x32_bf16 a[76:79], a[224:227], a[112:115], a[76:79]
    ds_read_b64_tr_b16 a[242:243], v35 offset:34816
    v_mfma_f32_16x16x32_bf16 a[80:83], a[224:227], a[116:119], a[80:83]
    buffer_load_dwordx4 v16, s[52:55], s88 offen offset:2048 lds
    s_waitcnt lgkmcnt(6)
    v_mfma_f32_16x16x32_bf16 a[72:75], a[228:231], a[120:123], a[72:75]
    ds_read_b64_tr_b16 a[244:245], v37 offset:32768
    v_mfma_f32_16x16x32_bf16 a[76:79], a[228:231], a[124:127], a[76:79]
    ds_read_b64_tr_b16 a[246:247], v37 offset:34816
    v_mfma_f32_16x16x32_bf16 a[80:83], a[228:231], a[128:131], a[80:83]
    buffer_load_dwordx4 v17, s[52:55], s88 offen offset:3072 lds
    s_waitcnt lgkmcnt(6)
    v_mfma_f32_16x16x32_bf16 v[76:79], a[232:235], v[64:67], 0
    ds_read_b64_tr_b16 a[216:217], v31 offset:36864
    s_add_u32 m0, s86, 16384
    v_mfma_f32_16x16x32_bf16 v[80:83], a[232:235], v[68:71], 0
    ds_read_b64_tr_b16 a[218:219], v31 offset:38912
    s_add_u32 s88, s69, s81
    v_mfma_f32_16x16x32_bf16 v[84:87], a[232:235], v[72:75], 0
    buffer_load_dwordx4 v14, s[52:55], s88 offen lds
    s_waitcnt lgkmcnt(6)
    v_mfma_f32_16x16x32_bf16 v[100:103], a[236:239], v[64:67], 0
    ds_read_b64_tr_b16 a[220:221], v33 offset:36864
    v_mfma_f32_16x16x32_bf16 v[104:107], a[236:239], v[68:71], 0
    ds_read_b64_tr_b16 a[222:223], v33 offset:38912
    v_mfma_f32_16x16x32_bf16 v[108:111], a[236:239], v[72:75], 0
    buffer_load_dwordx4 v15, s[52:55], s88 offen offset:1024 lds
    s_waitcnt lgkmcnt(6)
    v_mfma_f32_16x16x32_bf16 v[124:127], a[240:243], v[64:67], 0
    ds_read_b64_tr_b16 a[224:225], v35 offset:36864
    v_mfma_f32_16x16x32_bf16 v[128:131], a[240:243], v[68:71], 0
    ds_read_b64_tr_b16 a[226:227], v35 offset:38912
    v_mfma_f32_16x16x32_bf16 v[132:135], a[240:243], v[72:75], 0
    buffer_load_dwordx4 v16, s[52:55], s88 offen offset:2048 lds
    s_waitcnt lgkmcnt(6)
    v_mfma_f32_16x16x32_bf16 v[148:151], a[244:247], v[64:67], 0
    ds_read_b64_tr_b16 a[228:229], v37 offset:36864
    v_mfma_f32_16x16x32_bf16 v[152:155], a[244:247], v[68:71], 0
    ds_read_b64_tr_b16 a[230:231], v37 offset:38912
    v_mfma_f32_16x16x32_bf16 v[156:159], a[244:247], v[72:75], 0
    buffer_load_dwordx4 v17, s[52:55], s88 offen offset:3072 lds
    s_waitcnt lgkmcnt(6)
    s_barrier
    v_mfma_f32_16x16x32_bf16 v[76:79], a[216:219], v[88:91], v[76:79]
    ds_read_b64_tr_b16 a[232:233], v30 offset:32768
    v_mfma_f32_16x16x32_bf16 v[80:83], a[216:219], v[92:95], v[80:83]
    ds_read_b64_tr_b16 a[234:235], v30 offset:34816
    v_mfma_f32_16x16x32_bf16 v[84:87], a[216:219], v[96:99], v[84:87]
    s_waitcnt lgkmcnt(6)
    v_mfma_f32_16x16x32_bf16 v[100:103], a[220:223], v[88:91], v[100:103]
    ds_read_b64_tr_b16 a[236:237], v32 offset:32768
    v_mfma_f32_16x16x32_bf16 v[104:107], a[220:223], v[92:95], v[104:107]
    ds_read_b64_tr_b16 a[238:239], v32 offset:34816
    v_mfma_f32_16x16x32_bf16 v[108:111], a[220:223], v[96:99], v[108:111]
    s_waitcnt lgkmcnt(6)
    v_mfma_f32_16x16x32_bf16 v[124:127], a[224:227], v[88:91], v[124:127]
    ds_read_b64_tr_b16 a[240:241], v34 offset:32768
    v_mfma_f32_16x16x32_bf16 v[128:131], a[224:227], v[92:95], v[128:131]
    ds_read_b64_tr_b16 a[242:243], v34 offset:34816
    v_mfma_f32_16x16x32_bf16 v[132:135], a[224:227], v[96:99], v[132:135]
    s_waitcnt lgkmcnt(6)
    v_mfma_f32_16x16x32_bf16 v[148:151], a[228:231], v[88:91], v[148:151]
    ds_read_b64_tr_b16 a[244:245], v36 offset:32768
    v_mfma_f32_16x16x32_bf16 v[152:155], a[228:231], v[92:95], v[152:155]
    ds_read_b64_tr_b16 a[246:247], v36 offset:34816
    v_mfma_f32_16x16x32_bf16 v[156:159], a[228:231], v[96:99], v[156:159]
    s_waitcnt lgkmcnt(6)
    v_mfma_f32_16x16x32_bf16 v[76:79], a[232:235], v[112:115], v[76:79]
    ds_read_b64_tr_b16 a[216:217], v30 offset:36864
    s_add_u32 m0, s86, 114688
    v_mfma_f32_16x16x32_bf16 v[80:83], a[232:235], v[116:119], v[80:83]
    ds_read_b64_tr_b16 a[218:219], v30 offset:38912
    s_add_u32 s88, s70, s81
    v_mfma_f32_16x16x32_bf16 v[84:87], a[232:235], v[120:123], v[84:87]
    buffer_load_dwordx4 v14, s[52:55], s88 offen lds
    s_waitcnt lgkmcnt(6)
    v_mfma_f32_16x16x32_bf16 v[100:103], a[236:239], v[112:115], v[100:103]
    ds_read_b64_tr_b16 a[220:221], v32 offset:36864
    v_mfma_f32_16x16x32_bf16 v[104:107], a[236:239], v[116:119], v[104:107]
    ds_read_b64_tr_b16 a[222:223], v32 offset:38912
    v_mfma_f32_16x16x32_bf16 v[108:111], a[236:239], v[120:123], v[108:111]
    buffer_load_dwordx4 v15, s[52:55], s88 offen offset:1024 lds
    s_waitcnt lgkmcnt(6)
    v_mfma_f32_16x16x32_bf16 v[124:127], a[240:243], v[112:115], v[124:127]
    ds_read_b64_tr_b16 a[224:225], v34 offset:36864
    v_mfma_f32_16x16x32_bf16 v[128:131], a[240:243], v[116:119], v[128:131]
    ds_read_b64_tr_b16 a[226:227], v34 offset:38912
    v_mfma_f32_16x16x32_bf16 v[132:135], a[240:243], v[120:123], v[132:135]
    buffer_load_dwordx4 v16, s[52:55], s88 offen offset:2048 lds
    s_waitcnt lgkmcnt(6)
    v_mfma_f32_16x16x32_bf16 v[148:151], a[244:247], v[112:115], v[148:151]
    ds_read_b64_tr_b16 a[228:229], v36 offset:36864
    v_mfma_f32_16x16x32_bf16 v[152:155], a[244:247], v[116:119], v[152:155]
    ds_read_b64_tr_b16 a[230:231], v36 offset:38912
    v_mfma_f32_16x16x32_bf16 v[156:159], a[244:247], v[120:123], v[156:159]
    buffer_load_dwordx4 v17, s[52:55], s88 offen offset:3072 lds
    s_waitcnt lgkmcnt(6)
    s_waitcnt vmcnt(16)
    s_barrier
    v_mfma_f32_16x16x32_bf16 v[76:79], a[216:219], v[136:139], v[76:79]
    ds_read_b64_tr_b16 a[232:233], v30 offset:0
    v_mfma_f32_16x16x32_bf16 v[80:83], a[216:219], v[140:143], v[80:83]
    ds_read_b64_tr_b16 a[234:235], v30 offset:2048
    v_mfma_f32_16x16x32_bf16 v[84:87], a[216:219], v[144:147], v[84:87]
    s_waitcnt lgkmcnt(6)
    v_mfma_f32_16x16x32_bf16 v[100:103], a[220:223], v[136:139], v[100:103]
    ds_read_b64_tr_b16 a[236:237], v32 offset:0
    v_mfma_f32_16x16x32_bf16 v[104:107], a[220:223], v[140:143], v[104:107]
    ds_read_b64_tr_b16 a[238:239], v32 offset:2048
    v_mfma_f32_16x16x32_bf16 v[108:111], a[220:223], v[144:147], v[108:111]
    s_waitcnt lgkmcnt(6)
    v_mfma_f32_16x16x32_bf16 v[124:127], a[224:227], v[136:139], v[124:127]
    ds_read_b64_tr_b16 a[240:241], v34 offset:0
    v_mfma_f32_16x16x32_bf16 v[128:131], a[224:227], v[140:143], v[128:131]
    ds_read_b64_tr_b16 a[242:243], v34 offset:2048
    v_mfma_f32_16x16x32_bf16 v[132:135], a[224:227], v[144:147], v[132:135]
    s_waitcnt lgkmcnt(6)
    v_mfma_f32_16x16x32_bf16 v[148:151], a[228:231], v[136:139], v[148:151]
    ds_read_b64_tr_b16 a[244:245], v36 offset:0
    v_mfma_f32_16x16x32_bf16 v[152:155], a[228:231], v[140:143], v[152:155]
    ds_read_b64_tr_b16 a[246:247], v36 offset:2048
    v_mfma_f32_16x16x32_bf16 v[156:159], a[228:231], v[144:147], v[156:159]
    s_waitcnt lgkmcnt(6)
    v_mfma_f32_16x16x32_bf16 v[76:79], a[232:235], v[160:163], v[76:79]
    ds_read_b64_tr_b16 a[216:217], v30 offset:4096
    s_add_u32 m0, s86, 65536
    v_mfma_f32_16x16x32_bf16 v[80:83], a[232:235], v[164:167], v[80:83]
    ds_read_b64_tr_b16 a[218:219], v30 offset:6144
    s_add_u32 s88, s68, s81
    v_mfma_f32_16x16x32_bf16 v[84:87], a[232:235], v[168:171], v[84:87]
    buffer_load_dwordx4 v14, s[52:55], s88 offen lds
    s_waitcnt lgkmcnt(6)
    v_mfma_f32_16x16x32_bf16 v[100:103], a[236:239], v[160:163], v[100:103]
    ds_read_b64_tr_b16 a[220:221], v32 offset:4096
    v_mfma_f32_16x16x32_bf16 v[104:107], a[236:239], v[164:167], v[104:107]
    ds_read_b64_tr_b16 a[222:223], v32 offset:6144
    v_mfma_f32_16x16x32_bf16 v[108:111], a[236:239], v[168:171], v[108:111]
    buffer_load_dwordx4 v15, s[52:55], s88 offen offset:1024 lds
    s_waitcnt lgkmcnt(6)
    v_mfma_f32_16x16x32_bf16 v[124:127], a[240:243], v[160:163], v[124:127]
    ds_read_b64_tr_b16 a[224:225], v34 offset:4096
    v_mfma_f32_16x16x32_bf16 v[128:131], a[240:243], v[164:167], v[128:131]
    ds_read_b64_tr_b16 a[226:227], v34 offset:6144
    v_mfma_f32_16x16x32_bf16 v[132:135], a[240:243], v[168:171], v[132:135]
    buffer_load_dwordx4 v16, s[52:55], s88 offen offset:2048 lds
    s_waitcnt lgkmcnt(6)
    v_mfma_f32_16x16x32_bf16 v[148:151], a[244:247], v[160:163], v[148:151]
    ds_read_b64_tr_b16 a[228:229], v36 offset:4096
    v_mfma_f32_16x16x32_bf16 v[152:155], a[244:247], v[164:167], v[152:155]
    ds_read_b64_tr_b16 a[230:231], v36 offset:6144
    v_mfma_f32_16x16x32_bf16 v[156:159], a[244:247], v[168:171], v[156:159]
    buffer_load_dwordx4 v17, s[52:55], s88 offen offset:3072 lds
    s_waitcnt lgkmcnt(6)
    s_waitcnt vmcnt(16)
    s_barrier
    v_mfma_f32_16x16x32_bf16 v[76:79], a[216:219], v[184:187], v[76:79]
    ds_read_b64_tr_b16 a[232:233], v35 offset:16384
    v_mfma_f32_16x16x32_bf16 v[80:83], a[216:219], v[188:191], v[80:83]
    ds_read_b64_tr_b16 a[234:235], v35 offset:18432
    v_mfma_f32_16x16x32_bf16 v[84:87], a[216:219], v[192:195], v[84:87]
    s_waitcnt lgkmcnt(6)
    v_mfma_f32_16x16x32_bf16 v[100:103], a[220:223], v[184:187], v[100:103]
    ds_read_b64_tr_b16 a[236:237], v37 offset:16384
    v_mfma_f32_16x16x32_bf16 v[104:107], a[220:223], v[188:191], v[104:107]
    ds_read_b64_tr_b16 a[238:239], v37 offset:18432
    v_mfma_f32_16x16x32_bf16 v[108:111], a[220:223], v[192:195], v[108:111]
    s_waitcnt lgkmcnt(6)
    v_mfma_f32_16x16x32_bf16 v[124:127], a[224:227], v[184:187], v[124:127]
    ds_read_b64_tr_b16 a[240:241], v31 offset:16384
    v_mfma_f32_16x16x32_bf16 v[128:131], a[224:227], v[188:191], v[128:131]
    ds_read_b64_tr_b16 a[242:243], v31 offset:18432
    v_mfma_f32_16x16x32_bf16 v[132:135], a[224:227], v[192:195], v[132:135]
    s_waitcnt lgkmcnt(6)
    v_mfma_f32_16x16x32_bf16 v[148:151], a[228:231], v[184:187], v[148:151]
    ds_read_b64_tr_b16 a[244:245], v33 offset:16384
    v_mfma_f32_16x16x32_bf16 v[152:155], a[228:231], v[188:191], v[152:155]
    ds_read_b64_tr_b16 a[246:247], v33 offset:18432
    v_mfma_f32_16x16x32_bf16 v[156:159], a[228:231], v[192:195], v[156:159]
    s_waitcnt lgkmcnt(6)
    v_mfma_f32_16x16x32_bf16 v[124:127], a[232:235], v[208:211], v[124:127]
    ds_read_b64_tr_b16 a[216:217], v35 offset:20480
    v_mfma_f32_16x16x32_bf16 v[128:131], a[232:235], v[212:215], v[128:131]
    ds_read_b64_tr_b16 a[218:219], v35 offset:22528
    v_mfma_f32_16x16x32_bf16 v[132:135], a[232:235], v[216:219], v[132:135]
    s_waitcnt lgkmcnt(6)
    v_mfma_f32_16x16x32_bf16 v[148:151], a[236:239], v[208:211], v[148:151]
    ds_read_b64_tr_b16 a[220:221], v37 offset:20480
    v_mfma_f32_16x16x32_bf16 v[152:155], a[236:239], v[212:215], v[152:155]
    ds_read_b64_tr_b16 a[222:223], v37 offset:22528
    v_mfma_f32_16x16x32_bf16 v[156:159], a[236:239], v[216:219], v[156:159]
    s_waitcnt lgkmcnt(6)
    v_mfma_f32_16x16x32_bf16 v[76:79], a[240:243], v[208:211], v[76:79]
    ds_read_b64_tr_b16 a[224:225], v31 offset:20480
    v_mfma_f32_16x16x32_bf16 v[80:83], a[240:243], v[212:215], v[80:83]
    ds_read_b64_tr_b16 a[226:227], v31 offset:22528
    v_mfma_f32_16x16x32_bf16 v[84:87], a[240:243], v[216:219], v[84:87]
    s_waitcnt lgkmcnt(6)
    v_mfma_f32_16x16x32_bf16 v[100:103], a[244:247], v[208:211], v[100:103]
    ds_read_b64_tr_b16 a[228:229], v33 offset:20480
    v_mfma_f32_16x16x32_bf16 v[104:107], a[244:247], v[212:215], v[104:107]
    ds_read_b64_tr_b16 a[230:231], v33 offset:22528
    v_mfma_f32_16x16x32_bf16 v[108:111], a[244:247], v[216:219], v[108:111]
    s_waitcnt lgkmcnt(6)
    s_waitcnt vmcnt(12)
    s_barrier
    v_mfma_f32_16x16x32_bf16 v[124:127], a[216:219], v[232:235], v[124:127]
    ds_read_b64_tr_b16 a[232:233], v38 offset:49152
    v_mfma_f32_16x16x32_bf16 v[128:131], a[216:219], v[236:239], v[128:131]
    ds_read_b64_tr_b16 a[234:235], v38 offset:51200
    v_mfma_f32_16x16x32_bf16 v[132:135], a[216:219], v[240:243], v[132:135]
    s_waitcnt lgkmcnt(6)
    v_mfma_f32_16x16x32_bf16 v[148:151], a[220:223], v[232:235], v[148:151]
    ds_read_b64_tr_b16 a[236:237], v38 offset:53248
    v_mfma_f32_16x16x32_bf16 v[152:155], a[220:223], v[236:239], v[152:155]
    ds_read_b64_tr_b16 a[238:239], v38 offset:55296
    v_mfma_f32_16x16x32_bf16 v[156:159], a[220:223], v[240:243], v[156:159]
    s_waitcnt lgkmcnt(6)
    v_mfma_f32_16x16x32_bf16 v[76:79], a[224:227], v[232:235], v[76:79]
    ds_read_b64_tr_b16 a[240:241], v38 offset:57344
    ds_write_b128 v40, v[124:127] offset:0
    v_mfma_f32_16x16x32_bf16 v[80:83], a[224:227], v[236:239], v[80:83]
    ds_read_b64_tr_b16 a[242:243], v38 offset:59392
    ds_write_b128 v40, v[128:131] offset:1024
    v_mfma_f32_16x16x32_bf16 v[84:87], a[224:227], v[240:243], v[84:87]
    ds_write_b128 v40, v[132:135] offset:2048
    s_waitcnt lgkmcnt(9)
    v_mfma_f32_16x16x32_bf16 v[100:103], a[228:231], v[232:235], v[100:103]
    ds_read_b64_tr_b16 a[244:245], v38 offset:61440
    ds_write_b128 v40, v[148:151] offset:3072
    v_mfma_f32_16x16x32_bf16 v[104:107], a[228:231], v[236:239], v[104:107]
    ds_read_b64_tr_b16 a[246:247], v38 offset:63488
    ds_write_b128 v40, v[152:155] offset:4096
    v_mfma_f32_16x16x32_bf16 v[108:111], a[228:231], v[240:243], v[108:111]
    ds_write_b128 v40, v[156:159] offset:5120
    v_pk_mul_f32 v[76:77], v[76:77], v[44:45] op_sel_hi:[1,0]
    s_add_u32 m0, s86, 98304
    s_add_u32 s88, s73, s81
    buffer_load_dwordx4 v14, s[52:55], s88 offen lds
    v_pk_mul_f32 v[78:79], v[78:79], v[44:45] op_sel_hi:[1,0]
    v_pk_mul_f32 v[100:101], v[100:101], v[44:45] op_sel_hi:[1,0]
    v_pk_mul_f32 v[102:103], v[102:103], v[44:45] op_sel_hi:[1,0]
    v_pk_mul_f32 v[80:81], v[80:81], v[46:47] op_sel_hi:[1,0]
    v_pk_mul_f32 v[82:83], v[82:83], v[46:47] op_sel_hi:[1,0]
    v_pk_mul_f32 v[104:105], v[104:105], v[46:47] op_sel_hi:[1,0]
    v_pk_mul_f32 v[106:107], v[106:107], v[46:47] op_sel_hi:[1,0]
    v_pk_mul_f32 v[84:85], v[84:85], v[48:49] op_sel_hi:[1,0]
    v_pk_mul_f32 v[86:87], v[86:87], v[48:49] op_sel_hi:[1,0]
    v_pk_mul_f32 v[108:109], v[108:109], v[48:49] op_sel_hi:[1,0]
    v_pk_mul_f32 v[110:111], v[110:111], v[48:49] op_sel_hi:[1,0]
    buffer_load_dwordx4 v15, s[52:55], s88 offen offset:1024 lds
    s_waitcnt lgkmcnt(0)
    s_barrier
    ds_read_b128 v[172:175], v41 offset:0
    ds_read_b128 v[196:199], v41 offset:3072
    ds_read_b128 v[176:179], v41 offset:1024
    ds_read_b128 v[200:203], v41 offset:4096
    ds_read_b128 v[180:183], v41 offset:2048
    ds_read_b128 v[204:207], v41 offset:5120
    s_waitcnt lgkmcnt(5)
    v_pk_fma_f32 v[76:77], v[172:173], v[44:45], v[76:77] op_sel:[0,1,0] op_sel_hi:[1,1,1]
    v_pk_fma_f32 v[78:79], v[174:175], v[44:45], v[78:79] op_sel:[0,1,0] op_sel_hi:[1,1,1]
    s_waitcnt lgkmcnt(4)
    v_pk_fma_f32 v[100:101], v[196:197], v[44:45], v[100:101] op_sel:[0,1,0] op_sel_hi:[1,1,1]
    buffer_load_dwordx4 v16, s[52:55], s88 offen offset:2048 lds
    v_pk_fma_f32 v[102:103], v[198:199], v[44:45], v[102:103] op_sel:[0,1,0] op_sel_hi:[1,1,1]
    v_cvt_pk_bf16_f32 v172, v76, v77
    v_cvt_pk_bf16_f32 v173, v78, v79
    v_cvt_pk_bf16_f32 v174, v100, v101
    v_cvt_pk_bf16_f32 v175, v102, v103
    ds_write_b128 v41, v[172:175] offset:0
    s_waitcnt lgkmcnt(4)
    v_pk_fma_f32 v[80:81], v[176:177], v[46:47], v[80:81] op_sel:[0,1,0] op_sel_hi:[1,1,1]
    v_pk_fma_f32 v[82:83], v[178:179], v[46:47], v[82:83] op_sel:[0,1,0] op_sel_hi:[1,1,1]
    s_waitcnt lgkmcnt(3)
    v_pk_fma_f32 v[104:105], v[200:201], v[46:47], v[104:105] op_sel:[0,1,0] op_sel_hi:[1,1,1]
    buffer_load_dwordx4 v17, s[52:55], s88 offen offset:3072 lds
    v_pk_fma_f32 v[106:107], v[202:203], v[46:47], v[106:107] op_sel:[0,1,0] op_sel_hi:[1,1,1]
    v_cvt_pk_bf16_f32 v176, v80, v81
    v_cvt_pk_bf16_f32 v177, v82, v83
    v_cvt_pk_bf16_f32 v178, v104, v105
    v_cvt_pk_bf16_f32 v179, v106, v107
    ds_write_b128 v41, v[176:179] offset:1024
    s_waitcnt lgkmcnt(3)
    v_pk_fma_f32 v[84:85], v[180:181], v[48:49], v[84:85] op_sel:[0,1,0] op_sel_hi:[1,1,1]
    v_pk_fma_f32 v[86:87], v[182:183], v[48:49], v[86:87] op_sel:[0,1,0] op_sel_hi:[1,1,1]
    s_waitcnt lgkmcnt(2)
    v_pk_fma_f32 v[108:109], v[204:205], v[48:49], v[108:109] op_sel:[0,1,0] op_sel_hi:[1,1,1]
    v_pk_fma_f32 v[110:111], v[206:207], v[48:49], v[110:111] op_sel:[0,1,0] op_sel_hi:[1,1,1]
    v_cvt_pk_bf16_f32 v180, v84, v85
    v_cvt_pk_bf16_f32 v181, v86, v87
    v_cvt_pk_bf16_f32 v182, v108, v109
    v_cvt_pk_bf16_f32 v183, v110, v111
    ds_write_b128 v41, v[180:183] offset:2048
    s_waitcnt lgkmcnt(0)
    s_barrier
    ds_read_b128 a[132:135], v42 offset:6144
    ds_read_b128 a[136:139], v42 offset:7168
    ds_read_b128 a[140:143], v42 offset:8192
    ds_read_b128 a[144:147], v42 offset:0
    ds_read_b128 a[148:151], v42 offset:1024
    ds_read_b128 a[152:155], v42 offset:2048
    ds_read_b128 a[156:159], v42 offset:18432
    ds_read_b128 a[160:163], v42 offset:19456
    ds_read_b128 a[164:167], v42 offset:20480
    ds_read_b128 a[168:171], v42 offset:12288
    ds_read_b128 a[172:175], v42 offset:13312
    ds_read_b128 a[176:179], v42 offset:14336
    s_waitcnt lgkmcnt(0)
    s_waitcnt vmcnt(4)
    s_barrier
    v_mfma_f32_16x16x32_bf16 a[0:3], a[232:235], a[132:135], a[0:3]
    ds_read_b64_tr_b16 a[216:217], v39 offset:0
    s_add_u32 m0, s86, 32768
    s_add_u32 s88, s71, s81
    buffer_load_dwordx4 v14, s[52:55], s88 offen lds
    v_mfma_f32_16x16x32_bf16 a[4:7], a[232:235], a[136:139], a[4:7]
    ds_read_b64_tr_b16 a[218:219], v39 offset:2048
    s_lshl_b32 s96, s93, 3
    s_add_u32 s96, s96, 0
    s_add_u32 s24, s30, s96
    v_mfma_f32_16x16x32_bf16 a[8:11], a[232:235], a[140:143], a[8:11]
    s_addc_u32 s25, s31, 0
    v_mov_b32 v41, 0
    global_load_dword v43, v41, s[24:25] sc1
    v_mfma_f32_16x16x32_bf16 a[0:3], a[236:239], a[144:147], a[0:3]
    ds_read_b64_tr_b16 a[220:221], v39 offset:4096
    buffer_load_dwordx4 v15, s[52:55], s88 offen offset:1024 lds
    v_and_b32 v61, 15, v1
    v_mul_u32_u24 v56, 144, v61
    v_mfma_f32_16x16x32_bf16 a[4:7], a[236:239], a[148:151], a[4:7]
    ds_read_b64_tr_b16 a[222:223], v39 offset:6144
    v_lshrrev_b32 v62, 4, v1
    v_lshlrev_b32 v62, 3, v62
    v_add_u32 v56, v56, v62
    v_mfma_f32_16x16x32_bf16 a[8:11], a[236:239], a[152:155], a[8:11]
    s_lshl_b32 s96, s87, 5
    s_add_u32 s96, s96, 131072
    v_add_u32 v56, s96, v56
    v_mfma_f32_16x16x32_bf16 a[0:3], a[240:243], a[156:159], a[0:3]
    ds_read_b64_tr_b16 a[224:225], v39 offset:8192
    buffer_load_dwordx4 v16, s[52:55], s88 offen offset:2048 lds
    s_mul_i32 s96, s87, 12
    v_lshrrev_b32 v61, 3, v1
    v_mfma_f32_16x16x32_bf16 a[4:7], a[240:243], a[160:163], a[4:7]
    ds_read_b64_tr_b16 a[226:227], v39 offset:10240
    v_and_b32 v62, 7, v1
    v_lshlrev_b32 v62, 4, v62
    v_add_u32 v63, s96, v61
    v_mfma_f32_16x16x32_bf16 a[8:11], a[240:243], a[164:167], a[8:11]
    v_mul_u32_u24 v57, 144, v63
    v_add_u32 v57, v57, v62
    v_add_u32 v57, 131072, v57
    v_mfma_f32_16x16x32_bf16 a[0:3], a[244:247], a[168:171], a[0:3]
    ds_read_b64_tr_b16 a[228:229], v39 offset:12288
    buffer_load_dwordx4 v17, s[52:55], s88 offen offset:3072 lds
    s_add_u32 m0, s86, 0
    s_add_u32 s88, s72, s81
    v_mfma_f32_16x16x32_bf16 a[4:7], a[244:247], a[172:175], a[4:7]
    ds_read_b64_tr_b16 a[230:231], v39 offset:14336
    v_lshlrev_b32 v59, 7, v63
    v_add_u32 v59, v59, v62
    v_and_b32 v61, 3, v61
    v_mfma_f32_16x16x32_bf16 a[8:11], a[244:247], a[176:179], a[8:11]
    v_add_u32 v61, 8, v61
    v_add_u32 v63, s96, v61
    v_mul_u32_u24 v58, 144, v63
    s_waitcnt lgkmcnt(6)
    s_barrier
    v_mfma_f32_16x16x32_bf16 a[12:15], a[216:219], a[132:135], a[12:15]
    ds_read_b64_tr_b16 a[232:233], v38 offset:16384
    buffer_load_dwordx4 v14, s[52:55], s88 offen lds
    v_add_u32 v58, v58, v62
    v_add_u32 v58, 131072, v58
    v_mfma_f32_16x16x32_bf16 a[16:19], a[216:219], a[136:139], a[16:19]
    ds_read_b64_tr_b16 a[234:235], v38 offset:18432
    v_lshlrev_b32 v60, 7, v63
    v_add_u32 v60, v60, v62
    v_accvgpr_read_b32 v44, a0
    v_mfma_f32_16x16x32_bf16 a[20:23], a[216:219], a[140:143], a[20:23]
    v_accvgpr_read_b32 v45, a1
    v_accvgpr_read_b32 v46, a2
    v_accvgpr_read_b32 v47, a3
    s_waitcnt lgkmcnt(6)
    v_mfma_f32_16x16x32_bf16 a[12:15], a[220:223], a[144:147], a[12:15]
    ds_read_b64_tr_b16 a[236:237], v38 offset:20480
    buffer_load_dwordx4 v15, s[52:55], s88 offen offset:1024 lds
    v_cvt_pk_bf16_f32 v44, v44, v45
    v_cvt_pk_bf16_f32 v45, v46, v47
    v_mfma_f32_16x16x32_bf16 a[16:19], a[220:223], a[148:151], a[16:19]
    ds_read_b64_tr_b16 a[238:239], v38 offset:22528
    ds_write_b64 v56, v[44:45] offset:0
    v_accvgpr_read_b32 v48, a4
    v_accvgpr_read_b32 v49, a5
    v_mfma_f32_16x16x32_bf16 a[20:23], a[220:223], a[152:155], a[20:23]
    v_accvgpr_read_b32 v50, a6
    v_accvgpr_read_b32 v51, a7
    v_cvt_pk_bf16_f32 v48, v48, v49
    s_waitcnt lgkmcnt(7)
    v_mfma_f32_16x16x32_bf16 a[12:15], a[224:227], a[156:159], a[12:15]
    ds_read_b64_tr_b16 a[240:241], v38 offset:24576
    buffer_load_dwordx4 v16, s[52:55], s88 offen offset:2048 lds
    v_cvt_pk_bf16_f32 v49, v50, v51
    ds_write_b64 v56, v[48:49] offset:2304
    v_mfma_f32_16x16x32_bf16 a[16:19], a[224:227], a[160:163], a[16:19]
    ds_read_b64_tr_b16 a[242:243], v38 offset:26624
    v_accvgpr_read_b32 v44, a8
    v_accvgpr_read_b32 v45, a9
    v_accvgpr_read_b32 v46, a10
    v_mfma_f32_16x16x32_bf16 a[20:23], a[224:227], a[164:167], a[20:23]
    v_accvgpr_read_b32 v47, a11
    v_cvt_pk_bf16_f32 v44, v44, v45
    v_cvt_pk_bf16_f32 v45, v46, v47
    s_waitcnt lgkmcnt(8)
    v_mfma_f32_16x16x32_bf16 a[12:15], a[228:231], a[168:171], a[12:15]
    ds_read_b64_tr_b16 a[244:245], v38 offset:28672
    buffer_load_dwordx4 v17, s[52:55], s88 offen offset:3072 lds
    ds_write_b64 v56, v[44:45] offset:4608
    v_mfma_f32_16x16x32_bf16 a[16:19], a[228:231], a[172:175], a[16:19]
    ds_read_b64_tr_b16 a[246:247], v38 offset:30720
    v_mfma_f32_16x16x32_bf16 a[20:23], a[228:231], a[176:179], a[20:23]
    s_waitcnt lgkmcnt(9)
    s_waitcnt lgkmcnt(1)
    s_barrier
    v_mfma_f32_16x16x32_bf16 a[24:27], a[232:235], a[132:135], a[24:27]
    ds_read_b64_tr_b16 a[216:217], v39 offset:49152
    ds_read_b128 v[76:79], v57 offset:0
    ds_read_b128 v[80:83], v58 offset:0
    v_accvgpr_read_b32 v48, a12
    v_mfma_f32_16x16x32_bf16 a[28:31], a[232:235], a[136:139], a[28:31]
    ds_read_b64_tr_b16 a[218:219], v39 offset:51200
    v_accvgpr_read_b32 v49, a13
    v_accvgpr_read_b32 v50, a14
    v_accvgpr_read_b32 v51, a15
    v_mfma_f32_16x16x32_bf16 a[32:35], a[232:235], a[140:143], a[32:35]
    v_cvt_pk_bf16_f32 v48, v48, v49
    v_cvt_pk_bf16_f32 v49, v50, v51
    ds_write_b64 v56, v[48:49] offset:6912
    v_mfma_f32_16x16x32_bf16 a[24:27], a[236:239], a[144:147], a[24:27]
    ds_read_b64_tr_b16 a[220:221], v39 offset:53248
    v_accvgpr_read_b32 v44, a16
    v_accvgpr_read_b32 v45, a17
    v_accvgpr_read_b32 v46, a18
    v_mfma_f32_16x16x32_bf16 a[28:31], a[236:239], a[148:151], a[28:31]
    ds_read_b64_tr_b16 a[222:223], v39 offset:55296
    v_accvgpr_read_b32 v47, a19
    v_cvt_pk_bf16_f32 v44, v44, v45
    v_cvt_pk_bf16_f32 v45, v46, v47
    v_mfma_f32_16x16x32_bf16 a[32:35], a[236:239], a[152:155], a[32:35]
    ds_write_b64 v56, v[44:45] offset:9216
    v_accvgpr_read_b32 v48, a20
    v_accvgpr_read_b32 v49, a21
    v_mfma_f32_16x16x32_bf16 a[24:27], a[240:243], a[156:159], a[24:27]
    ds_read_b64_tr_b16 a[224:225], v39 offset:57344
    v_accvgpr_read_b32 v50, a22
    v_accvgpr_read_b32 v51, a23
    v_cvt_pk_bf16_f32 v48, v48, v49
    v_mfma_f32_16x16x32_bf16 a[28:31], a[240:243], a[160:163], a[28:31]
    ds_read_b64_tr_b16 a[226:227], v39 offset:59392
    v_cvt_pk_bf16_f32 v49, v50, v51
    ds_write_b64 v56, v[48:49] offset:11520
    s_mov_b32 s97, 0
    v_mfma_f32_16x16x32_bf16 a[32:35], a[240:243], a[164:167], a[32:35]
    s_waitcnt lgkmcnt(8)
    buffer_store_dwordx4 v[76:79], v59, s[56:59], s97 offen sc1
    buffer_store_dwordx4 v[80:83], v60, s[56:59], s97 offen sc1
    v_mfma_f32_16x16x32_bf16 a[24:27], a[244:247], a[168:171], a[24:27]
    ds_read_b64_tr_b16 a[228:229], v39 offset:61440
    v_mfma_f32_16x16x32_bf16 a[28:31], a[244:247], a[172:175], a[28:31]
    ds_read_b64_tr_b16 a[230:231], v39 offset:63488
    v_mfma_f32_16x16x32_bf16 a[32:35], a[244:247], a[176:179], a[32:35]
    s_waitcnt lgkmcnt(9)
    s_waitcnt vmcnt(6)
    s_waitcnt lgkmcnt(2)
    s_barrier
    v_mfma_f32_16x16x32_bf16 a[36:39], a[216:219], a[132:135], a[36:39]
    ds_read_b64_tr_b16 a[232:233], v38 offset:32768
    ds_read_b128 v[84:87], v57 offset:6912
    ds_read_b128 v[100:103], v58 offset:6912
    v_accvgpr_read_b32 v44, a24
    v_mfma_f32_16x16x32_bf16 a[40:43], a[216:219], a[136:139], a[40:43]
    ds_read_b64_tr_b16 a[234:235], v38 offset:34816
    v_accvgpr_read_b32 v45, a25
    v_accvgpr_read_b32 v46, a26
    v_accvgpr_read_b32 v47, a27
    v_mfma_f32_16x16x32_bf16 a[44:47], a[216:219], a[140:143], a[44:47]
    v_cvt_pk_bf16_f32 v44, v44, v45
    v_cvt_pk_bf16_f32 v45, v46, v47
    ds_write_b64 v56, v[44:45] offset:0
    v_mfma_f32_16x16x32_bf16 a[36:39], a[220:223], a[144:147], a[36:39]
    ds_read_b64_tr_b16 a[236:237], v38 offset:36864
    v_accvgpr_read_b32 v48, a28
    v_accvgpr_read_b32 v49, a29
    v_accvgpr_read_b32 v50, a30
    v_mfma_f32_16x16x32_bf16 a[40:43], a[220:223], a[148:151], a[40:43]
    ds_read_b64_tr_b16 a[238:239], v38 offset:38912
    v_accvgpr_read_b32 v51, a31
    v_cvt_pk_bf16_f32 v48, v48, v49
    v_cvt_pk_bf16_f32 v49, v50, v51
    v_mfma_f32_16x16x32_bf16 a[44:47], a[220:223], a[152:155], a[44:47]
    ds_write_b64 v56, v[48:49] offset:2304
    v_accvgpr_read_b32 v44, a32
    v_accvgpr_read_b32 v45, a33
    v_mfma_f32_16x16x32_bf16 a[36:39], a[224:227], a[156:159], a[36:39]
    ds_read_b64_tr_b16 a[240:241], v38 offset:40960
    v_accvgpr_read_b32 v46, a34
    v_accvgpr_read_b32 v47, a35
    v_cvt_pk_bf16_f32 v44, v44, v45
    v_mfma_f32_16x16x32_bf16 a[40:43], a[224:227], a[160:163], a[40:43]
    ds_read_b64_tr_b16 a[242:243], v38 offset:43008
    v_cvt_pk_bf16_f32 v45, v46, v47
    ds_write_b64 v56, v[44:45] offset:4608
    s_mov_b32 s97, 6144
    v_mfma_f32_16x16x32_bf16 a[44:47], a[224:227], a[164:167], a[44:47]
    s_waitcnt lgkmcnt(8)
    buffer_store_dwordx4 v[84:87], v59, s[56:59], s97 offen sc1
    buffer_store_dwordx4 v[100:103], v60, s[56:59], s97 offen sc1
    v_mfma_f32_16x16x32_bf16 a[36:39], a[228:231], a[168:171], a[36:39]
    ds_read_b64_tr_b16 a[244:245], v38 offset:45056
    v_mfma_f32_16x16x32_bf16 a[40:43], a[228:231], a[172:175], a[40:43]
    ds_read_b64_tr_b16 a[246:247], v38 offset:47104
    v_mfma_f32_16x16x32_bf16 a[44:47], a[228:231], a[176:179], a[44:47]
    s_waitcnt lgkmcnt(9)
    s_waitcnt vmcnt(4)
    s_waitcnt lgkmcnt(2)
    s_barrier
    v_mfma_f32_16x16x32_bf16 a[48:51], a[232:235], a[132:135], a[48:51]
    ds_read_b64_tr_b16 a[216:217], v38 offset:0
    ds_read_b128 v[104:107], v57 offset:0
    ds_read_b128 v[108:111], v58 offset:0
    v_accvgpr_read_b32 v48, a36
    v_mfma_f32_16x16x32_bf16 a[52:55], a[232:235], a[136:139], a[52:55]
    ds_read_b64_tr_b16 a[218:219], v38 offset:2048
    v_accvgpr_read_b32 v49, a37
    v_accvgpr_read_b32 v50, a38
    v_accvgpr_read_b32 v51, a39
    v_mfma_f32_16x16x32_bf16 a[56:59], a[232:235], a[140:143], a[56:59]
    v_cvt_pk_bf16_f32 v48, v48, v49
    v_cvt_pk_bf16_f32 v49, v50, v51
    ds_write_b64 v56, v[48:49] offset:6912
    v_mfma_f32_16x16x32_bf16 a[48:51], a[236:239], a[144:147], a[48:51]
    ds_read_b64_tr_b16 a[220:221], v38 offset:4096
    v_accvgpr_read_b32 v44, a40
    v_accvgpr_read_b32 v45, a41
    v_accvgpr_read_b32 v46, a42
    v_mfma_f32_16x16x32_bf16 a[52:55], a[236:239], a[148:151], a[52:55]
    ds_read_b64_tr_b16 a[222:223], v38 offset:6144
    v_accvgpr_read_b32 v47, a43
    v_cvt_pk_bf16_f32 v44, v44, v45
    v_cvt_pk_bf16_f32 v45, v46, v47
    v_mfma_f32_16x16x32_bf16 a[56:59], a[236:239], a[152:155], a[56:59]
    ds_write_b64 v56, v[44:45] offset:9216
    v_accvgpr_read_b32 v48, a44
    v_accvgpr_read_b32 v49, a45
    v_mfma_f32_16x16x32_bf16 a[48:51], a[240:243], a[156:159], a[48:51]
    ds_read_b64_tr_b16 a[224:225], v38 offset:8192
    v_accvgpr_read_b32 v50, a46
    v_accvgpr_read_b32 v51, a47
    v_cvt_pk_bf16_f32 v48, v48, v49
    v_mfma_f32_16x16x32_bf16 a[52:55], a[240:243], a[160:163], a[52:55]
    ds_read_b64_tr_b16 a[226:227], v38 offset:10240
    v_cvt_pk_bf16_f32 v49, v50, v51
    ds_write_b64 v56, v[48:49] offset:11520
    s_mov_b32 s97, 12288
    v_mfma_f32_16x16x32_bf16 a[56:59], a[240:243], a[164:167], a[56:59]
    s_waitcnt lgkmcnt(8)
    buffer_store_dwordx4 v[104:107], v59, s[56:59], s97 offen sc1
    buffer_store_dwordx4 v[108:111], v60, s[56:59], s97 offen sc1
    v_mfma_f32_16x16x32_bf16 a[48:51], a[244:247], a[168:171], a[48:51]
    ds_read_b64_tr_b16 a[228:229], v38 offset:12288
    v_mfma_f32_16x16x32_bf16 a[52:55], a[244:247], a[172:175], a[52:55]
    ds_read_b64_tr_b16 a[230:231], v38 offset:14336
    v_mfma_f32_16x16x32_bf16 a[56:59], a[244:247], a[176:179], a[56:59]
    s_waitcnt lgkmcnt(9)
    s_waitcnt lgkmcnt(2)
    s_barrier
    v_mfma_f32_16x16x32_bf16 a[60:63], a[216:219], a[132:135], a[60:63]
    ds_read_b64_tr_b16 a[232:233], v39 offset:32768
    ds_read_b128 v[124:127], v57 offset:6912
    ds_read_b128 v[128:131], v58 offset:6912
    v_accvgpr_read_b32 v44, a48
    v_mfma_f32_16x16x32_bf16 a[64:67], a[216:219], a[136:139], a[64:67]
    ds_read_b64_tr_b16 a[234:235], v39 offset:34816
    v_accvgpr_read_b32 v45, a49
    v_accvgpr_read_b32 v46, a50
    v_accvgpr_read_b32 v47, a51
    v_mfma_f32_16x16x32_bf16 a[68:71], a[216:219], a[140:143], a[68:71]
    v_cvt_pk_bf16_f32 v44, v44, v45
    v_cvt_pk_bf16_f32 v45, v46, v47
    ds_write_b64 v56, v[44:45] offset:0
    v_mfma_f32_16x16x32_bf16 a[60:63], a[220:223], a[144:147], a[60:63]
    ds_read_b64_tr_b16 a[236:237], v39 offset:36864
    v_accvgpr_read_b32 v48, a52
    v_accvgpr_read_b32 v49, a53
    v_accvgpr_read_b32 v50, a54
    v_mfma_f32_16x16x32_bf16 a[64:67], a[220:223], a[148:151], a[64:67]
    ds_read_b64_tr_b16 a[238:239], v39 offset:38912
    v_accvgpr_read_b32 v51, a55
    v_cvt_pk_bf16_f32 v48, v48, v49
    v_cvt_pk_bf16_f32 v49, v50, v51
    v_mfma_f32_16x16x32_bf16 a[68:71], a[220:223], a[152:155], a[68:71]
    ds_write_b64 v56, v[48:49] offset:2304
    v_accvgpr_read_b32 v44, a56
    v_accvgpr_read_b32 v45, a57
    v_mfma_f32_16x16x32_bf16 a[60:63], a[224:227], a[156:159], a[60:63]
    ds_read_b64_tr_b16 a[240:241], v39 offset:40960
    v_accvgpr_read_b32 v46, a58
    v_accvgpr_read_b32 v47, a59
    v_cvt_pk_bf16_f32 v44, v44, v45
    v_mfma_f32_16x16x32_bf16 a[64:67], a[224:227], a[160:163], a[64:67]
    ds_read_b64_tr_b16 a[242:243], v39 offset:43008
    v_cvt_pk_bf16_f32 v45, v46, v47
    ds_write_b64 v56, v[44:45] offset:4608
    s_mov_b32 s97, 18432
    v_mfma_f32_16x16x32_bf16 a[68:71], a[224:227], a[164:167], a[68:71]
    s_waitcnt lgkmcnt(8)
    buffer_store_dwordx4 v[124:127], v59, s[56:59], s97 offen sc1
    buffer_store_dwordx4 v[128:131], v60, s[56:59], s97 offen sc1
    v_mfma_f32_16x16x32_bf16 a[60:63], a[228:231], a[168:171], a[60:63]
    ds_read_b64_tr_b16 a[244:245], v39 offset:45056
    v_mfma_f32_16x16x32_bf16 a[64:67], a[228:231], a[172:175], a[64:67]
    ds_read_b64_tr_b16 a[246:247], v39 offset:47104
    v_mfma_f32_16x16x32_bf16 a[68:71], a[228:231], a[176:179], a[68:71]
    s_waitcnt lgkmcnt(9)
    v_mfma_f32_16x16x32_bf16 a[72:75], a[232:235], a[132:135], a[72:75]
    s_waitcnt lgkmcnt(2)
    s_barrier
    ds_read_b128 v[132:135], v57 offset:0
    ds_read_b128 v[148:151], v58 offset:0
    v_accvgpr_read_b32 v48, a60
    v_accvgpr_read_b32 v49, a61
    v_mfma_f32_16x16x32_bf16 a[76:79], a[232:235], a[136:139], a[76:79]
    v_accvgpr_read_b32 v50, a62
    v_accvgpr_read_b32 v51, a63
    v_cvt_pk_bf16_f32 v48, v48, v49
    v_cvt_pk_bf16_f32 v49, v50, v51
    v_mfma_f32_16x16x32_bf16 a[80:83], a[232:235], a[140:143], a[80:83]
    ds_write_b64 v56, v[48:49] offset:6912
    v_accvgpr_read_b32 v44, a64
    v_accvgpr_read_b32 v45, a65
    v_mfma_f32_16x16x32_bf16 a[72:75], a[236:239], a[144:147], a[72:75]
    v_accvgpr_read_b32 v46, a66
    v_accvgpr_read_b32 v47, a67
    v_cvt_pk_bf16_f32 v44, v44, v45
    v_cvt_pk_bf16_f32 v45, v46, v47
    v_mfma_f32_16x16x32_bf16 a[76:79], a[236:239], a[148:151], a[76:79]
    ds_write_b64 v56, v[44:45] offset:9216
    v_accvgpr_read_b32 v48, a68
    v_accvgpr_read_b32 v49, a69
    v_accvgpr_read_b32 v50, a70
    v_mfma_f32_16x16x32_bf16 a[80:83], a[236:239], a[152:155], a[80:83]
    v_accvgpr_read_b32 v51, a71
    v_cvt_pk_bf16_f32 v48, v48, v49
    v_cvt_pk_bf16_f32 v49, v50, v51
    v_mfma_f32_16x16x32_bf16 a[72:75], a[240:243], a[156:159], a[72:75]
    ds_write_b64 v56, v[48:49] offset:11520
    s_mov_b32 s97, 24576
    s_waitcnt lgkmcnt(3)
    buffer_store_dwordx4 v[132:135], v59, s[56:59], s97 offen sc1
    v_mfma_f32_16x16x32_bf16 a[76:79], a[240:243], a[160:163], a[76:79]
    buffer_store_dwordx4 v[148:151], v60, s[56:59], s97 offen sc1
    v_mfma_f32_16x16x32_bf16 a[80:83], a[240:243], a[164:167], a[80:83]
    v_mfma_f32_16x16x32_bf16 a[72:75], a[244:247], a[168:171], a[72:75]
    v_mfma_f32_16x16x32_bf16 a[76:79], a[244:247], a[172:175], a[76:79]
    v_mfma_f32_16x16x32_bf16 a[80:83], a[244:247], a[176:179], a[80:83]
    s_waitcnt lgkmcnt(0)
    s_barrier
    ds_read_b128 v[152:155], v57 offset:6912
    ds_read_b128 v[156:159], v58 offset:6912
    s_nop 1
    v_accvgpr_read_b32 v44, a72
    v_accvgpr_read_b32 v45, a73
    v_accvgpr_read_b32 v46, a74
    v_accvgpr_read_b32 v47, a75
    v_cvt_pk_bf16_f32 v44, v44, v45
    v_cvt_pk_bf16_f32 v45, v46, v47
    ds_write_b64 v56, v[44:45] offset:0
    v_accvgpr_read_b32 v48, a76
    v_accvgpr_read_b32 v49, a77
    v_accvgpr_read_b32 v50, a78
    v_accvgpr_read_b32 v51, a79
    v_cvt_pk_bf16_f32 v48, v48, v49
    v_cvt_pk_bf16_f32 v49, v50, v51
    ds_write_b64 v56, v[48:49] offset:2304
    v_accvgpr_read_b32 v44, a80
    v_accvgpr_read_b32 v45, a81
    v_accvgpr_read_b32 v46, a82
    v_accvgpr_read_b32 v47, a83
    v_cvt_pk_bf16_f32 v44, v44, v45
    v_cvt_pk_bf16_f32 v45, v46, v47
    ds_write_b64 v56, v[44:45] offset:4608
    s_mov_b32 s97, 30720
    s_waitcnt lgkmcnt(3)
    buffer_store_dwordx4 v[152:155], v59, s[56:59], s97 offen sc1
    buffer_store_dwordx4 v[156:159], v60, s[56:59], s97 offen sc1
    s_waitcnt lgkmcnt(0)
    s_barrier
    ds_read_b128 v[172:175], v57 offset:0
    ds_read_b128 v[176:179], v58 offset:0
    s_mov_b32 s97, 36864
    s_waitcnt lgkmcnt(0)
    buffer_store_dwordx4 v[172:175], v59, s[56:59], s97 offen sc1
    buffer_store_dwordx4 v[176:179], v60, s[56:59], s97 offen sc1

    v_and_b32 v58, 15, v1
    v_lshrrev_b32 v59, 1, v58
    v_and_b32 v60, 1, v58
    v_lshlrev_b32 v60, 4, v60
    v_mov_b32 v61, 0x3f80
    v_lshlrev_b32 v61, v60, v61

    v_cmp_eq_u32 vcc, 0, v59
    s_nop 1
    v_cndmask_b32 v44, 0, v61, vcc
    v_cmp_eq_u32 vcc, 1, v59
    s_nop 1
    v_cndmask_b32 v45, 0, v61, vcc
    v_cmp_eq_u32 vcc, 2, v59
    s_nop 1
    v_cndmask_b32 v46, 0, v61, vcc
    v_cmp_eq_u32 vcc, 3, v59
    s_nop 1
    v_cndmask_b32 v47, 0, v61, vcc

    v_lshrrev_b32 v59, 4, v1
    v_mul_u32_u24 v60, 43008, v59
    v_lshlrev_b32 v61, 4, v58
    v_add_u32 v60, v60, v61
    v_lshrrev_b32 v61, 3, v58
    v_mul_u32_u24 v61, 1792, v61
    v_and_b32 v62, 7, v58
    v_lshlrev_b32 v62, 4, v62
    v_add_u32 v61, v61, v62
    v_lshlrev_b32 v59, 3, v59
    v_add_u32 v61, v61, v59
    s_mul_i32 s96, s93, 344064
    s_add_u32 s96, s96, 0

    s_add_u32 s44, s32, s96
    s_addc_u32 s45, s33, 0
    s_and_b32 s45, s45, 0xffff
    s_mov_b32 s46, 344064
    s_mov_b32 s47, 0x20000

    s_mul_i32 s96, s89, 48
    s_mul_i32 s97, s90, 6
    s_add_u32 s96, s96, s97
    s_mul_i32 s96, s96, 1792
    s_mul_i32 s97, s91, 896
    s_add_u32 s96, s96, s97

    s_add_u32 s48, s28, s96
    s_addc_u32 s49, s29, 0
    s_and_b32 s49, s49, 0xffff
    s_mov_b32 s50, 9856
    s_mov_b32 s51, 0x20000

    s_add_u32 s96, s87, 0
    s_mul_i32 s97, s96, 43
    s_lshr_b32 s97, s97, 7
    s_mul_i32 s98, s97, 3
    s_sub_u32 s96, s96, s98
    s_mul_i32 s60, s97, 6144
    s_lshl_b32 s98, s96, 8
    s_add_u32 s60, s60, s98
    s_mul_i32 s98, s90, 768
    s_add_u32 s60, s60, s98
    s_add_u32 s97, s97, s92
    s_cmp_ge_u32 s97, 7
    s_cselect_b32 s98, 7, 0
    s_sub_u32 s97, s97, s98
    s_lshl_b32 s97, s97, 7
    s_mul_i32 s96, s96, 3584
    s_add_u32 s74, s96, s97

    s_add_u32 s96, s87, 4
    s_mul_i32 s97, s96, 43
    s_lshr_b32 s97, s97, 7
    s_mul_i32 s98, s97, 3
    s_sub_u32 s96, s96, s98
    s_mul_i32 s61, s97, 6144
    s_lshl_b32 s98, s96, 8
    s_add_u32 s61, s61, s98
    s_mul_i32 s98, s90, 768
    s_add_u32 s61, s61, s98
    s_add_u32 s97, s97, s92
    s_cmp_ge_u32 s97, 7
    s_cselect_b32 s98, 7, 0
    s_sub_u32 s97, s97, s98
    s_lshl_b32 s97, s97, 7
    s_mul_i32 s96, s96, 3584
    s_add_u32 s75, s96, s97

    s_add_u32 s96, s87, 8
    s_mul_i32 s97, s96, 43
    s_lshr_b32 s97, s97, 7
    s_mul_i32 s98, s97, 3
    s_sub_u32 s96, s96, s98
    s_mul_i32 s62, s97, 6144
    s_lshl_b32 s98, s96, 8
    s_add_u32 s62, s62, s98
    s_mul_i32 s98, s90, 768
    s_add_u32 s62, s62, s98
    s_add_u32 s97, s97, s92
    s_cmp_ge_u32 s97, 7
    s_cselect_b32 s98, 7, 0
    s_sub_u32 s97, s97, s98
    s_lshl_b32 s97, s97, 7
    s_mul_i32 s96, s96, 3584
    s_add_u32 s76, s96, s97

    s_add_u32 s96, s87, 12
    s_mul_i32 s97, s96, 43
    s_lshr_b32 s97, s97, 7
    s_mul_i32 s98, s97, 3
    s_sub_u32 s96, s96, s98
    s_mul_i32 s63, s97, 6144
    s_lshl_b32 s98, s96, 8
    s_add_u32 s63, s63, s98
    s_mul_i32 s98, s90, 768
    s_add_u32 s63, s63, s98
    s_add_u32 s97, s97, s92
    s_cmp_ge_u32 s97, 7
    s_cselect_b32 s98, 7, 0
    s_sub_u32 s97, s97, s98
    s_lshl_b32 s97, s97, 7
    s_mul_i32 s96, s96, 3584
    s_add_u32 s77, s96, s97

    s_add_u32 s96, s87, 16
    s_mul_i32 s97, s96, 43
    s_lshr_b32 s97, s97, 7
    s_mul_i32 s98, s97, 3
    s_sub_u32 s96, s96, s98
    s_mul_i32 s64, s97, 6144
    s_lshl_b32 s98, s96, 8
    s_add_u32 s64, s64, s98
    s_mul_i32 s98, s90, 768
    s_add_u32 s64, s64, s98
    s_add_u32 s97, s97, s92
    s_cmp_ge_u32 s97, 7
    s_cselect_b32 s98, 7, 0
    s_sub_u32 s97, s97, s98
    s_lshl_b32 s97, s97, 7
    s_mul_i32 s96, s96, 3584
    s_add_u32 s78, s96, s97

    s_add_u32 s96, s87, 20
    s_mul_i32 s97, s96, 43
    s_lshr_b32 s97, s97, 7
    s_mul_i32 s98, s97, 3
    s_sub_u32 s96, s96, s98
    s_mul_i32 s65, s97, 6144
    s_lshl_b32 s98, s96, 8
    s_add_u32 s65, s65, s98
    s_mul_i32 s98, s90, 768
    s_add_u32 s65, s65, s98
    s_add_u32 s97, s97, s92
    s_cmp_ge_u32 s97, 7
    s_cselect_b32 s98, 7, 0
    s_sub_u32 s97, s97, s98
    s_lshl_b32 s97, s97, 7
    s_mul_i32 s96, s96, 3584
    s_add_u32 s79, s96, s97

    s_waitcnt vmcnt(0)

    s_lshl_b32 s96, s90, 7
    s_lshl_b32 s97, s87, 2
    s_add_u32 s96, s96, s97
    v_mov_b32 v56, 1
    v_mov_b32 v57, 0
    s_mov_b64 exec, 1
    buffer_store_dword v56, v57, s[4:7], s96 offen sc1
    s_mov_b64 exec, -1

    s_cmp_lg_u32 s87, 0
    s_cbranch_scc1 L_polled
    s_mov_b32 s98, 0
    s_mov_b64 exec, 0xff
L_cnt:
    v_cmp_ne_u32 vcc, 8, v43
    s_cbranch_vccz L_cntok
    global_load_dword v43, v41, s[24:25] sc1
    s_waitcnt vmcnt(0)
    s_add_u32 s98, s98, 1
    s_cmp_lt_u32 s98, 0x20000
    s_cbranch_scc1 L_cnt
L_cntok:
    v_lshlrev_b32 v56, 7, v1
    s_mov_b32 s98, 0
L_poll:
    buffer_load_dwordx4 v[128:131], v56, s[4:7], 0 offen sc1
    s_waitcnt vmcnt(0)
    v_and_b32 v128, v128, v129
    v_and_b32 v130, v130, v131
    v_and_b32 v128, v128, v130
    v_cmp_ne_u32 vcc, 1, v128
    s_cbranch_vccz L_pollok
    s_add_u32 s98, s98, 1
    s_cmp_lt_u32 s98, 0x20000
    s_cbranch_scc1 L_poll
L_pollok:
    s_mov_b64 exec, -1
L_polled:

    s_barrier
    buffer_load_dwordx4 v[128:131], v60, s[44:47], s60 offen sc1
    s_add_u32 s88, s60, 172032
    buffer_load_dwordx4 v[132:135], v60, s[44:47], s88 offen sc1
    buffer_load_dwordx4 v[136:139], v60, s[44:47], s61 offen sc1
    s_add_u32 s88, s61, 172032
    buffer_load_dwordx4 v[140:143], v60, s[44:47], s88 offen sc1
    buffer_load_dwordx4 v[144:147], v60, s[44:47], s62 offen sc1
    s_add_u32 s88, s62, 172032
    buffer_load_dwordx4 v[148:151], v60, s[44:47], s88 offen sc1
    buffer_load_dwordx4 v[152:155], v60, s[44:47], s63 offen sc1
    s_add_u32 s88, s63, 172032
    buffer_load_dwordx4 v[156:159], v60, s[44:47], s88 offen sc1
    buffer_load_dwordx4 v[160:163], v60, s[44:47], s64 offen sc1
    s_add_u32 s88, s64, 172032
    buffer_load_dwordx4 v[164:167], v60, s[44:47], s88 offen sc1
    s_cmp_lg_u32 s87, 0
    s_cbranch_scc1 L_c5a
    buffer_load_dwordx4 v[168:171], v60, s[44:47], s65 offen sc1
    s_add_u32 s88, s65, 172032
    buffer_load_dwordx4 v[172:175], v60, s[44:47], s88 offen sc1
L_c5a:
    s_waitcnt vmcnt(8)
    v_mfma_f32_16x16x32_bf16 v[184:187], v[44:47], v[128:131], 0
    v_mfma_f32_16x16x32_bf16 v[184:187], v[44:47], v[132:135], v[184:187]
    s_waitcnt vmcnt(6)
    v_mfma_f32_16x16x32_bf16 v[188:191], v[44:47], v[136:139], 0
    v_mfma_f32_16x16x32_bf16 v[188:191], v[44:47], v[140:143], v[188:191]
    s_waitcnt vmcnt(4)
    v_mfma_f32_16x16x32_bf16 v[192:195], v[44:47], v[144:147], 0
    v_mfma_f32_16x16x32_bf16 v[192:195], v[44:47], v[148:151], v[192:195]
    s_waitcnt vmcnt(2)
    v_mfma_f32_16x16x32_bf16 v[196:199], v[44:47], v[152:155], 0
    v_mfma_f32_16x16x32_bf16 v[196:199], v[44:47], v[156:159], v[196:199]
    s_waitcnt vmcnt(0)
    v_mfma_f32_16x16x32_bf16 v[200:203], v[44:47], v[160:163], 0
    v_mfma_f32_16x16x32_bf16 v[200:203], v[44:47], v[164:167], v[200:203]
    s_cmp_lg_u32 s87, 0
    s_cbranch_scc1 L_c5b
    s_waitcnt vmcnt(0)
    v_mfma_f32_16x16x32_bf16 v[204:207], v[44:47], v[168:171], 0
    v_mfma_f32_16x16x32_bf16 v[204:207], v[44:47], v[172:175], v[204:207]
L_c5b:
    s_mov_b32 exec_hi, 0
    v_cvt_pk_bf16_f32 v184, v184, v185
    v_cvt_pk_bf16_f32 v185, v186, v187
    buffer_store_dwordx2 v[184:185], v61, s[48:51], s74 offen
    v_cvt_pk_bf16_f32 v188, v188, v189
    v_cvt_pk_bf16_f32 v189, v190, v191
    buffer_store_dwordx2 v[188:189], v61, s[48:51], s75 offen
    v_cvt_pk_bf16_f32 v192, v192, v193
    v_cvt_pk_bf16_f32 v193, v194, v195
    buffer_store_dwordx2 v[192:193], v61, s[48:51], s76 offen
    v_cvt_pk_bf16_f32 v196, v196, v197
    v_cvt_pk_bf16_f32 v197, v198, v199
    buffer_store_dwordx2 v[196:197], v61, s[48:51], s77 offen
    v_cvt_pk_bf16_f32 v200, v200, v201
    v_cvt_pk_bf16_f32 v201, v202, v203
    buffer_store_dwordx2 v[200:201], v61, s[48:51], s78 offen
    s_cmp_lg_u32 s87, 0
    s_cbranch_scc1 L_c5c
    s_nop 7
    v_cvt_pk_bf16_f32 v204, v204, v205
    v_cvt_pk_bf16_f32 v205, v206, v207
    buffer_store_dwordx2 v[204:205], v61, s[48:51], s79 offen
L_c5c:
    s_mov_b32 exec_hi, -1
    s_endpgm
L_end:
s_endpgm
.section .rodata,"a"
.p2align 6
.amdhsa_kernel concat_heads__gqa_block_cached__gqa_block_cached__near_ridge_kernel
  .amdhsa_next_free_vgpr 512
  .amdhsa_next_free_sgpr 102
  .amdhsa_accum_offset 256
  .amdhsa_group_segment_fixed_size 0
  .amdhsa_kernarg_size 104
  .amdhsa_user_sgpr_count 2
  .amdhsa_user_sgpr_kernarg_segment_ptr 1
  .amdhsa_system_sgpr_workgroup_id_x 1
.end_amdhsa_kernel
```
